```python
import torch

def _softmax(x, axis=-1):
    return torch.softmax(x, dim=axis)
def _gelu(x):
    return torch.nn.functional.gelu(x, approximate="tanh")
def _silu(x):
    return torch.nn.functional.silu(x)
def _sigmoid(x):
    return torch.sigmoid(x)
def _layernorm(x, axis=-1, eps=1e-5):
    m = x.mean(dim=axis, keepdim=True)
    v = x.var(dim=axis, keepdim=True, unbiased=False)
    return (x - m) / torch.sqrt(v + eps)
def _scatter_add(tgt, idx, src, axis=0):
    return tgt.clone().index_add_(axis, idx, src)
def _segment_sum(src, seg, n):
    out = torch.zeros((n,) + src.shape[1:], dtype=src.dtype)
    return out.index_add_(0, seg, src)
def _pad(x, pw):
    flat = tuple(v for pair in reversed(pw) for v in pair)
    return torch.nn.functional.pad(x, flat)

kernel_name = 'concat_heads__mha_block_cached__mha_block_cached__near_ridge'

def setup_inputs():

    _w = (lambda a: (lambda t: t.to(torch.bfloat16) if t.is_floating_point() else t)(torch.as_tensor(a)))
    def _A_setup():
        B, Sq, D = 32, 32, 512
        H, Sk, Dh = 32, 32, 128
        return {
            "x": _w((lambda *s: torch.randn(*s, dtype=torch.bfloat16) * 0.8)(B, Sq, D)),
            "k_cache": _w((lambda *s: torch.randn(*s, dtype=torch.bfloat16) * 0.8)(B, H, Sk, Dh)),
            "v_cache": _w((lambda *s: torch.randn(*s, dtype=torch.bfloat16) * 0.05)(B, H, Sk, Dh)),
            "wq": _w((lambda *s: torch.randn(*s, dtype=torch.bfloat16) * 0.8)(D, H * Dh) * (D ** -0.5)),
            "wo": _w((lambda *s: torch.randn(*s, dtype=torch.bfloat16) * 0.05)(H * Dh, D) * ((H * Dh) ** -0.5)),
        }
    _A_in = _A_setup()

    def _B_setup():
        B, Sq, D = 32, 32, 512
        H, Sk, Dh = 32, 32, 128
        return {
            "x": _w((lambda *s: torch.randn(*s, dtype=torch.bfloat16) * 0.8)(B, Sq, D)),
            "k_cache": _w((lambda *s: torch.randn(*s, dtype=torch.bfloat16) * 0.8)(B, H, Sk, Dh)),
            "v_cache": _w((lambda *s: torch.randn(*s, dtype=torch.bfloat16) * 0.05)(B, H, Sk, Dh)),
            "wq": _w((lambda *s: torch.randn(*s, dtype=torch.bfloat16) * 0.8)(D, H * Dh) * (D ** -0.5)),
            "wo": _w((lambda *s: torch.randn(*s, dtype=torch.bfloat16) * 0.05)(H * Dh, D) * ((H * Dh) ** -0.5)),
        }
    _B_in = _B_setup()

    return {
        "A_x": _A_in["x"],
        "A_k_cache": _A_in["k_cache"],
        "A_v_cache": _A_in["v_cache"],
        "A_wq": _A_in["wq"],
        "A_wo": _A_in["wo"],
        "B_x": _B_in["x"],
        "B_k_cache": _B_in["k_cache"],
        "B_v_cache": _B_in["v_cache"],
        "B_wq": _B_in["wq"],
        "B_wo": _B_in["wo"],
    }

def reference(A_x, A_k_cache, A_v_cache, A_wq, A_wo, B_x, B_k_cache, B_v_cache, B_wq, B_wo):
    def _A_ref(x, k_cache, v_cache, wq, wo):
        B, Sq, D = x.shape
        H, Dh = 32, 128
        q = (lambda x, *d: x.permute(*d))((x @ wq).reshape(B, Sq, H, Dh), 0, 2, 1, 3)
        scores = torch.einsum("bhqd,bhkd->bhqk", q, k_cache) * (Dh ** -0.5)
        p = _softmax(scores, axis=-1)
        o = torch.einsum("bhqk,bhkd->bhqd", p, v_cache)
        return (lambda x, *d: x.permute(*d))(o, 0, 2, 1, 3).reshape(B, Sq, H * Dh) @ wo

    def _B_ref(x, k_cache, v_cache, wq, wo):
        B, Sq, D = x.shape
        H, Dh = 32, 128
        q = (lambda x, *d: x.permute(*d))((x @ wq).reshape(B, Sq, H, Dh), 0, 2, 1, 3)
        scores = torch.einsum("bhqd,bhkd->bhqk", q, k_cache) * (Dh ** -0.5)
        p = _softmax(scores, axis=-1)
        o = torch.einsum("bhqk,bhkd->bhqd", p, v_cache)
        return (lambda x, *d: x.permute(*d))(o, 0, 2, 1, 3).reshape(B, Sq, H * Dh) @ wo

    a = _A_ref(A_x, A_k_cache, A_v_cache, A_wq, A_wo)
    b = _B_ref(B_x, B_k_cache, B_v_cache, B_wq, B_wo)
    return torch.concatenate([a, b], axis=-1)
```

```asm
; @launch grid=(256,1,1) block=(256,1,1) lds=162560
.amdgcn_target "amdgcn-amd-amdhsa--gfx950"
.text
.globl concat_heads__mha_block_cached__mha_block_cached__near_ridge_kernel
.p2align 12
.p2align 8
.type concat_heads__mha_block_cached__mha_block_cached__near_ridge_kernel,@function
concat_heads__mha_block_cached__mha_block_cached__near_ridge_kernel:
 s_cmp_ge_u32 s2, 256
 s_cbranch_scc1 L_end
 s_load_dwordx16 s[36:51], s[0:1], 0
 s_load_dwordx8 s[52:59], s[0:1], 64
 s_load_dwordx2 s[60:61], s[0:1], 96
 v_lshrrev_b32 v12, 6, v0
 v_and_b32 v1, 63, v0
 v_readfirstlane_b32 s62, v12
 s_bfe_u32 s88, s2, 0x10002
 s_and_b32 s89, s2, 3
 s_bfe_u32 s90, s2, 0x20003
 s_lshr_b32 s91, s2, 5
 s_lshr_b32 s93, s2, 7
 s_lshr_b32 s78, s2, 7
 s_getpc_b64 s[4:5]
L_pc:
 s_bfe_u32 s3, s2, 262147
 s_lshl_b32 s3, s3, 2
 s_add_u32 s3, s3, s62
 s_mul_i32 s3, s3, 512
 s_mul_i32 s65, s78, L_v1-L_v0
 s_add_u32 s3, s3, s65
 s_add_u32 s3, s3, L_v0-L_pc
 v_lshlrev_b32 v43, 7, v1
 v_add_u32 v43, s3, v43
 s_mov_b64 exec, 15
 global_load_dword v48, v43, s[4:5]
 s_mov_b64 exec, -1
 s_add_u32 s92, s90, s91
 s_and_b32 s92, s92, 3
 v_lshrrev_b32 v12, 4, v1
 v_and_b32 v13, 15, v1
 v_lshlrev_b32 v14, 2, v12
 v_xor_b32 v14, v14, v13
 v_lshlrev_b32 v14, 4, v14
 v_xor_b32 v15, v12, v13
 v_lshlrev_b32 v15, 4, v15
 s_and_b32 s94, s62, 1
 s_lshr_b32 s65, s62, 1
 s_mul_i32 s63, s62, 4224
 s_lshl_b32 s3, s65, 18
 s_lshl_b32 s94, s94, 15
 s_add_u32 s3, s3, s94
 v_lshl_add_u32 v4, v12, 13, v14
 v_add_u32 v4, s3, v4
 v_add_u32 v5, 64480, v4
 v_add_u32 v6, 128960, v4
 v_add_u32 v7, 193440, v4
 v_and_b32 v8, 0x70, v15
 v_lshrrev_b32 v9, 3, v1
 v_lshl_add_u32 v8, v9, 10, v8
 s_lshl_b32 s3, s62, 15
 v_add_u32 v8, s3, v8
 v_add_u32 v9, 7104, v8
 v_add_u32 v10, 14208, v8
 v_add_u32 v11, 21312, v8
 s_mul_i32 s64, s62, 17408
 s_add_u32 s64, s64, 92928
 s_lshl_b32 s94, s89, 3
 s_lshl_b32 s65, s90, 1
 s_add_u32 s94, s94, s65
 s_add_u32 s94, s94, s93
 s_lshl_b32 s70, s91, 17
 s_lshl_b32 s3, s92, 7
 s_add_u32 s70, s70, s3
 s_lshl_b32 s71, s94, 8
 s_lshl_b32 s3, s92, 19
 s_add_u32 s71, s71, s3
 s_andn2_b32 s80, s70, 0x100
 s_andn2_b32 s81, s71, 0x100000
 s_cmp_lg_u32 s88, 0
 s_waitcnt lgkmcnt(0)
 s_cselect_b64 s[16:17], s[52:53], s[42:43]
 s_cselect_b64 s[4:5], s[46:47], s[36:37]
 s_cselect_b64 s[8:9], s[48:49], s[38:39]
 s_cselect_b64 s[12:13], s[50:51], s[40:41]
 s_cselect_b64 s[20:21], s[54:55], s[44:45]
 s_add_u32 m0, s63, 0
 s_add_u32 s86, s16, s81
 s_addc_u32 s87, s17, 0
 global_load_lds_dwordx4 v4, s[86:87] offset:0
 global_load_lds_dwordx4 v5, s[86:87] offset:1056
 global_load_lds_dwordx4 v6, s[86:87] offset:2112
 global_load_lds_dwordx4 v7, s[86:87] offset:3168
 s_add_u32 m0, s64, 0
 s_add_u32 s86, s4, s80
 s_addc_u32 s87, s5, 0
 global_load_lds_dwordx4 v8, s[86:87] offset:0
 global_load_lds_dwordx4 v9, s[86:87] offset:1088
 global_load_lds_dwordx4 v10, s[86:87] offset:2176
 global_load_lds_dwordx4 v11, s[86:87] offset:3264
 s_mov_b32 s34, 27262976
 s_mov_b32 s35, 0x20000
 s_mov_b64 s[32:33], s[60:61]
 s_mov_b64 s[24:25], s[56:57]
 s_mov_b64 s[28:29], s[58:59]
 s_lshl_b32 s95, s88, 3
 s_add_u32 s95, s95, s91
 s_lshl_b32 s73, s95, 13
 s_add_u32 s73, s73, 12582912
 s_and_b32 s3, s2, 0x1b
 s_or_b32 s68, s3, s62
 s_cmp_lg_u32 s3, 0
 s_cbranch_scc1 L_noclr
 v_lshlrev_b32 v56, 4, v0
 s_add_u32 s3, s73, 4096
 v_mov_b32 v52, 0
 v_mov_b32 v53, 0
 v_mov_b32 v54, 0
 v_mov_b32 v55, 0
 buffer_store_dwordx4 v[52:55], v56, s[32:35], s73 offen sc1
 buffer_store_dwordx4 v[52:55], v56, s[32:35], s3 offen sc1
L_noclr:
 s_lshl_b32 s69, s94, 13
 s_lshl_b32 s3, s91, 20
 s_add_u32 s69, s69, s3
 s_lshl_b32 s3, s62, 18
 v_lshl_add_u32 v17, v12, 8, v15
 v_add_u32 v17, s3, v17
 v_lshl_add_u32 v27, v12, 8, v14
 v_add_u32 v27, s3, v27
 s_sub_u32 s12, s12, 128
 s_subb_u32 s13, s13, 0
 v_add_u32 v24, 128, v27
 v_add_u32 v25, 96, v27
 v_add_u32 v26, 64, v27
 v_add_u32 v27, 32, v27
 s_lshl_b32 s79, s94, 17
 s_lshl_b32 s3, s92, 8
 s_add_u32 s79, s79, s3
 s_lshl_b32 s72, s95, 18
 s_lshl_b32 s3, s94, 13
 s_add_u32 s72, s72, s3
 s_lshl_b32 s3, s62, 11
 s_add_u32 s72, s72, s3
 s_lshl_b32 s65, s95, 19
 s_lshl_b32 s3, s90, 17
 s_add_u32 s65, s65, s3
 s_lshl_b32 s3, s62, 11
 s_add_u32 s65, s65, s3
 s_mul_i32 s3, s89, 40960
 s_add_u32 s65, s65, s3
 s_add_u32 s75, s65, 4194304
 s_lshl_b32 s96, s91, 18
 s_lshl_b32 s3, s62, 16
 s_add_u32 s96, s96, s3
 s_lshl_b32 s3, s88, 10
 s_add_u32 s96, s96, s3
 s_lshl_b32 s3, s92, 8
 s_add_u32 s96, s96, s3
 s_lshl_b32 s3, s89, 6
 s_add_u32 s96, s96, s3
 s_mov_b32 s76, 0x3e0293ee
 s_lshl_b32 s95, s95, 4
 s_lshl_b32 s3, s89, 6
 v_xor_b32 v20, s3, v14
 v_lshl_add_u32 v20, v12, 10, v20
 s_lshl_b32 s3, s62, 14
 v_add_u32 v20, s3, v20
 v_add_u32 v21, 3040, v20
 v_add_u32 v22, 6080, v20
 v_add_u32 v23, 9120, v20
 v_lshrrev_b32 v14, 2, v13
 v_and_b32 v15, 3, v13
 v_mul_u32_u24 v28, 1056, v12
 v_lshl_add_u32 v28, v14, 8, v28
 v_lshl_add_u32 v28, v15, 3, v28
 v_xor_b32 v43, 3, v14
 v_lshl_add_u32 v31, v43, 6, v28
 v_xor_b32 v43, 2, v14
 v_lshl_add_u32 v30, v43, 6, v28
 v_xor_b32 v43, 1, v14
 v_lshl_add_u32 v29, v43, 6, v28
 v_xor_b32 v43, 0, v14
 v_lshl_add_u32 v28, v43, 6, v28
 v_add_u32 v32, 50688, v28
 v_add_u32 v36, s64, v28
 v_add_u32 v33, 50688, v29
 v_add_u32 v37, s64, v29
 v_add_u32 v34, 50688, v30
 v_add_u32 v38, s64, v30
 v_add_u32 v35, 50688, v31
 v_add_u32 v39, s64, v31
 v_mul_u32_u24 v43, 1088, v14
 v_lshl_add_u32 v43, v15, 8, v43
 v_add_u32 v43, s64, v43
 v_bfe_u32 v16, v1, 1, 2
 v_xor_b32 v16, v12, v16
 v_lshlrev_b32 v16, 4, v16
 v_lshl_add_u32 v16, v13, 7, v16
 v_and_b32 v44, 8, v1
 v_lshl_add_u32 v16, v44, 3, v16
 v_add_u32 v16, s64, v16
 v_and_b32 v44, 1, v12
 v_lshl_add_u32 v43, v44, 3, v43
 v_lshrrev_b32 v45, 1, v12
 v_xor_b32 v18, v45, v15
 v_xor_b32 v19, 2, v18
 v_lshl_add_u32 v18, v18, 4, v43
 v_lshl_add_u32 v19, v19, 4, v43
 v_lshlrev_b32 v46, 11, v13
 v_lshl_add_u32 v46, v44, 5, v46
 v_lshl_add_u32 v46, v45, 4, v46
 s_lshl_b32 s65, s89, 11
 s_lshl_b32 s3, s90, 9
 s_add_u32 s65, s65, s3
 s_lshl_b32 s3, s62, 7
 s_add_u32 s65, s65, s3
 s_add_u32 s74, s73, s65
 v_max_u32 v43, 1, v15
 v_lshlrev_b32 v41, 9, v43
 v_xor_b32 v41, s65, v41
 v_lshlrev_b32 v42, 11, v43
 v_xor_b32 v42, s65, v42
 v_bfe_u32 v43, v1, 1, 2
 v_lshrrev_b32 v2, 3, v13
 v_and_b32 v3, 1, v1
 v_lshl_add_u32 v2, v2, 1, v3
 v_cmp_eq_u32 vcc, v43, v12
 v_mov_b32 v3, 0x3f80
 v_lshlrev_b32 v46, 13, v12
 v_cndmask_b32 v3, 0, v3, vcc
 v_lshl_add_u32 v46, v13, 2, v46
 v_add_u32 v46, 4096, v46
 v_cmp_eq_u32 vcc, 0, v2
 s_nop 1
 v_cndmask_b32 v45, 0, v3, vcc
 v_lshlrev_b32 v44, 16, v45
 v_accvgpr_write_b32 a248, v45
 v_accvgpr_write_b32 a252, v44
 v_cmp_eq_u32 vcc, 1, v2
 s_nop 1
 v_cndmask_b32 v45, 0, v3, vcc
 v_lshlrev_b32 v44, 16, v45
 v_accvgpr_write_b32 a249, v45
 v_accvgpr_write_b32 a253, v44
 v_cmp_eq_u32 vcc, 2, v2
 s_nop 1
 v_cndmask_b32 v45, 0, v3, vcc
 v_lshlrev_b32 v44, 16, v45
 v_accvgpr_write_b32 a250, v45
 v_accvgpr_write_b32 a254, v44
 v_cmp_eq_u32 vcc, 3, v2
 s_nop 1
 v_cndmask_b32 v45, 0, v3, vcc
 v_lshlrev_b32 v44, 16, v45
 v_accvgpr_write_b32 a251, v45
 v_accvgpr_write_b32 a255, v44
 v_lshlrev_b32 v40, 4, v1
 v_mov_b32 v44, 1
 v_mov_b32 v45, 0
 s_add_u32 s24, s24, s96
 s_addc_u32 s25, s25, 0
 s_add_u32 s28, s28, s95
 s_addc_u32 s29, s29, 0
 s_add_u32 m0, s63, 16896
 s_xor_b32 s66, s81, 0x80000
 s_add_u32 s86, s16, s66
 s_addc_u32 s87, s17, 0
 global_load_lds_dwordx4 v4, s[86:87] offset:0
 global_load_lds_dwordx4 v5, s[86:87] offset:1056
 global_load_lds_dwordx4 v6, s[86:87] offset:2112
 global_load_lds_dwordx4 v7, s[86:87] offset:3168
 s_add_u32 m0, s64, 4352
 s_xor_b32 s66, s80, 0x80
 s_add_u32 s86, s4, s66
 s_addc_u32 s87, s5, 0
 global_load_lds_dwordx4 v8, s[86:87] offset:0
 global_load_lds_dwordx4 v9, s[86:87] offset:1088
 global_load_lds_dwordx4 v10, s[86:87] offset:2176
 global_load_lds_dwordx4 v11, s[86:87] offset:3264
 s_cmp_eq_u32 s78, 1
 s_cbranch_scc1 L_v1
 s_branch L_v0
.p2align 12
L_v0:
 s_mov_b64 exec, 0
 s_cmp_eq_u32 s62, 0
 s_cbranch_scc1 L_hop0_0_0
 s_cmp_eq_u32 s62, 1
 s_cbranch_scc1 L_hop0_0_1
 s_cmp_eq_u32 s62, 2
 s_cbranch_scc1 L_hop0_0_2
 s_branch L_hop0_0_3
L_ret0_0:
 s_mov_b64 exec, -1
 s_waitcnt vmcnt(8)
 s_barrier
 ds_read_b128 a[0:3], v16 offset:0
 ds_read_b128 a[4:7], v16 offset:2176
 ds_read_b128 a[8:11], v16 offset:64
 ds_read_b128 a[12:15], v16 offset:2240
 ds_read_b64_tr_b16 a[192:193], v28 offset:0
 ds_read_b64_tr_b16 a[194:195], v28 offset:4224
 ds_read_b64_tr_b16 a[196:197], v28 offset:32
 ds_read_b64_tr_b16 a[198:199], v28 offset:4256
 ds_read_b64_tr_b16 a[200:201], v29 offset:0
 ds_read_b64_tr_b16 a[202:203], v29 offset:4224
 ds_read_b64_tr_b16 a[204:205], v29 offset:32
 ds_read_b64_tr_b16 a[206:207], v29 offset:4256
 ds_read_b64_tr_b16 a[208:209], v30 offset:0
 ds_read_b64_tr_b16 a[210:211], v30 offset:4224
 ds_read_b64_tr_b16 a[212:213], v30 offset:32
 ds_read_b64_tr_b16 a[214:215], v30 offset:4256
 s_waitcnt lgkmcnt(4)
 v_mfma_f32_16x16x32_bf16 v[60:63], a[192:195], a[0:3], 0
 ds_read_b64_tr_b16 a[216:217], v31 offset:0
 s_add_u32 m0, s63, 33792
 s_xor_b32 s66, s81, 0x100
 v_mfma_f32_16x16x32_bf16 v[64:67], a[192:195], a[4:7], 0
 ds_read_b64_tr_b16 a[218:219], v31 offset:4224
 s_add_u32 s86, s16, s66
 s_addc_u32 s87, s17, 0
 v_mfma_f32_16x16x32_bf16 v[68:71], a[196:199], a[0:3], 0
 ds_read_b64_tr_b16 a[220:221], v31 offset:32
 global_load_lds_dwordx4 v4, s[86:87] offset:0
 v_mfma_f32_16x16x32_bf16 v[72:75], a[196:199], a[4:7], 0
 ds_read_b64_tr_b16 a[222:223], v31 offset:4256
 s_xor_b32 s3, s79, 0xf0000
 v_mfma_f32_16x16x32_bf16 v[76:79], a[200:203], a[0:3], 0
 ds_read_b64_tr_b16 a[192:193], v28 offset:8448
 s_add_u32 s0, s20, s3
 s_addc_u32 s1, s21, 0
 v_mfma_f32_16x16x32_bf16 v[80:83], a[200:203], a[4:7], 0
 ds_read_b64_tr_b16 a[194:195], v28 offset:12672
 global_load_lds_dwordx4 v5, s[86:87] offset:1056
 v_mfma_f32_16x16x32_bf16 v[84:87], a[204:207], a[0:3], 0
 ds_read_b64_tr_b16 a[196:197], v28 offset:8480
 s_xor_b32 s3, s79, 0xe0000
 v_mfma_f32_16x16x32_bf16 v[88:91], a[204:207], a[4:7], 0
 ds_read_b64_tr_b16 a[198:199], v28 offset:12704
 s_waitcnt lgkmcnt(4)
 v_mfma_f32_16x16x32_bf16 v[92:95], a[208:211], a[0:3], 0
 ds_read_b64_tr_b16 a[200:201], v29 offset:8448
 global_load_lds_dwordx4 v6, s[86:87] offset:2112
 v_mfma_f32_16x16x32_bf16 v[96:99], a[208:211], a[4:7], 0
 ds_read_b64_tr_b16 a[202:203], v29 offset:12672
 s_add_u32 s6, s20, s3
 s_addc_u32 s7, s21, 0
 v_mfma_f32_16x16x32_bf16 v[100:103], a[212:215], a[0:3], 0
 ds_read_b64_tr_b16 a[204:205], v29 offset:8480
 s_xor_b32 s3, s79, 0xb0000
 v_mfma_f32_16x16x32_bf16 v[104:107], a[212:215], a[4:7], 0
 ds_read_b64_tr_b16 a[206:207], v29 offset:12704
 global_load_lds_dwordx4 v7, s[86:87] offset:3168
 v_mfma_f32_16x16x32_bf16 v[108:111], a[216:219], a[0:3], 0
 ds_read_b64_tr_b16 a[208:209], v30 offset:8448
 s_add_u32 m0, s63, 50688
 s_xor_b32 s66, s81, 0x100000
 v_mfma_f32_16x16x32_bf16 v[112:115], a[216:219], a[4:7], 0
 ds_read_b64_tr_b16 a[210:211], v30 offset:12672
 s_add_u32 s86, s16, s66
 s_addc_u32 s87, s17, 0
 v_mfma_f32_16x16x32_bf16 v[116:119], a[220:223], a[0:3], 0
 ds_read_b64_tr_b16 a[212:213], v30 offset:8480
 global_load_lds_dwordx4 v4, s[86:87] offset:0
 v_mfma_f32_16x16x32_bf16 v[120:123], a[220:223], a[4:7], 0
 ds_read_b64_tr_b16 a[214:215], v30 offset:12704
 s_waitcnt lgkmcnt(4)
 v_mfma_f32_16x16x32_bf16 v[60:63], a[192:195], a[8:11], v[60:63]
 ds_read_b64_tr_b16 a[216:217], v31 offset:8448
 s_add_u32 s10, s20, s3
 s_addc_u32 s11, s21, 0
 v_mfma_f32_16x16x32_bf16 v[64:67], a[192:195], a[12:15], v[64:67]
 ds_read_b64_tr_b16 a[218:219], v31 offset:12672
 global_load_lds_dwordx4 v5, s[86:87] offset:1056
 v_mfma_f32_16x16x32_bf16 v[68:71], a[196:199], a[8:11], v[68:71]
 ds_read_b64_tr_b16 a[220:221], v31 offset:8480
 s_xor_b32 s3, s79, 0xa0000
 v_mfma_f32_16x16x32_bf16 v[72:75], a[196:199], a[12:15], v[72:75]
 ds_read_b64_tr_b16 a[222:223], v31 offset:12704
 s_waitcnt vmcnt(10)
 s_barrier
 s_cmp_lg_u32 s68, 0
 s_cbranch_scc0 L_init0
L_noinit0:
 v_mfma_f32_16x16x32_bf16 v[76:79], a[200:203], a[8:11], v[76:79]
 ds_read_b64_tr_b16 a[192:193], v28 offset:16896
 global_load_lds_dwordx4 v6, s[86:87] offset:2112
 v_mfma_f32_16x16x32_bf16 v[80:83], a[200:203], a[12:15], v[80:83]
 ds_read_b64_tr_b16 a[194:195], v28 offset:21120
 s_waitcnt vmcnt(7)
 ds_read_b128 a[16:19], v16 offset:4352
 v_mfma_f32_16x16x32_bf16 v[84:87], a[204:207], a[8:11], v[84:87]
 ds_read_b64_tr_b16 a[196:197], v28 offset:16928
 s_add_u32 s14, s20, s3
 s_addc_u32 s15, s21, 0
 v_mfma_f32_16x16x32_bf16 v[88:91], a[204:207], a[12:15], v[88:91]
 ds_read_b64_tr_b16 a[198:199], v28 offset:21152
 global_load_lds_dwordx4 v7, s[86:87] offset:3168
 s_waitcnt lgkmcnt(5)
 v_mfma_f32_16x16x32_bf16 v[92:95], a[208:211], a[8:11], v[92:95]
 ds_read_b64_tr_b16 a[200:201], v29 offset:16896
 s_add_u32 m0, s64, 0
 s_xor_b32 s66, s80, 0x100
 ds_read_b128 a[20:23], v16 offset:6528
 v_mfma_f32_16x16x32_bf16 v[96:99], a[208:211], a[12:15], v[96:99]
 ds_read_b64_tr_b16 a[202:203], v29 offset:21120
 s_add_u32 s86, s4, s66
 s_addc_u32 s87, s5, 0
 v_mfma_f32_16x16x32_bf16 v[100:103], a[212:215], a[8:11], v[100:103]
 ds_read_b64_tr_b16 a[204:205], v29 offset:16928
 global_load_lds_dwordx4 v8, s[86:87] offset:0
 ds_read_b128 a[24:27], v16 offset:4416
 v_mfma_f32_16x16x32_bf16 v[104:107], a[212:215], a[12:15], v[104:107]
 ds_read_b64_tr_b16 a[206:207], v29 offset:21152
 s_xor_b32 s3, s79, 0x70000
 v_mfma_f32_16x16x32_bf16 v[108:111], a[216:219], a[8:11], v[108:111]
 ds_read_b64_tr_b16 a[208:209], v30 offset:16896
 ds_read_b128 a[28:31], v16 offset:6592
 v_mfma_f32_16x16x32_bf16 v[112:115], a[216:219], a[12:15], v[112:115]
 ds_read_b64_tr_b16 a[210:211], v30 offset:21120
 global_load_lds_dwordx4 v9, s[86:87] offset:1088
 v_mfma_f32_16x16x32_bf16 v[116:119], a[220:223], a[8:11], v[116:119]
 ds_read_b64_tr_b16 a[212:213], v30 offset:16928
 s_add_u32 s18, s20, s3
 s_addc_u32 s19, s21, 0
 v_mfma_f32_16x16x32_bf16 v[120:123], a[220:223], a[12:15], v[120:123]
 ds_read_b64_tr_b16 a[214:215], v30 offset:21152
 s_waitcnt lgkmcnt(5)
 v_mfma_f32_16x16x32_bf16 v[60:63], a[192:195], a[16:19], v[60:63]
 ds_read_b64_tr_b16 a[216:217], v31 offset:16896
 global_load_lds_dwordx4 v10, s[86:87] offset:2176
 v_mfma_f32_16x16x32_bf16 v[64:67], a[192:195], a[20:23], v[64:67]
 ds_read_b64_tr_b16 a[218:219], v31 offset:21120
 s_xor_b32 s3, s79, 0x60000
 v_mfma_f32_16x16x32_bf16 v[68:71], a[196:199], a[16:19], v[68:71]
 ds_read_b64_tr_b16 a[220:221], v31 offset:16928
 s_add_u32 s22, s20, s3
 s_addc_u32 s23, s21, 0
 v_mfma_f32_16x16x32_bf16 v[72:75], a[196:199], a[20:23], v[72:75]
 ds_read_b64_tr_b16 a[222:223], v31 offset:21152
 global_load_lds_dwordx4 v11, s[86:87] offset:3264
 v_mfma_f32_16x16x32_bf16 v[76:79], a[200:203], a[16:19], v[76:79]
 ds_read_b64_tr_b16 a[192:193], v28 offset:25344
 s_add_u32 m0, s63, 67584
 s_xor_b32 s66, s81, 0x180000
 v_mfma_f32_16x16x32_bf16 v[80:83], a[200:203], a[20:23], v[80:83]
 ds_read_b64_tr_b16 a[194:195], v28 offset:29568
 s_add_u32 s86, s16, s66
 s_addc_u32 s87, s17, 0
 v_mfma_f32_16x16x32_bf16 v[84:87], a[204:207], a[16:19], v[84:87]
 ds_read_b64_tr_b16 a[196:197], v28 offset:25376
 global_load_lds_dwordx4 v4, s[86:87] offset:0
 v_mfma_f32_16x16x32_bf16 v[88:91], a[204:207], a[20:23], v[88:91]
 ds_read_b64_tr_b16 a[198:199], v28 offset:29600
 s_xor_b32 s3, s79, 0x30000
 s_waitcnt lgkmcnt(4)
 v_mfma_f32_16x16x32_bf16 v[92:95], a[208:211], a[16:19], v[92:95]
 ds_read_b64_tr_b16 a[200:201], v29 offset:25344
 s_add_u32 s26, s20, s3
 s_addc_u32 s27, s21, 0
 v_mfma_f32_16x16x32_bf16 v[96:99], a[208:211], a[20:23], v[96:99]
 ds_read_b64_tr_b16 a[202:203], v29 offset:29568
 global_load_lds_dwordx4 v5, s[86:87] offset:1056
 v_mfma_f32_16x16x32_bf16 v[100:103], a[212:215], a[16:19], v[100:103]
 ds_read_b64_tr_b16 a[204:205], v29 offset:25376
 s_xor_b32 s3, s79, 0x20000
 v_mfma_f32_16x16x32_bf16 v[104:107], a[212:215], a[20:23], v[104:107]
 ds_read_b64_tr_b16 a[206:207], v29 offset:29600
 s_add_u32 s30, s20, s3
 s_addc_u32 s31, s21, 0
 v_mfma_f32_16x16x32_bf16 v[108:111], a[216:219], a[16:19], v[108:111]
 ds_read_b64_tr_b16 a[208:209], v30 offset:25344
 global_load_lds_dwordx4 v6, s[86:87] offset:2112
 v_mfma_f32_16x16x32_bf16 v[112:115], a[216:219], a[20:23], v[112:115]
 ds_read_b64_tr_b16 a[210:211], v30 offset:29568
 s_xor_b32 s3, s79, 0xd0000
 v_mfma_f32_16x16x32_bf16 v[116:119], a[220:223], a[16:19], v[116:119]
 ds_read_b64_tr_b16 a[212:213], v30 offset:25376
 s_add_u32 s36, s20, s3
 s_addc_u32 s37, s21, 0
 v_mfma_f32_16x16x32_bf16 v[120:123], a[220:223], a[20:23], v[120:123]
 ds_read_b64_tr_b16 a[214:215], v30 offset:29600
 s_waitcnt lgkmcnt(4)
 v_mfma_f32_16x16x32_bf16 v[60:63], a[192:195], a[24:27], v[60:63]
 ds_read_b64_tr_b16 a[216:217], v31 offset:25344
 s_xor_b32 s3, s79, 0xc0000
 v_mfma_f32_16x16x32_bf16 v[64:67], a[192:195], a[28:31], v[64:67]
 ds_read_b64_tr_b16 a[218:219], v31 offset:29568
 s_add_u32 s38, s20, s3
 s_addc_u32 s39, s21, 0
 v_mfma_f32_16x16x32_bf16 v[68:71], a[196:199], a[24:27], v[68:71]
 ds_read_b64_tr_b16 a[220:221], v31 offset:25376
 s_xor_b32 s3, s79, 0x90000
 v_mfma_f32_16x16x32_bf16 v[72:75], a[196:199], a[28:31], v[72:75]
 ds_read_b64_tr_b16 a[222:223], v31 offset:29600
 s_waitcnt vmcnt(11)
 s_barrier
 v_mfma_f32_16x16x32_bf16 v[76:79], a[200:203], a[24:27], v[76:79]
 ds_read_b64_tr_b16 a[192:193], v28 offset:33792
 s_add_u32 s40, s20, s3
 s_addc_u32 s41, s21, 0
 v_mfma_f32_16x16x32_bf16 v[80:83], a[200:203], a[28:31], v[80:83]
 ds_read_b64_tr_b16 a[194:195], v28 offset:38016
 s_xor_b32 s3, s79, 0x80000
 v_mfma_f32_16x16x32_bf16 v[84:87], a[204:207], a[24:27], v[84:87]
 ds_read_b64_tr_b16 a[196:197], v28 offset:33824
 s_add_u32 s42, s20, s3
 s_addc_u32 s43, s21, 0
 v_mfma_f32_16x16x32_bf16 v[88:91], a[204:207], a[28:31], v[88:91]
 ds_read_b64_tr_b16 a[198:199], v28 offset:38048
 s_waitcnt lgkmcnt(4)
 v_mfma_f32_16x16x32_bf16 v[92:95], a[208:211], a[24:27], v[92:95]
 ds_read_b64_tr_b16 a[200:201], v29 offset:33792
 global_load_lds_dwordx4 v7, s[86:87] offset:3168
 v_mfma_f32_16x16x32_bf16 v[96:99], a[208:211], a[28:31], v[96:99]
 ds_read_b64_tr_b16 a[202:203], v29 offset:38016
 s_xor_b32 s3, s79, 0x50000
 v_mfma_f32_16x16x32_bf16 v[100:103], a[212:215], a[24:27], v[100:103]
 ds_read_b64_tr_b16 a[204:205], v29 offset:33824
 s_add_u32 s44, s20, s3
 s_addc_u32 s45, s21, 0
 v_mfma_f32_16x16x32_bf16 v[104:107], a[212:215], a[28:31], v[104:107]
 ds_read_b64_tr_b16 a[206:207], v29 offset:38048
 s_xor_b32 s3, s79, 0x40000
 v_mfma_f32_16x16x32_bf16 v[108:111], a[216:219], a[24:27], v[108:111]
 ds_read_b64_tr_b16 a[208:209], v30 offset:33792
 s_add_u32 s46, s20, s3
 s_addc_u32 s47, s21, 0
 v_mfma_f32_16x16x32_bf16 v[112:115], a[216:219], a[28:31], v[112:115]
 ds_read_b64_tr_b16 a[210:211], v30 offset:38016
 s_add_u32 m0, s64, 4352
 s_xor_b32 s66, s80, 0x180
 v_mfma_f32_16x16x32_bf16 v[116:119], a[220:223], a[24:27], v[116:119]
 ds_read_b64_tr_b16 a[212:213], v30 offset:33824
 s_add_u32 s86, s4, s66
 s_addc_u32 s87, s5, 0
 v_mfma_f32_16x16x32_bf16 v[120:123], a[220:223], a[28:31], v[120:123]
 ds_read_b64_tr_b16 a[214:215], v30 offset:38048
 global_load_lds_dwordx4 v8, s[86:87] offset:0
 s_waitcnt lgkmcnt(4)
 v_mfma_f32_16x16x32_bf16 v[124:127], a[192:195], a[0:3], 0
 ds_read_b64_tr_b16 a[216:217], v31 offset:33792
 s_xor_b32 s3, s79, 0x10000
 v_mfma_f32_16x16x32_bf16 v[128:131], a[192:195], a[4:7], 0
 ds_read_b64_tr_b16 a[218:219], v31 offset:38016
 s_add_u32 s48, s20, s3
 s_addc_u32 s49, s21, 0
 v_mfma_f32_16x16x32_bf16 v[132:135], a[196:199], a[0:3], 0
 ds_read_b64_tr_b16 a[220:221], v31 offset:33824
 s_xor_b32 s3, s69, 0xf000
 v_mfma_f32_16x16x32_bf16 v[136:139], a[196:199], a[4:7], 0
 ds_read_b64_tr_b16 a[222:223], v31 offset:38048
 global_load_lds_dwordx4 v9, s[86:87] offset:1088
 v_mfma_f32_16x16x32_bf16 v[140:143], a[200:203], a[0:3], 0
 ds_read_b64_tr_b16 a[192:193], v28 offset:42240
 s_add_u32 s50, s12, s3
 s_addc_u32 s51, s13, 0
 v_mfma_f32_16x16x32_bf16 v[144:147], a[200:203], a[4:7], 0
 ds_read_b64_tr_b16 a[194:195], v28 offset:46464
 s_xor_b32 s3, s69, 0xb000
 v_mfma_f32_16x16x32_bf16 v[148:151], a[204:207], a[0:3], 0
 ds_read_b64_tr_b16 a[196:197], v28 offset:42272
 s_add_u32 s52, s12, s3
 s_addc_u32 s53, s13, 0
 v_mfma_f32_16x16x32_bf16 v[152:155], a[204:207], a[4:7], 0
 ds_read_b64_tr_b16 a[198:199], v28 offset:46496
 s_waitcnt lgkmcnt(4)
 v_mfma_f32_16x16x32_bf16 v[156:159], a[208:211], a[0:3], 0
 ds_read_b64_tr_b16 a[200:201], v29 offset:42240
 global_load_lds_dwordx4 v10, s[86:87] offset:2176
 v_mfma_f32_16x16x32_bf16 v[160:163], a[208:211], a[4:7], 0
 ds_read_b64_tr_b16 a[202:203], v29 offset:46464
 s_xor_b32 s3, s69, 0x7000
 v_mfma_f32_16x16x32_bf16 v[164:167], a[212:215], a[0:3], 0
 ds_read_b64_tr_b16 a[204:205], v29 offset:42272
 s_add_u32 s54, s12, s3
 s_addc_u32 s55, s13, 0
 v_mfma_f32_16x16x32_bf16 v[168:171], a[212:215], a[4:7], 0
 ds_read_b64_tr_b16 a[206:207], v29 offset:46496
 s_xor_b32 s3, s69, 0x3000
L_hop0_0_0:
L_pad0_297:
 s_cbranch_execz L_ret0_0
 v_mfma_f32_16x16x32_bf16 v[172:175], a[216:219], a[0:3], 0
 ds_read_b64_tr_b16 a[208:209], v30 offset:42240
 s_add_u32 s56, s12, s3
 s_addc_u32 s57, s13, 0
 v_mfma_f32_16x16x32_bf16 v[176:179], a[216:219], a[4:7], 0
 ds_read_b64_tr_b16 a[210:211], v30 offset:46464
 s_xor_b32 s3, s69, 0xd000
 v_mfma_f32_16x16x32_bf16 v[180:183], a[220:223], a[0:3], 0
 ds_read_b64_tr_b16 a[212:213], v30 offset:42272
 global_load_lds_dwordx4 v11, s[86:87] offset:3264
 v_mfma_f32_16x16x32_bf16 v[184:187], a[220:223], a[4:7], 0
 ds_read_b64_tr_b16 a[214:215], v30 offset:46496
 s_waitcnt lgkmcnt(4)
 v_mfma_f32_16x16x32_bf16 v[124:127], a[192:195], a[8:11], v[124:127]
 ds_read_b64_tr_b16 a[216:217], v31 offset:42240
 s_add_u32 s58, s12, s3
 s_addc_u32 s59, s13, 0
 v_mfma_f32_16x16x32_bf16 v[128:131], a[192:195], a[12:15], v[128:131]
 ds_read_b64_tr_b16 a[218:219], v31 offset:46464
 s_xor_b32 s3, s69, 0x9000
 v_mfma_f32_16x16x32_bf16 v[132:135], a[196:199], a[8:11], v[132:135]
 ds_read_b64_tr_b16 a[220:221], v31 offset:42272
 s_add_u32 s60, s12, s3
 s_addc_u32 s61, s13, 0
 v_mfma_f32_16x16x32_bf16 v[136:139], a[196:199], a[12:15], v[136:139]
 ds_read_b64_tr_b16 a[222:223], v31 offset:46496
 s_waitcnt vmcnt(4)
 s_barrier
 v_mfma_f32_16x16x32_bf16 v[140:143], a[200:203], a[8:11], v[140:143]
 ds_read_b64_tr_b16 a[192:193], v32 offset:0
 s_add_u32 m0, s63, 0
 s_xor_b32 s66, s71, 0x200000
 v_mfma_f32_16x16x32_bf16 v[144:147], a[200:203], a[12:15], v[144:147]
 ds_read_b64_tr_b16 a[194:195], v32 offset:4224
 s_add_u32 s86, s16, s66
 s_addc_u32 s87, s17, 0
 v_mfma_f32_16x16x32_bf16 v[148:151], a[204:207], a[8:11], v[148:151]
 ds_read_b64_tr_b16 a[196:197], v32 offset:32
 global_load_lds_dwordx4 v4, s[86:87] offset:0
 ds_read_b128 a[32:35], v16 offset:0
 v_mfma_f32_16x16x32_bf16 v[152:155], a[204:207], a[12:15], v[152:155]
 ds_read_b64_tr_b16 a[198:199], v32 offset:4256
 s_waitcnt lgkmcnt(5)
 v_mfma_f32_16x16x32_bf16 v[156:159], a[208:211], a[8:11], v[156:159]
 ds_read_b64_tr_b16 a[200:201], v33 offset:0
 ds_read_b128 a[36:39], v16 offset:2176
 v_mfma_f32_16x16x32_bf16 v[160:163], a[208:211], a[12:15], v[160:163]
 ds_read_b64_tr_b16 a[202:203], v33 offset:4224
 global_load_lds_dwordx4 v5, s[86:87] offset:1056
 v_mfma_f32_16x16x32_bf16 v[164:167], a[212:215], a[8:11], v[164:167]
 ds_read_b64_tr_b16 a[204:205], v33 offset:32
 ds_read_b128 a[40:43], v16 offset:64
 v_mfma_f32_16x16x32_bf16 v[168:171], a[212:215], a[12:15], v[168:171]
 ds_read_b64_tr_b16 a[206:207], v33 offset:4256
 ds_read_b128 a[44:47], v16 offset:2240
 v_mfma_f32_16x16x32_bf16 v[172:175], a[216:219], a[8:11], v[172:175]
 ds_read_b64_tr_b16 a[208:209], v34 offset:0
 global_load_lds_dwordx4 v6, s[86:87] offset:2112
 v_mfma_f32_16x16x32_bf16 v[176:179], a[216:219], a[12:15], v[176:179]
 ds_read_b64_tr_b16 a[210:211], v34 offset:4224
 s_xor_b32 s3, s69, 0x5000
 v_mfma_f32_16x16x32_bf16 v[180:183], a[220:223], a[8:11], v[180:183]
 ds_read_b64_tr_b16 a[212:213], v34 offset:32
 s_add_u32 s88, s12, s3
 s_addc_u32 s89, s13, 0
 v_mfma_f32_16x16x32_bf16 v[184:187], a[220:223], a[12:15], v[184:187]
 ds_read_b64_tr_b16 a[214:215], v34 offset:4256
 global_load_lds_dwordx4 v7, s[86:87] offset:3168
 s_waitcnt lgkmcnt(5)
 v_mfma_f32_16x16x32_bf16 v[60:63], a[192:195], a[32:35], v[60:63]
 ds_read_b64_tr_b16 a[216:217], v35 offset:0
 s_waitcnt lgkmcnt(5)
 s_add_u32 m0, s64, 0
 s_xor_b32 s66, s70, 0x200
 v_mfma_f32_16x16x32_bf16 v[64:67], a[192:195], a[36:39], v[64:67]
 ds_read_b64_tr_b16 a[218:219], v35 offset:4224
 s_add_u32 s86, s4, s66
 s_addc_u32 s87, s5, 0
 v_mfma_f32_16x16x32_bf16 v[68:71], a[196:199], a[32:35], v[68:71]
 ds_read_b64_tr_b16 a[220:221], v35 offset:32
 global_load_lds_dwordx4 v8, s[86:87] offset:0
 v_mfma_f32_16x16x32_bf16 v[72:75], a[196:199], a[36:39], v[72:75]
 ds_read_b64_tr_b16 a[222:223], v35 offset:4256
 s_xor_b32 s3, s69, 0x3000
 v_mfma_f32_16x16x32_bf16 v[76:79], a[200:203], a[32:35], v[76:79]
 ds_read_b64_tr_b16 a[192:193], v32 offset:8448
 s_add_u32 s90, s8, s3
 s_addc_u32 s91, s9, 0
 v_mfma_f32_16x16x32_bf16 v[80:83], a[200:203], a[36:39], v[80:83]
 ds_read_b64_tr_b16 a[194:195], v32 offset:12672
 global_load_lds_dwordx4 v9, s[86:87] offset:1088
 v_mfma_f32_16x16x32_bf16 v[84:87], a[204:207], a[32:35], v[84:87]
 ds_read_b64_tr_b16 a[196:197], v32 offset:8480
 s_xor_b32 s3, s71, 0x380100
 v_mfma_f32_16x16x32_bf16 v[88:91], a[204:207], a[36:39], v[88:91]
 ds_read_b64_tr_b16 a[198:199], v32 offset:12704
 s_waitcnt lgkmcnt(4)
 v_mfma_f32_16x16x32_bf16 v[92:95], a[208:211], a[32:35], v[92:95]
 ds_read_b64_tr_b16 a[200:201], v33 offset:8448
 global_load_lds_dwordx4 v10, s[86:87] offset:2176
 v_mfma_f32_16x16x32_bf16 v[96:99], a[208:211], a[36:39], v[96:99]
 ds_read_b64_tr_b16 a[202:203], v33 offset:12672
 s_add_u32 s92, s16, s3
 s_addc_u32 s93, s17, 0
 v_mfma_f32_16x16x32_bf16 v[100:103], a[212:215], a[32:35], v[100:103]
 ds_read_b64_tr_b16 a[204:205], v33 offset:8480
 s_xor_b32 s3, s71, 0x300100
 v_mfma_f32_16x16x32_bf16 v[104:107], a[212:215], a[36:39], v[104:107]
 ds_read_b64_tr_b16 a[206:207], v33 offset:12704
 global_load_lds_dwordx4 v11, s[86:87] offset:3264
 v_mfma_f32_16x16x32_bf16 v[108:111], a[216:219], a[32:35], v[108:111]
 ds_read_b64_tr_b16 a[208:209], v34 offset:8448
 s_add_u32 m0, s63, 16896
 s_xor_b32 s66, s71, 0x280000
 v_mfma_f32_16x16x32_bf16 v[112:115], a[216:219], a[36:39], v[112:115]
 ds_read_b64_tr_b16 a[210:211], v34 offset:12672
 s_add_u32 s86, s16, s66
 s_addc_u32 s87, s17, 0
 v_mfma_f32_16x16x32_bf16 v[116:119], a[220:223], a[32:35], v[116:119]
 ds_read_b64_tr_b16 a[212:213], v34 offset:8480
 global_load_lds_dwordx4 v4, s[86:87] offset:0
 v_mfma_f32_16x16x32_bf16 v[120:123], a[220:223], a[36:39], v[120:123]
 ds_read_b64_tr_b16 a[214:215], v34 offset:12704
 s_waitcnt lgkmcnt(4)
 v_mfma_f32_16x16x32_bf16 v[60:63], a[192:195], a[40:43], v[60:63]
 ds_read_b64_tr_b16 a[216:217], v35 offset:8448
 s_add_u32 s94, s16, s3
 s_addc_u32 s95, s17, 0
 v_mfma_f32_16x16x32_bf16 v[64:67], a[192:195], a[44:47], v[64:67]
 ds_read_b64_tr_b16 a[218:219], v35 offset:12672
 global_load_lds_dwordx4 v5, s[86:87] offset:1056
 v_mfma_f32_16x16x32_bf16 v[68:71], a[196:199], a[40:43], v[68:71]
 ds_read_b64_tr_b16 a[220:221], v35 offset:8480
 s_xor_b32 s3, s71, 0x280100
 v_mfma_f32_16x16x32_bf16 v[72:75], a[196:199], a[44:47], v[72:75]
 ds_read_b64_tr_b16 a[222:223], v35 offset:12704
 s_add_u32 s96, s16, s3
 s_addc_u32 s97, s17, 0
 v_mfma_f32_16x16x32_bf16 v[76:79], a[200:203], a[40:43], v[76:79]
 ds_read_b64_tr_b16 a[192:193], v32 offset:16896
 global_load_lds_dwordx4 v6, s[86:87] offset:2112
 v_mfma_f32_16x16x32_bf16 v[80:83], a[200:203], a[44:47], v[80:83]
 ds_read_b64_tr_b16 a[194:195], v32 offset:21120
 s_waitcnt vmcnt(11)
 ds_read_b128 a[48:51], v16 offset:4352
 v_mfma_f32_16x16x32_bf16 v[84:87], a[204:207], a[40:43], v[84:87]
 ds_read_b64_tr_b16 a[196:197], v32 offset:16928
 ds_read_b128 a[52:55], v16 offset:6528
 v_mfma_f32_16x16x32_bf16 v[88:91], a[204:207], a[44:47], v[88:91]
 ds_read_b64_tr_b16 a[198:199], v32 offset:21152
 s_waitcnt lgkmcnt(6)
 v_mfma_f32_16x16x32_bf16 v[92:95], a[208:211], a[40:43], v[92:95]
 ds_read_b64_tr_b16 a[200:201], v33 offset:16896
 ds_read_b128 a[56:59], v16 offset:4416
 v_mfma_f32_16x16x32_bf16 v[96:99], a[208:211], a[44:47], v[96:99]
 ds_read_b64_tr_b16 a[202:203], v33 offset:21120
 ds_read_b128 a[60:63], v16 offset:6592
 v_mfma_f32_16x16x32_bf16 v[100:103], a[212:215], a[40:43], v[100:103]
 ds_read_b64_tr_b16 a[204:205], v33 offset:16928
 s_xor_b32 s3, s71, 0x200100
 v_mfma_f32_16x16x32_bf16 v[104:107], a[212:215], a[44:47], v[104:107]
 ds_read_b64_tr_b16 a[206:207], v33 offset:21152
 s_add_u32 s98, s16, s3
 s_addc_u32 s99, s17, 0
 v_mfma_f32_16x16x32_bf16 v[108:111], a[216:219], a[40:43], v[108:111]
 ds_read_b64_tr_b16 a[208:209], v34 offset:16896
 s_xor_b32 s3, s81, 0x180100
 v_mfma_f32_16x16x32_bf16 v[112:115], a[216:219], a[44:47], v[112:115]
 ds_read_b64_tr_b16 a[210:211], v34 offset:21120
 s_add_u32 s100, s16, s3
 s_addc_u32 s101, s17, 0
 v_mfma_f32_16x16x32_bf16 v[116:119], a[220:223], a[40:43], v[116:119]
 ds_read_b64_tr_b16 a[212:213], v34 offset:16928
 s_add_u32 s20, s20, s79
 s_addc_u32 s21, s21, 0
 v_mfma_f32_16x16x32_bf16 v[120:123], a[220:223], a[44:47], v[120:123]
 ds_read_b64_tr_b16 a[214:215], v34 offset:21152
 s_waitcnt lgkmcnt(4)
 v_mfma_f32_16x16x32_bf16 v[60:63], a[192:195], a[48:51], v[60:63]
 ds_read_b64_tr_b16 a[216:217], v35 offset:16896
 s_xor_b32 s3, s69, 0x1000
 v_mfma_f32_16x16x32_bf16 v[64:67], a[192:195], a[52:55], v[64:67]
 ds_read_b64_tr_b16 a[218:219], v35 offset:21120
 s_add_u32 s12, s12, s3
 s_addc_u32 s13, s13, 0
 v_mfma_f32_16x16x32_bf16 v[68:71], a[196:199], a[48:51], v[68:71]
 ds_read_b64_tr_b16 a[220:221], v35 offset:16928
 v_mfma_f32_16x16x32_bf16 v[72:75], a[196:199], a[52:55], v[72:75]
 ds_read_b64_tr_b16 a[222:223], v35 offset:21152
 v_mfma_f32_16x16x32_bf16 v[76:79], a[200:203], a[48:51], v[76:79]
 ds_read_b64_tr_b16 a[192:193], v32 offset:25344
 v_mfma_f32_16x16x32_bf16 v[80:83], a[200:203], a[52:55], v[80:83]
 ds_read_b64_tr_b16 a[194:195], v32 offset:29568
 v_mfma_f32_16x16x32_bf16 v[84:87], a[204:207], a[48:51], v[84:87]
 ds_read_b64_tr_b16 a[196:197], v32 offset:25376
 global_load_lds_dwordx4 v7, s[86:87] offset:3168
 v_mfma_f32_16x16x32_bf16 v[88:91], a[204:207], a[52:55], v[88:91]
 ds_read_b64_tr_b16 a[198:199], v32 offset:29600
 s_add_u32 m0, s64, 4352
 s_xor_b32 s66, s70, 0x280
 s_waitcnt lgkmcnt(4)
 v_mfma_f32_16x16x32_bf16 v[92:95], a[208:211], a[48:51], v[92:95]
 ds_read_b64_tr_b16 a[200:201], v33 offset:25344
 s_add_u32 s86, s4, s66
 s_addc_u32 s87, s5, 0
 v_mfma_f32_16x16x32_bf16 v[96:99], a[208:211], a[52:55], v[96:99]
 ds_read_b64_tr_b16 a[202:203], v33 offset:29568
 v_mfma_f32_16x16x32_bf16 v[100:103], a[212:215], a[48:51], v[100:103]
 ds_read_b64_tr_b16 a[204:205], v33 offset:25376
 v_mfma_f32_16x16x32_bf16 v[104:107], a[212:215], a[52:55], v[104:107]
 ds_read_b64_tr_b16 a[206:207], v33 offset:29600
 global_load_lds_dwordx4 v8, s[86:87] offset:0
 v_mfma_f32_16x16x32_bf16 v[108:111], a[216:219], a[48:51], v[108:111]
 ds_read_b64_tr_b16 a[208:209], v34 offset:25344
 v_mfma_f32_16x16x32_bf16 v[112:115], a[216:219], a[52:55], v[112:115]
 ds_read_b64_tr_b16 a[210:211], v34 offset:29568
 v_mfma_f32_16x16x32_bf16 v[116:119], a[220:223], a[48:51], v[116:119]
 ds_read_b64_tr_b16 a[212:213], v34 offset:25376
 v_mfma_f32_16x16x32_bf16 v[120:123], a[220:223], a[52:55], v[120:123]
 ds_read_b64_tr_b16 a[214:215], v34 offset:29600
 s_waitcnt lgkmcnt(4)
 v_mfma_f32_16x16x32_bf16 v[60:63], a[192:195], a[56:59], v[60:63]
 ds_read_b64_tr_b16 a[216:217], v35 offset:25344
 v_mfma_f32_16x16x32_bf16 v[64:67], a[192:195], a[60:63], v[64:67]
 ds_read_b64_tr_b16 a[218:219], v35 offset:29568
 global_load_lds_dwordx4 v9, s[86:87] offset:1088
 v_mfma_f32_16x16x32_bf16 v[68:71], a[196:199], a[56:59], v[68:71]
 ds_read_b64_tr_b16 a[220:221], v35 offset:25376
 v_mfma_f32_16x16x32_bf16 v[72:75], a[196:199], a[60:63], v[72:75]
 ds_read_b64_tr_b16 a[222:223], v35 offset:29600
 s_mov_b64 exec, 0
 s_cmp_eq_u32 s62, 0
 s_cbranch_scc1 L_hop0_1_0
 s_cmp_eq_u32 s62, 1
 s_cbranch_scc1 L_hop0_1_1
 s_cmp_eq_u32 s62, 2
 s_cbranch_scc1 L_hop0_1_2
 s_branch L_hop0_1_3
L_ret0_1:
 s_mov_b64 exec, -1
 s_waitcnt vmcnt(10)
 s_barrier
 v_mfma_f32_16x16x32_bf16 v[76:79], a[200:203], a[56:59], v[76:79]
 ds_read_b64_tr_b16 a[192:193], v28 offset:0
 global_load_lds_dwordx4 v10, s[86:87] offset:2176
 v_mfma_f32_16x16x32_bf16 v[80:83], a[200:203], a[60:63], v[80:83]
 ds_read_b64_tr_b16 a[194:195], v28 offset:4224
 v_mfma_f32_16x16x32_bf16 v[84:87], a[204:207], a[56:59], v[84:87]
 ds_read_b64_tr_b16 a[196:197], v28 offset:32
 v_mfma_f32_16x16x32_bf16 v[88:91], a[204:207], a[60:63], v[88:91]
 ds_read_b64_tr_b16 a[198:199], v28 offset:4256
 s_waitcnt lgkmcnt(4)
 v_mfma_f32_16x16x32_bf16 v[92:95], a[208:211], a[56:59], v[92:95]
 ds_read_b64_tr_b16 a[200:201], v29 offset:0
 v_mfma_f32_16x16x32_bf16 v[96:99], a[208:211], a[60:63], v[96:99]
 ds_read_b64_tr_b16 a[202:203], v29 offset:4224
 s_waitcnt vmcnt(7)
 ds_read_b128 a[64:67], v16 offset:0
 global_load_lds_dwordx4 v11, s[86:87] offset:3264
 v_mfma_f32_16x16x32_bf16 v[100:103], a[212:215], a[56:59], v[100:103]
 ds_read_b64_tr_b16 a[204:205], v29 offset:32
 s_add_u32 m0, s63, 33792
 s_xor_b32 s66, s71, 0x300000
 ds_read_b128 a[68:71], v16 offset:2176
 v_mfma_f32_16x16x32_bf16 v[104:107], a[212:215], a[60:63], v[104:107]
 ds_read_b64_tr_b16 a[206:207], v29 offset:4256
 s_add_u32 s86, s16, s66
 s_addc_u32 s87, s17, 0
 ds_read_b128 a[72:75], v16 offset:64
 v_mfma_f32_16x16x32_bf16 v[108:111], a[216:219], a[56:59], v[108:111]
 ds_read_b64_tr_b16 a[208:209], v30 offset:0
 global_load_lds_dwordx4 v4, s[86:87] offset:0
 ds_read_b128 a[76:79], v16 offset:2240
 v_mfma_f32_16x16x32_bf16 v[112:115], a[216:219], a[60:63], v[112:115]
 ds_read_b64_tr_b16 a[210:211], v30 offset:4224
 v_mfma_f32_16x16x32_bf16 v[116:119], a[220:223], a[56:59], v[116:119]
 ds_read_b64_tr_b16 a[212:213], v30 offset:32
 v_mfma_f32_16x16x32_bf16 v[120:123], a[220:223], a[60:63], v[120:123]
 ds_read_b64_tr_b16 a[214:215], v30 offset:4256
 global_load_lds_dwordx4 v5, s[86:87] offset:1056
 s_waitcnt lgkmcnt(6)
 v_mfma_f32_16x16x32_bf16 v[60:63], a[192:195], a[64:67], v[60:63]
 ds_read_b64_tr_b16 a[216:217], v31 offset:0
 v_mfma_f32_16x16x32_bf16 v[64:67], a[192:195], a[68:71], v[64:67]
 ds_read_b64_tr_b16 a[218:219], v31 offset:4224
 v_mfma_f32_16x16x32_bf16 v[68:71], a[196:199], a[64:67], v[68:71]
 ds_read_b64_tr_b16 a[220:221], v31 offset:32
 global_load_lds_dwordx4 v6, s[86:87] offset:2112
L_hop0_0_1:
L_pad0_585:
 s_cbranch_execz L_ret0_0
 v_mfma_f32_16x16x32_bf16 v[72:75], a[196:199], a[68:71], v[72:75]
 ds_read_b64_tr_b16 a[222:223], v31 offset:4256
 v_mfma_f32_16x16x32_bf16 v[76:79], a[200:203], a[64:67], v[76:79]
 ds_read_b64_tr_b16 a[192:193], v28 offset:8448
 v_mfma_f32_16x16x32_bf16 v[80:83], a[200:203], a[68:71], v[80:83]
 ds_read_b64_tr_b16 a[194:195], v28 offset:12672
 global_load_lds_dwordx4 v7, s[86:87] offset:3168
 v_mfma_f32_16x16x32_bf16 v[84:87], a[204:207], a[64:67], v[84:87]
 ds_read_b64_tr_b16 a[196:197], v28 offset:8480
 s_waitcnt lgkmcnt(10)
 s_add_u32 m0, s64, 0
 s_xor_b32 s66, s70, 0x300
 v_mfma_f32_16x16x32_bf16 v[88:91], a[204:207], a[68:71], v[88:91]
 ds_read_b64_tr_b16 a[198:199], v28 offset:12704
 s_add_u32 s86, s4, s66
 s_addc_u32 s87, s5, 0
 s_waitcnt lgkmcnt(4)
 v_mfma_f32_16x16x32_bf16 v[92:95], a[208:211], a[64:67], v[92:95]
 ds_read_b64_tr_b16 a[200:201], v29 offset:8448
 global_load_dword v43, v45, s[28:29] sc1
 v_mfma_f32_16x16x32_bf16 v[96:99], a[208:211], a[68:71], v[96:99]
 ds_read_b64_tr_b16 a[202:203], v29 offset:12672
 v_mfma_f32_16x16x32_bf16 v[100:103], a[212:215], a[64:67], v[100:103]
 ds_read_b64_tr_b16 a[204:205], v29 offset:8480
 v_mfma_f32_16x16x32_bf16 v[104:107], a[212:215], a[68:71], v[104:107]
 ds_read_b64_tr_b16 a[206:207], v29 offset:12704
 global_load_lds_dwordx4 v8, s[86:87] offset:0
 v_mfma_f32_16x16x32_bf16 v[108:111], a[216:219], a[64:67], v[108:111]
 ds_read_b64_tr_b16 a[208:209], v30 offset:8448
 v_mfma_f32_16x16x32_bf16 v[112:115], a[216:219], a[68:71], v[112:115]
 ds_read_b64_tr_b16 a[210:211], v30 offset:12672
 v_mfma_f32_16x16x32_bf16 v[116:119], a[220:223], a[64:67], v[116:119]
 ds_read_b64_tr_b16 a[212:213], v30 offset:8480
 global_load_lds_dwordx4 v9, s[86:87] offset:1088
 v_mfma_f32_16x16x32_bf16 v[120:123], a[220:223], a[68:71], v[120:123]
 ds_read_b64_tr_b16 a[214:215], v30 offset:12704
 s_waitcnt lgkmcnt(4)
 v_mfma_f32_16x16x32_bf16 v[60:63], a[192:195], a[72:75], v[60:63]
 ds_read_b64_tr_b16 a[216:217], v31 offset:8448
 v_mfma_f32_16x16x32_bf16 v[64:67], a[192:195], a[76:79], v[64:67]
 ds_read_b64_tr_b16 a[218:219], v31 offset:12672
 global_load_lds_dwordx4 v10, s[86:87] offset:2176
 v_mfma_f32_16x16x32_bf16 v[68:71], a[196:199], a[72:75], v[68:71]
 ds_read_b64_tr_b16 a[220:221], v31 offset:8480
 v_mfma_f32_16x16x32_bf16 v[72:75], a[196:199], a[76:79], v[72:75]
 ds_read_b64_tr_b16 a[222:223], v31 offset:12704
 s_waitcnt vmcnt(12)
 s_barrier
 v_mfma_f32_16x16x32_bf16 v[76:79], a[200:203], a[72:75], v[76:79]
 ds_read_b64_tr_b16 a[192:193], v28 offset:16896
 global_load_lds_dwordx4 v11, s[86:87] offset:3264
 v_mfma_f32_16x16x32_bf16 v[80:83], a[200:203], a[76:79], v[80:83]
 ds_read_b64_tr_b16 a[194:195], v28 offset:21120
 s_add_u32 m0, s64, 12800
 s_xor_b32 s66, s69, 0x1000
 v_mfma_f32_16x16x32_bf16 v[84:87], a[204:207], a[72:75], v[84:87]
 ds_read_b64_tr_b16 a[196:197], v28 offset:16928
 s_add_u32 s86, s8, s66
 s_addc_u32 s87, s9, 0
 v_mfma_f32_16x16x32_bf16 v[88:91], a[204:207], a[76:79], v[88:91]
 ds_read_b64_tr_b16 a[198:199], v28 offset:21152
 global_load_lds_dwordx4 v17, s[86:87] offset:-4096 nt
 s_waitcnt lgkmcnt(4)
 v_mfma_f32_16x16x32_bf16 v[92:95], a[208:211], a[72:75], v[92:95]
 ds_read_b64_tr_b16 a[200:201], v29 offset:16896
 s_add_u32 m0, s64, 12864
 v_mfma_f32_16x16x32_bf16 v[96:99], a[208:211], a[76:79], v[96:99]
 ds_read_b64_tr_b16 a[202:203], v29 offset:21120
 s_waitcnt vmcnt(10)
 ds_read_b128 a[80:83], v16 offset:4352
 v_mfma_f32_16x16x32_bf16 v[100:103], a[212:215], a[72:75], v[100:103]
 ds_read_b64_tr_b16 a[204:205], v29 offset:16928
 global_load_lds_dwordx4 v17, s[86:87] offset:-3072 nt
 ds_read_b128 a[84:87], v16 offset:6528
 v_mfma_f32_16x16x32_bf16 v[104:107], a[212:215], a[76:79], v[104:107]
 ds_read_b64_tr_b16 a[206:207], v29 offset:21152
 s_add_u32 m0, s64, 12928
 ds_read_b128 a[88:91], v16 offset:4416
 v_mfma_f32_16x16x32_bf16 v[108:111], a[216:219], a[72:75], v[108:111]
 ds_read_b64_tr_b16 a[208:209], v30 offset:16896
 ds_read_b128 a[92:95], v16 offset:6592
 v_mfma_f32_16x16x32_bf16 v[112:115], a[216:219], a[76:79], v[112:115]
 ds_read_b64_tr_b16 a[210:211], v30 offset:21120
 global_load_lds_dwordx4 v17, s[86:87] offset:-2048 nt
 v_mfma_f32_16x16x32_bf16 v[116:119], a[220:223], a[72:75], v[116:119]
 ds_read_b64_tr_b16 a[212:213], v30 offset:16928
 s_add_u32 m0, s64, 12992
 v_mfma_f32_16x16x32_bf16 v[120:123], a[220:223], a[76:79], v[120:123]
 ds_read_b64_tr_b16 a[214:215], v30 offset:21152
 s_waitcnt lgkmcnt(6)
 v_mfma_f32_16x16x32_bf16 v[60:63], a[192:195], a[80:83], v[60:63]
 ds_read_b64_tr_b16 a[216:217], v31 offset:16896
 global_load_lds_dwordx4 v17, s[86:87] offset:-1024 nt
 v_mfma_f32_16x16x32_bf16 v[64:67], a[192:195], a[84:87], v[64:67]
 ds_read_b64_tr_b16 a[218:219], v31 offset:21120
 s_add_u32 m0, s64, 13056
 v_mfma_f32_16x16x32_bf16 v[68:71], a[196:199], a[80:83], v[68:71]
 ds_read_b64_tr_b16 a[220:221], v31 offset:16928
 v_mfma_f32_16x16x32_bf16 v[72:75], a[196:199], a[84:87], v[72:75]
 ds_read_b64_tr_b16 a[222:223], v31 offset:21152
 global_load_lds_dwordx4 v17, s[86:87] offset:0 nt
 v_mfma_f32_16x16x32_bf16 v[76:79], a[200:203], a[80:83], v[76:79]
 ds_read_b64_tr_b16 a[192:193], v28 offset:25344
 s_add_u32 m0, s64, 13120
 v_mfma_f32_16x16x32_bf16 v[80:83], a[200:203], a[84:87], v[80:83]
 ds_read_b64_tr_b16 a[194:195], v28 offset:29568
 v_mfma_f32_16x16x32_bf16 v[84:87], a[204:207], a[80:83], v[84:87]
 ds_read_b64_tr_b16 a[196:197], v28 offset:25376
 global_load_lds_dwordx4 v17, s[86:87] offset:1024 nt
 v_mfma_f32_16x16x32_bf16 v[88:91], a[204:207], a[84:87], v[88:91]
 ds_read_b64_tr_b16 a[198:199], v28 offset:29600
 s_add_u32 m0, s64, 13184
 s_waitcnt lgkmcnt(4)
 v_mfma_f32_16x16x32_bf16 v[92:95], a[208:211], a[80:83], v[92:95]
 ds_read_b64_tr_b16 a[200:201], v29 offset:25344
 v_mfma_f32_16x16x32_bf16 v[96:99], a[208:211], a[84:87], v[96:99]
 ds_read_b64_tr_b16 a[202:203], v29 offset:29568
 v_mfma_f32_16x16x32_bf16 v[100:103], a[212:215], a[80:83], v[100:103]
 ds_read_b64_tr_b16 a[204:205], v29 offset:25376
 v_mfma_f32_16x16x32_bf16 v[104:107], a[212:215], a[84:87], v[104:107]
 ds_read_b64_tr_b16 a[206:207], v29 offset:29600
 v_mfma_f32_16x16x32_bf16 v[108:111], a[216:219], a[80:83], v[108:111]
 ds_read_b64_tr_b16 a[208:209], v30 offset:25344
 v_mfma_f32_16x16x32_bf16 v[112:115], a[216:219], a[84:87], v[112:115]
 ds_read_b64_tr_b16 a[210:211], v30 offset:29568
 v_mfma_f32_16x16x32_bf16 v[116:119], a[220:223], a[80:83], v[116:119]
 ds_read_b64_tr_b16 a[212:213], v30 offset:25376
 v_mfma_f32_16x16x32_bf16 v[120:123], a[220:223], a[84:87], v[120:123]
 ds_read_b64_tr_b16 a[214:215], v30 offset:29600
 s_waitcnt lgkmcnt(4)
 v_mfma_f32_16x16x32_bf16 v[60:63], a[192:195], a[88:91], v[60:63]
 ds_read_b64_tr_b16 a[216:217], v31 offset:25344
 v_mfma_f32_16x16x32_bf16 v[64:67], a[192:195], a[92:95], v[64:67]
 ds_read_b64_tr_b16 a[218:219], v31 offset:29568
 v_mfma_f32_16x16x32_bf16 v[68:71], a[196:199], a[88:91], v[68:71]
 ds_read_b64_tr_b16 a[220:221], v31 offset:25376
 v_mfma_f32_16x16x32_bf16 v[72:75], a[196:199], a[92:95], v[72:75]
 ds_read_b64_tr_b16 a[222:223], v31 offset:29600
 s_waitcnt vmcnt(11)
 s_barrier
 v_mfma_f32_16x16x32_bf16 v[76:79], a[200:203], a[88:91], v[76:79]
 ds_read_b64_tr_b16 a[192:193], v28 offset:33792
 v_mfma_f32_16x16x32_bf16 v[80:83], a[200:203], a[92:95], v[80:83]
 ds_read_b64_tr_b16 a[194:195], v28 offset:38016
 v_mfma_f32_16x16x32_bf16 v[84:87], a[204:207], a[88:91], v[84:87]
 ds_read_b64_tr_b16 a[196:197], v28 offset:33824
 v_mfma_f32_16x16x32_bf16 v[88:91], a[204:207], a[92:95], v[88:91]
 ds_read_b64_tr_b16 a[198:199], v28 offset:38048
 s_waitcnt lgkmcnt(4)
 v_mfma_f32_16x16x32_bf16 v[92:95], a[208:211], a[88:91], v[92:95]
 ds_read_b64_tr_b16 a[200:201], v29 offset:33792
 v_mfma_f32_16x16x32_bf16 v[96:99], a[208:211], a[92:95], v[96:99]
 ds_read_b64_tr_b16 a[202:203], v29 offset:38016
 s_waitcnt vmcnt(6)
 ds_read_b128 a[96:99], v16 offset:0
 v_cmp_ne_u32 vcc, 1, v43
 s_cbranch_vccnz L_slow0i
L_back0i:
 v_mfma_f32_16x16x32_bf16 v[100:103], a[212:215], a[88:91], v[100:103]
 ds_read_b64_tr_b16 a[204:205], v29 offset:33824
 global_load_lds_dwordx4 v17, s[86:87] offset:2048 nt
 ds_read_b128 a[100:103], v16 offset:2176
 v_mfma_f32_16x16x32_bf16 v[104:107], a[212:215], a[92:95], v[104:107]
 ds_read_b64_tr_b16 a[206:207], v29 offset:38048
 s_add_u32 m0, s64, 13248
 ds_read_b128 a[104:107], v16 offset:64
 v_mfma_f32_16x16x32_bf16 v[108:111], a[216:219], a[88:91], v[108:111]
 ds_read_b64_tr_b16 a[208:209], v30 offset:33792
 ds_read_b128 a[108:111], v16 offset:2240
 v_mfma_f32_16x16x32_bf16 v[112:115], a[216:219], a[92:95], v[112:115]
 ds_read_b64_tr_b16 a[210:211], v30 offset:38016
 global_load_lds_dwordx4 v17, s[86:87] offset:3072 nt
 v_mfma_f32_16x16x32_bf16 v[116:119], a[220:223], a[88:91], v[116:119]
 ds_read_b64_tr_b16 a[212:213], v30 offset:33824
 s_add_u32 m0, s63, 50688
 s_xor_b32 s66, s71, 0x380000
 v_mfma_f32_16x16x32_bf16 v[120:123], a[220:223], a[92:95], v[120:123]
 ds_read_b64_tr_b16 a[214:215], v30 offset:38048
 s_add_u32 s86, s16, s66
 s_addc_u32 s87, s17, 0
 s_waitcnt lgkmcnt(6)
 v_mfma_f32_16x16x32_bf16 v[60:63], a[192:195], a[96:99], v[60:63]
 ds_read_b64_tr_b16 a[216:217], v31 offset:33792
 global_load_lds_dwordx4 v4, s[86:87] offset:0
 v_mfma_f32_16x16x32_bf16 v[64:67], a[192:195], a[100:103], v[64:67]
 ds_read_b64_tr_b16 a[218:219], v31 offset:38016
 v_mfma_f32_16x16x32_bf16 v[68:71], a[196:199], a[96:99], v[68:71]
 ds_read_b64_tr_b16 a[220:221], v31 offset:33824
 v_mfma_f32_16x16x32_bf16 v[72:75], a[196:199], a[100:103], v[72:75]
 ds_read_b64_tr_b16 a[222:223], v31 offset:38048
 global_load_lds_dwordx4 v5, s[86:87] offset:1056
 v_mfma_f32_16x16x32_bf16 v[76:79], a[200:203], a[96:99], v[76:79]
 ds_read_b64_tr_b16 a[192:193], v28 offset:42240
 v_mfma_f32_16x16x32_bf16 v[80:83], a[200:203], a[100:103], v[80:83]
 ds_read_b64_tr_b16 a[194:195], v28 offset:46464
 v_mfma_f32_16x16x32_bf16 v[84:87], a[204:207], a[96:99], v[84:87]
 ds_read_b64_tr_b16 a[196:197], v28 offset:42272
 global_load_lds_dwordx4 v6, s[86:87] offset:2112
 v_mfma_f32_16x16x32_bf16 v[88:91], a[204:207], a[100:103], v[88:91]
 ds_read_b64_tr_b16 a[198:199], v28 offset:46496
 s_waitcnt lgkmcnt(4)
 v_mfma_f32_16x16x32_bf16 v[92:95], a[208:211], a[96:99], v[92:95]
 ds_read_b64_tr_b16 a[200:201], v29 offset:42240
 v_mfma_f32_16x16x32_bf16 v[96:99], a[208:211], a[100:103], v[96:99]
 ds_read_b64_tr_b16 a[202:203], v29 offset:46464
 global_load_lds_dwordx4 v7, s[86:87] offset:3168
 v_mfma_f32_16x16x32_bf16 v[100:103], a[212:215], a[96:99], v[100:103]
 ds_read_b64_tr_b16 a[204:205], v29 offset:42272
 s_add_u32 m0, s64, 4352
 s_xor_b32 s66, s70, 0x380
 v_mfma_f32_16x16x32_bf16 v[104:107], a[212:215], a[100:103], v[104:107]
 ds_read_b64_tr_b16 a[206:207], v29 offset:46496
 s_add_u32 s86, s4, s66
 s_addc_u32 s87, s5, 0
 v_mfma_f32_16x16x32_bf16 v[108:111], a[216:219], a[96:99], v[108:111]
 ds_read_b64_tr_b16 a[208:209], v30 offset:42240
 global_load_lds_dwordx4 v8, s[86:87] offset:0
 v_mfma_f32_16x16x32_bf16 v[112:115], a[216:219], a[100:103], v[112:115]
 ds_read_b64_tr_b16 a[210:211], v30 offset:46464
 v_mfma_f32_16x16x32_bf16 v[116:119], a[220:223], a[96:99], v[116:119]
 ds_read_b64_tr_b16 a[212:213], v30 offset:42272
 v_mfma_f32_16x16x32_bf16 v[120:123], a[220:223], a[100:103], v[120:123]
 ds_read_b64_tr_b16 a[214:215], v30 offset:46496
 global_load_lds_dwordx4 v9, s[86:87] offset:1088
 s_waitcnt lgkmcnt(4)
 v_mfma_f32_16x16x32_bf16 v[60:63], a[192:195], a[104:107], v[60:63]
 ds_read_b64_tr_b16 a[216:217], v31 offset:42240
 v_mfma_f32_16x16x32_bf16 v[64:67], a[192:195], a[108:111], v[64:67]
 ds_read_b64_tr_b16 a[218:219], v31 offset:46464
 v_mfma_f32_16x16x32_bf16 v[68:71], a[196:199], a[104:107], v[68:71]
 ds_read_b64_tr_b16 a[220:221], v31 offset:42272
 v_mfma_f32_16x16x32_bf16 v[72:75], a[196:199], a[108:111], v[72:75]
 ds_read_b64_tr_b16 a[222:223], v31 offset:46496
 s_waitcnt vmcnt(2)
 s_barrier
 v_mfma_f32_16x16x32_bf16 v[76:79], a[200:203], a[104:107], v[76:79]
 ds_read_b64_tr_b16 a[192:193], v32 offset:0
 global_load_lds_dwordx4 v10, s[86:87] offset:2176
 v_mfma_f32_16x16x32_bf16 v[80:83], a[200:203], a[108:111], v[80:83]
 ds_read_b64_tr_b16 a[194:195], v32 offset:4224
 ds_read_b64 a[128:129], v18 offset:8704
 v_mfma_f32_16x16x32_bf16 v[84:87], a[204:207], a[104:107], v[84:87]
 ds_read_b64_tr_b16 a[196:197], v32 offset:32
 ds_read_b64 a[130:131], v19 offset:8704
 v_mfma_f32_16x16x32_bf16 v[88:91], a[204:207], a[108:111], v[88:91]
 ds_read_b64_tr_b16 a[198:199], v32 offset:4256
 global_load_lds_dwordx4 v11, s[86:87] offset:3264
 s_waitcnt lgkmcnt(6)
 v_mfma_f32_16x16x32_bf16 v[92:95], a[208:211], a[104:107], v[92:95]
 ds_read_b64_tr_b16 a[200:201], v33 offset:0
 s_add_u32 m0, s63, 67584
 s_xor_b32 s66, s81, 0x80100
 v_mfma_f32_16x16x32_bf16 v[96:99], a[208:211], a[108:111], v[96:99]
 ds_read_b64_tr_b16 a[202:203], v33 offset:4224
 s_add_u32 s86, s16, s66
 s_addc_u32 s87, s17, 0
 s_waitcnt vmcnt(0)
 ds_read_b128 a[112:115], v16 offset:4352
 v_mfma_f32_16x16x32_bf16 v[100:103], a[212:215], a[104:107], v[100:103]
 ds_read_b64_tr_b16 a[204:205], v33 offset:32
 global_load_lds_dwordx4 v4, s[86:87] offset:0
 ds_read_b64 a[132:133], v18 offset:13056
 ds_read_b128 a[116:119], v16 offset:6528
 v_mfma_f32_16x16x32_bf16 v[104:107], a[212:215], a[108:111], v[104:107]
 ds_read_b64_tr_b16 a[206:207], v33 offset:4256
 ds_read_b128 a[120:123], v16 offset:4416
 v_mfma_f32_16x16x32_bf16 v[108:111], a[216:219], a[104:107], v[108:111]
 ds_read_b64_tr_b16 a[208:209], v34 offset:0
 ds_read_b64 a[134:135], v19 offset:13056
 ds_read_b128 a[124:127], v16 offset:6592
 v_mfma_f32_16x16x32_bf16 v[112:115], a[216:219], a[108:111], v[112:115]
 ds_read_b64_tr_b16 a[210:211], v34 offset:4224
 global_load_lds_dwordx4 v5, s[86:87] offset:1056
L_hop0_0_2:
L_pad0_858:
 s_cbranch_execz L_ret0_0
 v_mfma_f32_16x16x32_bf16 v[116:119], a[220:223], a[104:107], v[116:119]
 ds_read_b64_tr_b16 a[212:213], v34 offset:32
 ds_read_b64 a[136:137], v18 offset:8768
 v_mfma_f32_16x16x32_bf16 v[120:123], a[220:223], a[108:111], v[120:123]
 ds_read_b64_tr_b16 a[214:215], v34 offset:4256
 s_waitcnt lgkmcnt(8)
 v_mfma_f32_16x16x32_bf16 v[60:63], a[192:195], a[112:115], v[60:63]
 ds_read_b64_tr_b16 a[216:217], v35 offset:0
 global_load_lds_dwordx4 v6, s[86:87] offset:2112
 ds_read_b64 a[138:139], v19 offset:8768
 v_mfma_f32_16x16x32_bf16 v[64:67], a[192:195], a[116:119], v[64:67]
 ds_read_b64_tr_b16 a[218:219], v35 offset:4224
 ds_read_b64 a[140:141], v18 offset:13120
 v_mfma_f32_16x16x32_bf16 v[68:71], a[196:199], a[112:115], v[68:71]
 ds_read_b64_tr_b16 a[220:221], v35 offset:32
 ds_read_b64 a[142:143], v19 offset:13120
 v_mfma_f32_16x16x32_bf16 v[72:75], a[196:199], a[116:119], v[72:75]
 ds_read_b64_tr_b16 a[222:223], v35 offset:4256
 global_load_lds_dwordx4 v7, s[86:87] offset:3168
 v_mfma_f32_16x16x32_bf16 v[76:79], a[200:203], a[112:115], v[76:79]
 ds_read_b64_tr_b16 a[192:193], v32 offset:8448
 s_add_u32 m0, s63, 0
 s_xor_b32 s66, s81, 0x100100
 v_mfma_f32_16x16x32_bf16 v[80:83], a[200:203], a[116:119], v[80:83]
 ds_read_b64_tr_b16 a[194:195], v32 offset:12672
 s_add_u32 s86, s16, s66
 s_addc_u32 s87, s17, 0
 v_mfma_f32_16x16x32_bf16 v[84:87], a[204:207], a[112:115], v[84:87]
 ds_read_b64_tr_b16 a[196:197], v32 offset:8480
 global_load_lds_dwordx4 v4, s[86:87] offset:0
 ds_read_b64 a[144:145], v18 offset:8832
 v_mfma_f32_16x16x32_bf16 v[88:91], a[204:207], a[116:119], v[88:91]
 ds_read_b64_tr_b16 a[198:199], v32 offset:12704
 s_waitcnt lgkmcnt(5)
 v_mfma_f32_16x16x32_bf16 v[92:95], a[208:211], a[112:115], v[92:95]
 ds_read_b64_tr_b16 a[200:201], v33 offset:8448
 ds_read_b64 a[146:147], v19 offset:8832
 v_mfma_f32_16x16x32_bf16 v[96:99], a[208:211], a[116:119], v[96:99]
 ds_read_b64_tr_b16 a[202:203], v33 offset:12672
 global_load_lds_dwordx4 v5, s[86:87] offset:1056
 v_mfma_f32_16x16x32_bf16 v[100:103], a[212:215], a[112:115], v[100:103]
 ds_read_b64_tr_b16 a[204:205], v33 offset:8480
 ds_read_b64 a[148:149], v18 offset:13184
 v_mfma_f32_16x16x32_bf16 v[104:107], a[212:215], a[116:119], v[104:107]
 ds_read_b64_tr_b16 a[206:207], v33 offset:12704
 ds_read_b64 a[150:151], v19 offset:13184
 v_mfma_f32_16x16x32_bf16 v[108:111], a[216:219], a[112:115], v[108:111]
 ds_read_b64_tr_b16 a[208:209], v34 offset:8448
 global_load_lds_dwordx4 v6, s[86:87] offset:2112
 v_mfma_f32_16x16x32_bf16 v[112:115], a[216:219], a[116:119], v[112:115]
 ds_read_b64_tr_b16 a[210:211], v34 offset:12672
 ds_read_b64 a[152:153], v18 offset:8896
 v_mfma_f32_16x16x32_bf16 v[116:119], a[220:223], a[112:115], v[116:119]
 ds_read_b64_tr_b16 a[212:213], v34 offset:8480
 ds_read_b64 a[154:155], v19 offset:8896
 v_mfma_f32_16x16x32_bf16 v[120:123], a[220:223], a[116:119], v[120:123]
 ds_read_b64_tr_b16 a[214:215], v34 offset:12704
 global_load_lds_dwordx4 v7, s[86:87] offset:3168
 s_waitcnt lgkmcnt(7)
 v_mfma_f32_16x16x32_bf16 v[60:63], a[192:195], a[120:123], v[60:63]
 ds_read_b64_tr_b16 a[216:217], v35 offset:8448
 s_add_u32 m0, s63, 16896
 v_mfma_f32_16x16x32_bf16 v[64:67], a[192:195], a[124:127], v[64:67]
 ds_read_b64_tr_b16 a[218:219], v35 offset:12672
 ds_read_b64 a[156:157], v18 offset:13248
 v_mfma_f32_16x16x32_bf16 v[68:71], a[196:199], a[120:123], v[68:71]
 ds_read_b64_tr_b16 a[220:221], v35 offset:8480
 global_load_lds_dwordx4 v4, s[100:101] offset:0
 v_mfma_f32_16x16x32_bf16 v[72:75], a[196:199], a[124:127], v[72:75]
 ds_read_b64_tr_b16 a[222:223], v35 offset:12704
 s_waitcnt vmcnt(5)
 s_barrier
 v_mfma_f32_16x16x32_bf16 v[76:79], a[200:203], a[120:123], v[76:79]
 ds_read_b64_tr_b16 a[192:193], v32 offset:16896
 ds_read_b64 a[158:159], v19 offset:13248
 v_mfma_f32_16x16x32_bf16 v[80:83], a[200:203], a[124:127], v[80:83]
 ds_read_b64_tr_b16 a[194:195], v32 offset:21120
 global_load_lds_dwordx4 v5, s[100:101] offset:1056
 v_mfma_f32_16x16x32_bf16 v[84:87], a[204:207], a[120:123], v[84:87]
 ds_read_b64_tr_b16 a[196:197], v32 offset:16928
 v_mfma_f32_16x16x32_bf16 v[88:91], a[204:207], a[124:127], v[88:91]
 ds_read_b64_tr_b16 a[198:199], v32 offset:21152
 s_waitcnt lgkmcnt(5)
 v_mfma_f32_16x16x32_bf16 v[92:95], a[208:211], a[120:123], v[92:95]
 ds_read_b64_tr_b16 a[200:201], v33 offset:16896
 global_load_lds_dwordx4 v6, s[100:101] offset:2112
 v_mfma_f32_16x16x32_bf16 v[96:99], a[208:211], a[124:127], v[96:99]
 ds_read_b64_tr_b16 a[202:203], v33 offset:21120
 v_mfma_f32_16x16x32_bf16 v[100:103], a[212:215], a[120:123], v[100:103]
 ds_read_b64_tr_b16 a[204:205], v33 offset:16928
 v_mfma_f32_16x16x32_bf16 v[104:107], a[212:215], a[124:127], v[104:107]
 ds_read_b64_tr_b16 a[206:207], v33 offset:21152
 global_load_lds_dwordx4 v7, s[100:101] offset:3168
 v_mfma_f32_16x16x32_bf16 v[108:111], a[216:219], a[120:123], v[108:111]
 ds_read_b64_tr_b16 a[208:209], v34 offset:16896
 s_waitcnt lgkmcnt(8)
 s_add_u32 m0, s64, 12800
 v_mfma_f32_16x16x32_bf16 v[112:115], a[216:219], a[124:127], v[112:115]
 ds_read_b64_tr_b16 a[210:211], v34 offset:21120
 v_mfma_f32_16x16x32_bf16 v[116:119], a[220:223], a[120:123], v[116:119]
 ds_read_b64_tr_b16 a[212:213], v34 offset:16928
 global_load_lds_dwordx4 v17, s[90:91] offset:-4096 nt
 v_mfma_f32_16x16x32_bf16 v[120:123], a[220:223], a[124:127], v[120:123]
 ds_read_b64_tr_b16 a[214:215], v34 offset:21152
 s_add_u32 m0, s64, 12864
 s_waitcnt lgkmcnt(4)
 v_mfma_f32_16x16x32_bf16 v[124:127], a[192:195], a[16:19], v[124:127]
 ds_read_b64_tr_b16 a[216:217], v35 offset:16896
 v_mfma_f32_16x16x32_bf16 v[128:131], a[192:195], a[20:23], v[128:131]
 ds_read_b64_tr_b16 a[218:219], v35 offset:21120
 global_load_lds_dwordx4 v17, s[90:91] offset:-3072 nt
 v_mfma_f32_16x16x32_bf16 v[132:135], a[196:199], a[16:19], v[132:135]
 ds_read_b64_tr_b16 a[220:221], v35 offset:16928
 s_add_u32 m0, s64, 12928
 v_mfma_f32_16x16x32_bf16 v[136:139], a[196:199], a[20:23], v[136:139]
 ds_read_b64_tr_b16 a[222:223], v35 offset:21152
 v_cvt_pk_bf16_f32 v188, v60, v61
 v_mfma_f32_16x16x32_bf16 v[140:143], a[200:203], a[16:19], v[140:143]
 ds_read_b64_tr_b16 a[192:193], v32 offset:25344
 global_load_lds_dwordx4 v17, s[90:91] offset:-2048 nt
 v_mfma_f32_16x16x32_bf16 v[144:147], a[200:203], a[20:23], v[144:147]
 ds_read_b64_tr_b16 a[194:195], v32 offset:29568
 s_add_u32 m0, s64, 12992
 v_cvt_pk_bf16_f32 v189, v62, v63
 v_mfma_f32_16x16x32_bf16 v[148:151], a[204:207], a[16:19], v[148:151]
 ds_read_b64_tr_b16 a[196:197], v32 offset:25376
 v_cvt_pk_bf16_f32 v192, v64, v65
 v_mfma_f32_16x16x32_bf16 v[152:155], a[204:207], a[20:23], v[152:155]
 ds_read_b64_tr_b16 a[198:199], v32 offset:29600
 global_load_lds_dwordx4 v17, s[90:91] offset:-1024 nt
 s_waitcnt lgkmcnt(4)
 v_mfma_f32_16x16x32_bf16 v[156:159], a[208:211], a[16:19], v[156:159]
 ds_read_b64_tr_b16 a[200:201], v33 offset:25344
 s_add_u32 m0, s64, 13056
 v_cvt_pk_bf16_f32 v193, v66, v67
 v_mfma_f32_16x16x32_bf16 v[160:163], a[208:211], a[20:23], v[160:163]
 ds_read_b64_tr_b16 a[202:203], v33 offset:29568
 v_cvt_pk_bf16_f32 v190, v68, v69
 v_mfma_f32_16x16x32_bf16 v[164:167], a[212:215], a[16:19], v[164:167]
 ds_read_b64_tr_b16 a[204:205], v33 offset:25376
 global_load_lds_dwordx4 v17, s[90:91] offset:0 nt
 v_mfma_f32_16x16x32_bf16 v[168:171], a[212:215], a[20:23], v[168:171]
 ds_read_b64_tr_b16 a[206:207], v33 offset:29600
 s_add_u32 m0, s64, 13120
 v_cvt_pk_bf16_f32 v191, v70, v71
 v_mfma_f32_16x16x32_bf16 v[172:175], a[216:219], a[16:19], v[172:175]
 ds_read_b64_tr_b16 a[208:209], v34 offset:25344
 v_cvt_pk_bf16_f32 v194, v72, v73
 v_mfma_f32_16x16x32_bf16 v[176:179], a[216:219], a[20:23], v[176:179]
 ds_read_b64_tr_b16 a[210:211], v34 offset:29568
 global_load_lds_dwordx4 v17, s[90:91] offset:1024 nt
 v_cvt_pk_bf16_f32 v195, v74, v75
 v_mfma_f32_16x16x32_bf16 v[180:183], a[220:223], a[16:19], v[180:183]
 ds_read_b64_tr_b16 a[212:213], v34 offset:25376
 s_add_u32 m0, s64, 13184
 v_mfma_f32_16x16x32_bf16 v[184:187], a[220:223], a[20:23], v[184:187]
 ds_read_b64_tr_b16 a[214:215], v34 offset:29600
 v_cvt_pk_bf16_f32 v196, v76, v77
 s_waitcnt lgkmcnt(4)
 v_mfma_f32_16x16x32_bf16 v[124:127], a[192:195], a[24:27], v[124:127]
 ds_read_b64_tr_b16 a[216:217], v35 offset:25344
 global_load_lds_dwordx4 v17, s[90:91] offset:2048 nt
 v_cvt_pk_bf16_f32 v197, v78, v79
 v_mfma_f32_16x16x32_bf16 v[128:131], a[192:195], a[28:31], v[128:131]
 ds_read_b64_tr_b16 a[218:219], v35 offset:29568
 s_add_u32 m0, s64, 13248
 v_mfma_f32_16x16x32_bf16 v[132:135], a[196:199], a[24:27], v[132:135]
 ds_read_b64_tr_b16 a[220:221], v35 offset:25376
 v_cvt_pk_bf16_f32 v200, v80, v81
 v_mfma_f32_16x16x32_bf16 v[136:139], a[196:199], a[28:31], v[136:139]
 ds_read_b64_tr_b16 a[222:223], v35 offset:29600
 global_load_lds_dwordx4 v17, s[90:91] offset:3072 nt
 v_cvt_pk_bf16_f32 v201, v82, v83
 s_waitcnt vmcnt(12)
 s_barrier
 v_mfma_f32_16x16x32_bf16 v[140:143], a[200:203], a[24:27], v[140:143]
 ds_read_b64_tr_b16 a[192:193], v28 offset:0
 s_add_u32 m0, s64, 4096
 v_cvt_pk_bf16_f32 v198, v84, v85
 v_mfma_f32_16x16x32_bf16 v[144:147], a[200:203], a[28:31], v[144:147]
 ds_read_b64_tr_b16 a[194:195], v28 offset:4224
 v_cvt_pk_bf16_f32 v199, v86, v87
 v_mfma_f32_16x16x32_bf16 v[148:151], a[204:207], a[24:27], v[148:151]
 ds_read_b64_tr_b16 a[196:197], v28 offset:32
 global_load_lds_dwordx4 v24, s[12:13] offset:-4096
 v_mfma_f32_16x16x32_bf16 v[152:155], a[204:207], a[28:31], v[152:155]
 ds_read_b64_tr_b16 a[198:199], v28 offset:4256
 v_cvt_pk_bf16_f32 v202, v88, v89
 s_waitcnt lgkmcnt(4)
 v_mfma_f32_16x16x32_bf16 v[156:159], a[208:211], a[24:27], v[156:159]
 ds_read_b64_tr_b16 a[200:201], v29 offset:0
 v_cvt_pk_bf16_f32 v203, v90, v91
 v_mfma_f32_16x16x32_bf16 v[160:163], a[208:211], a[28:31], v[160:163]
 ds_read_b64_tr_b16 a[202:203], v29 offset:4224
 global_load_lds_dwordx4 v25, s[12:13] offset:-3040
 v_mfma_f32_16x16x32_bf16 v[164:167], a[212:215], a[24:27], v[164:167]
 ds_read_b64_tr_b16 a[204:205], v29 offset:32
 v_cvt_pk_bf16_f32 v204, v92, v93
 v_mfma_f32_16x16x32_bf16 v[168:171], a[212:215], a[28:31], v[168:171]
 ds_read_b64_tr_b16 a[206:207], v29 offset:4256
 v_cvt_pk_bf16_f32 v205, v94, v95
 v_mfma_f32_16x16x32_bf16 v[172:175], a[216:219], a[24:27], v[172:175]
 ds_read_b64_tr_b16 a[208:209], v30 offset:0
 global_load_lds_dwordx4 v26, s[12:13] offset:-1984
 v_mfma_f32_16x16x32_bf16 v[176:179], a[216:219], a[28:31], v[176:179]
 ds_read_b64_tr_b16 a[210:211], v30 offset:4224
 v_cvt_pk_bf16_f32 v208, v96, v97
 v_mfma_f32_16x16x32_bf16 v[180:183], a[220:223], a[24:27], v[180:183]
 ds_read_b64_tr_b16 a[212:213], v30 offset:32
 v_cvt_pk_bf16_f32 v209, v98, v99
 v_mfma_f32_16x16x32_bf16 v[184:187], a[220:223], a[28:31], v[184:187]
 ds_read_b64_tr_b16 a[214:215], v30 offset:4256
 v_cvt_pk_bf16_f32 v206, v100, v101
 s_waitcnt lgkmcnt(4)
 v_mfma_f32_16x16x32_bf16 v[124:127], a[192:195], a[32:35], v[124:127]
 ds_read_b64_tr_b16 a[216:217], v31 offset:0
 v_cvt_pk_bf16_f32 v207, v102, v103
 v_mfma_f32_16x16x32_bf16 v[128:131], a[192:195], a[36:39], v[128:131]
 ds_read_b64_tr_b16 a[218:219], v31 offset:4224
 v_cvt_pk_bf16_f32 v210, v104, v105
 v_mfma_f32_16x16x32_bf16 v[132:135], a[196:199], a[32:35], v[132:135]
 ds_read_b64_tr_b16 a[220:221], v31 offset:32
 v_cvt_pk_bf16_f32 v211, v106, v107
 v_mfma_f32_16x16x32_bf16 v[136:139], a[196:199], a[36:39], v[136:139]
 ds_read_b64_tr_b16 a[222:223], v31 offset:4256
 v_cvt_pk_bf16_f32 v212, v108, v109
 v_mfma_f32_16x16x32_bf16 v[140:143], a[200:203], a[32:35], v[140:143]
 ds_read_b64_tr_b16 a[192:193], v28 offset:8448
 v_cvt_pk_bf16_f32 v213, v110, v111
 v_mfma_f32_16x16x32_bf16 v[144:147], a[200:203], a[36:39], v[144:147]
 ds_read_b64_tr_b16 a[194:195], v28 offset:12672
 v_cvt_pk_bf16_f32 v216, v112, v113
 v_mfma_f32_16x16x32_bf16 v[148:151], a[204:207], a[32:35], v[148:151]
 ds_read_b64_tr_b16 a[196:197], v28 offset:8480
 v_cvt_pk_bf16_f32 v217, v114, v115
 v_mfma_f32_16x16x32_bf16 v[152:155], a[204:207], a[36:39], v[152:155]
 ds_read_b64_tr_b16 a[198:199], v28 offset:12704
 s_waitcnt lgkmcnt(4)
 v_mfma_f32_16x16x32_bf16 v[156:159], a[208:211], a[32:35], v[156:159]
 ds_read_b64_tr_b16 a[200:201], v29 offset:8448
 v_cvt_pk_bf16_f32 v214, v116, v117
 v_mfma_f32_16x16x32_bf16 v[160:163], a[208:211], a[36:39], v[160:163]
 ds_read_b64_tr_b16 a[202:203], v29 offset:12672
 v_cvt_pk_bf16_f32 v215, v118, v119
 v_mfma_f32_16x16x32_bf16 v[164:167], a[212:215], a[32:35], v[164:167]
 ds_read_b64_tr_b16 a[204:205], v29 offset:8480
 v_cvt_pk_bf16_f32 v218, v120, v121
 v_mfma_f32_16x16x32_bf16 v[168:171], a[212:215], a[36:39], v[168:171]
 ds_read_b64_tr_b16 a[206:207], v29 offset:12704
 v_cvt_pk_bf16_f32 v219, v122, v123
 v_mfma_f32_16x16x32_bf16 v[172:175], a[216:219], a[32:35], v[172:175]
 ds_read_b64_tr_b16 a[208:209], v30 offset:8448
 v_mfma_f32_16x16x32_bf16 v[176:179], a[216:219], a[36:39], v[176:179]
 ds_read_b64_tr_b16 a[210:211], v30 offset:12672
 v_mfma_f32_16x16x32_bf16 v[180:183], a[220:223], a[32:35], v[180:183]
 ds_read_b64_tr_b16 a[212:213], v30 offset:8480
 global_load_lds_dwordx4 v27, s[12:13] offset:-928
 v_mfma_f32_16x16x32_bf16 v[184:187], a[220:223], a[36:39], v[184:187]
 ds_read_b64_tr_b16 a[214:215], v30 offset:12704
 s_add_u32 m0, s64, 4224
 v_mfma_f32_16x16x32_bf16 v[60:63], a[128:131], v[188:191], 0
 v_mfma_f32_16x16x32_bf16 v[68:71], a[128:131], v[192:195], 0
 v_mfma_f32_16x16x32_bf16 v[64:67], a[132:135], v[188:191], 0
 v_mfma_f32_16x16x32_bf16 v[72:75], a[132:135], v[192:195], 0
 v_mfma_f32_16x16x32_bf16 v[60:63], a[136:139], v[196:199], v[60:63]
L_hop0_0_3:
L_pad0_1123:
 s_cbranch_execz L_ret0_0
 global_load_lds_dwordx4 v24, s[12:13] offset:0
 v_mfma_f32_16x16x32_bf16 v[68:71], a[136:139], v[200:203], v[68:71]
 v_mfma_f32_16x16x32_bf16 v[64:67], a[140:143], v[196:199], v[64:67]
 v_mfma_f32_16x16x32_bf16 v[72:75], a[140:143], v[200:203], v[72:75]
 v_mfma_f32_16x16x32_bf16 v[60:63], a[144:147], v[204:207], v[60:63]
 v_mfma_f32_16x16x32_bf16 v[68:71], a[144:147], v[208:211], v[68:71]
 v_mfma_f32_16x16x32_bf16 v[64:67], a[148:151], v[204:207], v[64:67]
 global_load_lds_dwordx4 v25, s[12:13] offset:1056
 v_mfma_f32_16x16x32_bf16 v[72:75], a[148:151], v[208:211], v[72:75]
 v_mfma_f32_16x16x32_bf16 v[60:63], a[152:155], v[212:215], v[60:63]
 v_mfma_f32_16x16x32_bf16 v[68:71], a[152:155], v[216:219], v[68:71]
 v_mfma_f32_16x16x32_bf16 v[64:67], a[156:159], v[212:215], v[64:67]
 v_mfma_f32_16x16x32_bf16 v[72:75], a[156:159], v[216:219], v[72:75]
 s_waitcnt lgkmcnt(4)
 v_mfma_f32_16x16x32_bf16 v[124:127], a[192:195], a[40:43], v[124:127]
 ds_read_b64_tr_b16 a[216:217], v31 offset:8448
 global_load_lds_dwordx4 v26, s[12:13] offset:2112
 v_mfma_f32_16x16x32_bf16 v[128:131], a[192:195], a[44:47], v[128:131]
 ds_read_b64_tr_b16 a[218:219], v31 offset:12672
 v_mfma_f32_16x16x32_bf16 v[132:135], a[196:199], a[40:43], v[132:135]
 ds_read_b64_tr_b16 a[220:221], v31 offset:8480
 v_max3_f32 v2, v60, v61, v62
 v_max3_f32 v3, v68, v69, v70
 v_max3_f32 v2, v2, v63, v64
 v_max3_f32 v3, v3, v71, v72
 v_max3_f32 v2, v2, v65, v66
 v_max3_f32 v3, v3, v73, v74
 v_max_f32 v2, v2, v67
 v_max_f32 v3, v3, v75
 s_nop 1
 v_permlane32_swap_b32 v2, v3
 v_max_f32 v2, v2, v3
 v_mov_b32 v48, v2
 s_nop 1
 v_permlane16_swap_b32 v2, v48
 v_max_f32 v2, v2, v48
 v_mov_b32 v3, v2
 s_nop 1
 v_permlane32_swap_b32 v2, v3
 v_mul_f32 v2, s76, v2
 v_mul_f32 v3, s76, v3
 v_fma_f32 v60, v60, s76, -v2
 v_fma_f32 v61, v61, s76, -v2
 v_fma_f32 v62, v62, s76, -v2
 v_fma_f32 v63, v63, s76, -v2
 v_fma_f32 v64, v64, s76, -v2
 v_fma_f32 v65, v65, s76, -v2
 v_fma_f32 v66, v66, s76, -v2
 v_fma_f32 v67, v67, s76, -v2
 v_fma_f32 v68, v68, s76, -v3
 v_fma_f32 v69, v69, s76, -v3
 v_fma_f32 v70, v70, s76, -v3
 v_fma_f32 v71, v71, s76, -v3
 v_fma_f32 v72, v72, s76, -v3
 v_fma_f32 v73, v73, s76, -v3
 v_fma_f32 v74, v74, s76, -v3
 v_fma_f32 v75, v75, s76, -v3
 v_exp_f32 v60, v60
 v_exp_f32 v61, v61
 v_exp_f32 v62, v62
 v_exp_f32 v63, v63
 v_exp_f32 v64, v64
 v_exp_f32 v65, v65
 v_exp_f32 v66, v66
 v_exp_f32 v67, v67
 v_exp_f32 v68, v68
 v_exp_f32 v69, v69
 v_exp_f32 v70, v70
 v_exp_f32 v71, v71
 v_exp_f32 v72, v72
 v_exp_f32 v73, v73
 v_exp_f32 v74, v74
 v_exp_f32 v75, v75
 v_add_f32 v2, v60, v61
 v_add_f32 v3, v68, v69
 v_add_f32 v2, v2, v62
 v_add_f32 v3, v3, v70
 v_add_f32 v2, v2, v63
 v_add_f32 v3, v3, v71
 v_add_f32 v2, v2, v64
 v_add_f32 v3, v3, v72
 v_add_f32 v2, v2, v65
 v_add_f32 v3, v3, v73
 v_add_f32 v2, v2, v66
 v_add_f32 v3, v3, v74
 v_add_f32 v2, v2, v67
 v_add_f32 v3, v3, v75
 s_nop 1
 v_permlane32_swap_b32 v2, v3
 v_add_f32 v2, v2, v3
 v_mov_b32 v48, v2
 s_nop 1
 v_permlane16_swap_b32 v2, v48
 v_add_f32 v2, v2, v48
 v_mov_b32 v3, v2
 s_nop 1
 v_permlane32_swap_b32 v2, v3
 v_rcp_f32 v2, v2
 v_rcp_f32 v3, v3
 v_mul_f32 v60, v2, v60
 v_mul_f32 v61, v2, v61
 v_mul_f32 v62, v2, v62
 v_mul_f32 v63, v2, v63
 v_mul_f32 v64, v2, v64
 v_mul_f32 v65, v2, v65
 v_mul_f32 v66, v2, v66
 v_mul_f32 v67, v2, v67
 v_mul_f32 v68, v3, v68
 v_mul_f32 v69, v3, v69
 v_mul_f32 v70, v3, v70
 v_mul_f32 v71, v3, v71
 v_mul_f32 v72, v3, v72
 v_mul_f32 v73, v3, v73
 v_mul_f32 v74, v3, v74
 v_mul_f32 v75, v3, v75
 v_mfma_f32_16x16x32_bf16 v[136:139], a[196:199], a[44:47], v[136:139]
 ds_read_b64_tr_b16 a[222:223], v31 offset:12704
 global_load_lds_dwordx4 v27, s[12:13] offset:3168
 v_cvt_pk_bf16_f32 v52, v60, v61
 s_waitcnt vmcnt(16)
 s_barrier
 v_mfma_f32_16x16x32_bf16 v[140:143], a[200:203], a[40:43], v[140:143]
 ds_read_b64_tr_b16 a[192:193], v28 offset:16896
 s_add_u32 m0, s63, 33792
 v_cvt_pk_bf16_f32 v53, v62, v63
 v_mfma_f32_16x16x32_bf16 v[144:147], a[200:203], a[44:47], v[144:147]
 ds_read_b64_tr_b16 a[194:195], v28 offset:21120
 v_cvt_pk_bf16_f32 v54, v64, v65
 v_mfma_f32_16x16x32_bf16 v[148:151], a[204:207], a[40:43], v[148:151]
 ds_read_b64_tr_b16 a[196:197], v28 offset:16928
 global_load_lds_dwordx4 v4, s[98:99] offset:0
 v_cvt_pk_bf16_f32 v55, v66, v67
 v_mfma_f32_16x16x32_bf16 v[152:155], a[204:207], a[44:47], v[152:155]
 ds_read_b64_tr_b16 a[198:199], v28 offset:21152
 v_cvt_pk_bf16_f32 v56, v68, v69
 s_waitcnt lgkmcnt(4)
 v_mfma_f32_16x16x32_bf16 v[156:159], a[208:211], a[40:43], v[156:159]
 ds_read_b64_tr_b16 a[200:201], v29 offset:16896
 v_cvt_pk_bf16_f32 v57, v70, v71
 v_mfma_f32_16x16x32_bf16 v[160:163], a[208:211], a[44:47], v[160:163]
 ds_read_b64_tr_b16 a[202:203], v29 offset:21120
 global_load_lds_dwordx4 v5, s[98:99] offset:1056
 v_cvt_pk_bf16_f32 v58, v72, v73
 v_mfma_f32_16x16x32_bf16 v[164:167], a[212:215], a[40:43], v[164:167]
 ds_read_b64_tr_b16 a[204:205], v29 offset:16928
 v_cvt_pk_bf16_f32 v59, v74, v75
 v_mfma_f32_16x16x32_bf16 v[168:171], a[212:215], a[44:47], v[168:171]
 ds_read_b64_tr_b16 a[206:207], v29 offset:21152
 v_mfma_f32_16x16x32_bf16 v[172:175], a[216:219], a[40:43], v[172:175]
 ds_read_b64_tr_b16 a[208:209], v30 offset:16896
 buffer_store_dwordx4 v[52:55], v40, s[32:35], s72 offen sc1
 v_mfma_f32_16x16x32_bf16 v[176:179], a[216:219], a[44:47], v[176:179]
 ds_read_b64_tr_b16 a[210:211], v30 offset:21120
 v_mfma_f32_16x16x32_bf16 v[180:183], a[220:223], a[40:43], v[180:183]
 ds_read_b64_tr_b16 a[212:213], v30 offset:16928
 v_mfma_f32_16x16x32_bf16 v[184:187], a[220:223], a[44:47], v[184:187]
 ds_read_b64_tr_b16 a[214:215], v30 offset:21152
 buffer_store_dwordx4 v[56:59], v40, s[32:35], s72 offen offset:1024 sc1
 s_waitcnt lgkmcnt(4)
 v_mfma_f32_16x16x32_bf16 v[124:127], a[192:195], a[48:51], v[124:127]
 ds_read_b64_tr_b16 a[216:217], v31 offset:16896
 v_mfma_f32_16x16x32_bf16 v[128:131], a[192:195], a[52:55], v[128:131]
 ds_read_b64_tr_b16 a[218:219], v31 offset:21120
 v_mfma_f32_16x16x32_bf16 v[132:135], a[196:199], a[48:51], v[132:135]
 ds_read_b64_tr_b16 a[220:221], v31 offset:16928
 global_load_lds_dwordx4 v6, s[98:99] offset:2112
 v_mfma_f32_16x16x32_bf16 v[136:139], a[196:199], a[52:55], v[136:139]
 ds_read_b64_tr_b16 a[222:223], v31 offset:21152
 v_mfma_f32_16x16x32_bf16 v[140:143], a[200:203], a[48:51], v[140:143]
 ds_read_b64_tr_b16 a[192:193], v28 offset:25344
 v_mfma_f32_16x16x32_bf16 v[144:147], a[200:203], a[52:55], v[144:147]
 ds_read_b64_tr_b16 a[194:195], v28 offset:29568
 global_load_lds_dwordx4 v7, s[98:99] offset:3168
 v_mfma_f32_16x16x32_bf16 v[148:151], a[204:207], a[48:51], v[148:151]
 ds_read_b64_tr_b16 a[196:197], v28 offset:25376
 s_add_u32 m0, s63, 50688
 v_mfma_f32_16x16x32_bf16 v[152:155], a[204:207], a[52:55], v[152:155]
 ds_read_b64_tr_b16 a[198:199], v28 offset:29600
 s_waitcnt lgkmcnt(4)
 v_mfma_f32_16x16x32_bf16 v[156:159], a[208:211], a[48:51], v[156:159]
 ds_read_b64_tr_b16 a[200:201], v29 offset:25344
 global_load_lds_dwordx4 v4, s[96:97] offset:0
 v_mfma_f32_16x16x32_bf16 v[160:163], a[208:211], a[52:55], v[160:163]
 ds_read_b64_tr_b16 a[202:203], v29 offset:29568
 s_waitcnt vmcnt(15)
 ds_read_b64 a[160:161], v18 offset:8704
 v_mfma_f32_16x16x32_bf16 v[164:167], a[212:215], a[48:51], v[164:167]
 ds_read_b64_tr_b16 a[204:205], v29 offset:25376
 ds_read_b64 a[162:163], v19 offset:8704
 v_mfma_f32_16x16x32_bf16 v[168:171], a[212:215], a[52:55], v[168:171]
 ds_read_b64_tr_b16 a[206:207], v29 offset:29600
 global_load_lds_dwordx4 v5, s[96:97] offset:1056
 v_mfma_f32_16x16x32_bf16 v[172:175], a[216:219], a[48:51], v[172:175]
 ds_read_b64_tr_b16 a[208:209], v30 offset:25344
 ds_read_b64 a[164:165], v18 offset:13056
 v_mfma_f32_16x16x32_bf16 v[176:179], a[216:219], a[52:55], v[176:179]
 ds_read_b64_tr_b16 a[210:211], v30 offset:29568
 ds_read_b64 a[166:167], v19 offset:13056
 v_mfma_f32_16x16x32_bf16 v[180:183], a[220:223], a[48:51], v[180:183]
 ds_read_b64_tr_b16 a[212:213], v30 offset:25376
 ds_read_b64 a[168:169], v18 offset:8768
 v_mfma_f32_16x16x32_bf16 v[184:187], a[220:223], a[52:55], v[184:187]
 ds_read_b64_tr_b16 a[214:215], v30 offset:29600
 s_waitcnt lgkmcnt(7)
 v_mfma_f32_16x16x32_bf16 v[124:127], a[192:195], a[56:59], v[124:127]
 ds_read_b64_tr_b16 a[216:217], v31 offset:25344
 ds_read_b64 a[170:171], v19 offset:8768
 v_mfma_f32_16x16x32_bf16 v[128:131], a[192:195], a[60:63], v[128:131]
 ds_read_b64_tr_b16 a[218:219], v31 offset:29568
 global_load_lds_dwordx4 v6, s[96:97] offset:2112
 v_mfma_f32_16x16x32_bf16 v[132:135], a[196:199], a[56:59], v[132:135]
 ds_read_b64_tr_b16 a[220:221], v31 offset:25376
 ds_read_b64 a[172:173], v18 offset:13120
 v_mfma_f32_16x16x32_bf16 v[136:139], a[196:199], a[60:63], v[136:139]
 ds_read_b64_tr_b16 a[222:223], v31 offset:29600
 s_waitcnt vmcnt(9)
 v_mfma_f32_16x16x32_bf16 v[140:143], a[200:203], a[56:59], v[140:143]
 ds_read_b64_tr_b16 a[192:193], v36 offset:0
 global_load_lds_dwordx4 v7, s[96:97] offset:3168
 v_mfma_f32_16x16x32_bf16 v[144:147], a[200:203], a[60:63], v[144:147]
 ds_read_b64_tr_b16 a[194:195], v36 offset:4224
 s_add_u32 m0, s63, 67584
 v_mfma_f32_16x16x32_bf16 v[148:151], a[204:207], a[56:59], v[148:151]
 ds_read_b64_tr_b16 a[196:197], v36 offset:32
 ds_read_b64 a[174:175], v19 offset:13120
 v_mfma_f32_16x16x32_bf16 v[152:155], a[204:207], a[60:63], v[152:155]
 ds_read_b64_tr_b16 a[198:199], v36 offset:4256
 global_load_lds_dwordx4 v4, s[94:95] offset:0
 s_waitcnt lgkmcnt(5)
 v_mfma_f32_16x16x32_bf16 v[156:159], a[208:211], a[56:59], v[156:159]
 ds_read_b64_tr_b16 a[200:201], v37 offset:0
 ds_read_b64 a[176:177], v18 offset:8832
 v_mfma_f32_16x16x32_bf16 v[160:163], a[208:211], a[60:63], v[160:163]
 ds_read_b64_tr_b16 a[202:203], v37 offset:4224
 ds_read_b64 a[178:179], v19 offset:8832
 v_mfma_f32_16x16x32_bf16 v[164:167], a[212:215], a[56:59], v[164:167]
 ds_read_b64_tr_b16 a[204:205], v37 offset:32
 global_load_lds_dwordx4 v5, s[94:95] offset:1056
 v_mfma_f32_16x16x32_bf16 v[168:171], a[212:215], a[60:63], v[168:171]
 ds_read_b64_tr_b16 a[206:207], v37 offset:4256
 ds_read_b64 a[180:181], v18 offset:13184
 v_mfma_f32_16x16x32_bf16 v[172:175], a[216:219], a[56:59], v[172:175]
 ds_read_b64_tr_b16 a[208:209], v38 offset:0
 ds_read_b64 a[182:183], v19 offset:13184
 v_mfma_f32_16x16x32_bf16 v[176:179], a[216:219], a[60:63], v[176:179]
 ds_read_b64_tr_b16 a[210:211], v38 offset:4224
 global_load_lds_dwordx4 v6, s[94:95] offset:2112
 v_mfma_f32_16x16x32_bf16 v[180:183], a[220:223], a[56:59], v[180:183]
 ds_read_b64_tr_b16 a[212:213], v38 offset:32
 ds_read_b64 a[184:185], v18 offset:8896
 v_mfma_f32_16x16x32_bf16 v[184:187], a[220:223], a[60:63], v[184:187]
 ds_read_b64_tr_b16 a[214:215], v38 offset:4256
 s_waitcnt lgkmcnt(7)
 v_mfma_f32_16x16x32_bf16 v[60:63], a[192:195], v[52:55], 0
 ds_read_b64_tr_b16 a[216:217], v39 offset:0
 global_load_lds_dwordx4 v7, s[94:95] offset:3168
 v_mfma_f32_16x16x32_bf16 v[64:67], a[192:195], v[56:59], 0
 ds_read_b64_tr_b16 a[218:219], v39 offset:4224
 ds_read_b64 a[186:187], v19 offset:8896
 v_mfma_f32_16x16x32_bf16 v[68:71], a[196:199], v[52:55], 0
 ds_read_b64_tr_b16 a[220:221], v39 offset:32
 ds_read_b64 a[188:189], v18 offset:13248
 v_mfma_f32_16x16x32_bf16 v[72:75], a[196:199], v[56:59], 0
 ds_read_b64_tr_b16 a[222:223], v39 offset:4256
 s_waitcnt vmcnt(8)
 s_barrier
 v_mfma_f32_16x16x32_bf16 v[76:79], a[200:203], v[52:55], 0
 ds_read_b64_tr_b16 a[192:193], v28 offset:33792
 s_add_u32 m0, s63, 0
 v_mfma_f32_16x16x32_bf16 v[80:83], a[200:203], v[56:59], 0
 ds_read_b64_tr_b16 a[194:195], v28 offset:38016
 global_load_lds_dwordx4 v4, s[92:93] offset:0
 v_mfma_f32_16x16x32_bf16 v[84:87], a[204:207], v[52:55], 0
 ds_read_b64_tr_b16 a[196:197], v28 offset:33824
 ds_read_b64 a[190:191], v19 offset:13248
 v_mfma_f32_16x16x32_bf16 v[88:91], a[204:207], v[56:59], 0
 ds_read_b64_tr_b16 a[198:199], v28 offset:38048
 s_waitcnt lgkmcnt(5)
 v_mfma_f32_16x16x32_bf16 v[92:95], a[208:211], v[52:55], 0
 ds_read_b64_tr_b16 a[200:201], v29 offset:33792
 global_load_lds_dwordx4 v5, s[92:93] offset:1056
 v_mfma_f32_16x16x32_bf16 v[96:99], a[208:211], v[56:59], 0
 ds_read_b64_tr_b16 a[202:203], v29 offset:38016
 v_mfma_f32_16x16x32_bf16 v[100:103], a[212:215], v[52:55], 0
 ds_read_b64_tr_b16 a[204:205], v29 offset:33824
 v_mfma_f32_16x16x32_bf16 v[104:107], a[212:215], v[56:59], 0
 ds_read_b64_tr_b16 a[206:207], v29 offset:38048
 global_load_lds_dwordx4 v6, s[92:93] offset:2112
 v_mfma_f32_16x16x32_bf16 v[108:111], a[216:219], v[52:55], 0
 ds_read_b64_tr_b16 a[208:209], v30 offset:33792
 v_mfma_f32_16x16x32_bf16 v[112:115], a[216:219], v[56:59], 0
 ds_read_b64_tr_b16 a[210:211], v30 offset:38016
 v_mfma_f32_16x16x32_bf16 v[116:119], a[220:223], v[52:55], 0
 ds_read_b64_tr_b16 a[212:213], v30 offset:33824
 s_mov_b64 exec, 1
 buffer_store_dword v44, v45, s[32:35], s74 offen offset:0 sc1
 s_mov_b64 exec, -1
 v_mfma_f32_16x16x32_bf16 v[120:123], a[220:223], v[56:59], 0
 ds_read_b64_tr_b16 a[214:215], v30 offset:38048
 s_waitcnt lgkmcnt(4)
L_hop0_1_0:
L_pad0_1423:
 s_cbranch_execz L_pad0_2517
 v_mfma_f32_16x16x32_bf16 v[124:127], a[192:195], a[64:67], v[124:127]
 ds_read_b64_tr_b16 a[216:217], v31 offset:33792
 v_mfma_f32_16x16x32_bf16 v[128:131], a[192:195], a[68:71], v[128:131]
 ds_read_b64_tr_b16 a[218:219], v31 offset:38016
 global_load_lds_dwordx4 v7, s[92:93] offset:3168
 v_mfma_f32_16x16x32_bf16 v[132:135], a[196:199], a[64:67], v[132:135]
 ds_read_b64_tr_b16 a[220:221], v31 offset:33824
 s_add_u32 m0, s63, 16896
 v_mfma_f32_16x16x32_bf16 v[136:139], a[196:199], a[68:71], v[136:139]
 ds_read_b64_tr_b16 a[222:223], v31 offset:38048
 v_cvt_pk_bf16_f32 v188, v60, v61
 v_mfma_f32_16x16x32_bf16 v[140:143], a[200:203], a[64:67], v[140:143]
 ds_read_b64_tr_b16 a[192:193], v28 offset:42240
 global_load_lds_dwordx4 v20, s[20:21] offset:0
 v_mfma_f32_16x16x32_bf16 v[144:147], a[200:203], a[68:71], v[144:147]
 ds_read_b64_tr_b16 a[194:195], v28 offset:46464
 v_cvt_pk_bf16_f32 v189, v62, v63
 v_mfma_f32_16x16x32_bf16 v[148:151], a[204:207], a[64:67], v[148:151]
 ds_read_b64_tr_b16 a[196:197], v28 offset:42272
 v_cvt_pk_bf16_f32 v192, v64, v65
 v_mfma_f32_16x16x32_bf16 v[152:155], a[204:207], a[68:71], v[152:155]
 ds_read_b64_tr_b16 a[198:199], v28 offset:46496
 global_load_lds_dwordx4 v21, s[20:21] offset:1056
 s_waitcnt lgkmcnt(4)
 v_mfma_f32_16x16x32_bf16 v[156:159], a[208:211], a[64:67], v[156:159]
 ds_read_b64_tr_b16 a[200:201], v29 offset:42240
 v_cvt_pk_bf16_f32 v193, v66, v67
 v_mfma_f32_16x16x32_bf16 v[160:163], a[208:211], a[68:71], v[160:163]
 ds_read_b64_tr_b16 a[202:203], v29 offset:46464
 v_cvt_pk_bf16_f32 v190, v68, v69
 v_mfma_f32_16x16x32_bf16 v[164:167], a[212:215], a[64:67], v[164:167]
 ds_read_b64_tr_b16 a[204:205], v29 offset:42272
 global_load_lds_dwordx4 v22, s[20:21] offset:2112
 v_mfma_f32_16x16x32_bf16 v[168:171], a[212:215], a[68:71], v[168:171]
 ds_read_b64_tr_b16 a[206:207], v29 offset:46496
 v_cvt_pk_bf16_f32 v191, v70, v71
 v_mfma_f32_16x16x32_bf16 v[172:175], a[216:219], a[64:67], v[172:175]
 ds_read_b64_tr_b16 a[208:209], v30 offset:42240
 v_cvt_pk_bf16_f32 v194, v72, v73
 v_mfma_f32_16x16x32_bf16 v[176:179], a[216:219], a[68:71], v[176:179]
 ds_read_b64_tr_b16 a[210:211], v30 offset:46464
 global_load_lds_dwordx4 v23, s[20:21] offset:3168
 v_mfma_f32_16x16x32_bf16 v[180:183], a[220:223], a[64:67], v[180:183]
 ds_read_b64_tr_b16 a[212:213], v30 offset:42272
 s_add_u32 m0, s64, 12800
 v_mfma_f32_16x16x32_bf16 v[184:187], a[220:223], a[68:71], v[184:187]
 ds_read_b64_tr_b16 a[214:215], v30 offset:46496
 s_waitcnt lgkmcnt(4)
 v_mfma_f32_16x16x32_bf16 v[124:127], a[192:195], a[72:75], v[124:127]
 ds_read_b64_tr_b16 a[216:217], v31 offset:42240
 global_load_lds_dwordx4 v24, s[88:89] offset:-4096
 v_mfma_f32_16x16x32_bf16 v[128:131], a[192:195], a[76:79], v[128:131]
 ds_read_b64_tr_b16 a[218:219], v31 offset:46464
 v_cvt_pk_bf16_f32 v195, v74, v75
 v_mfma_f32_16x16x32_bf16 v[132:135], a[196:199], a[72:75], v[132:135]
 ds_read_b64_tr_b16 a[220:221], v31 offset:42272
 v_cvt_pk_bf16_f32 v196, v76, v77
 v_mfma_f32_16x16x32_bf16 v[136:139], a[196:199], a[76:79], v[136:139]
 ds_read_b64_tr_b16 a[222:223], v31 offset:46496
 global_load_lds_dwordx4 v25, s[88:89] offset:-3040
 s_waitcnt vmcnt(15)
 s_barrier
 v_mfma_f32_16x16x32_bf16 v[140:143], a[200:203], a[72:75], v[140:143]
 ds_read_b64_tr_b16 a[192:193], v32 offset:0
 v_cvt_pk_bf16_f32 v197, v78, v79
 v_mfma_f32_16x16x32_bf16 v[144:147], a[200:203], a[76:79], v[144:147]
 ds_read_b64_tr_b16 a[194:195], v32 offset:4224
 v_cvt_pk_bf16_f32 v200, v80, v81
 v_mfma_f32_16x16x32_bf16 v[148:151], a[204:207], a[72:75], v[148:151]
 ds_read_b64_tr_b16 a[196:197], v32 offset:32
 global_load_lds_dwordx4 v26, s[88:89] offset:-1984
 v_mfma_f32_16x16x32_bf16 v[152:155], a[204:207], a[76:79], v[152:155]
 ds_read_b64_tr_b16 a[198:199], v32 offset:4256
 s_waitcnt lgkmcnt(4)
 v_mfma_f32_16x16x32_bf16 v[156:159], a[208:211], a[72:75], v[156:159]
 ds_read_b64_tr_b16 a[200:201], v33 offset:0
 v_cvt_pk_bf16_f32 v201, v82, v83
 v_mfma_f32_16x16x32_bf16 v[160:163], a[208:211], a[76:79], v[160:163]
 ds_read_b64_tr_b16 a[202:203], v33 offset:4224
 v_cvt_pk_bf16_f32 v198, v84, v85
 v_mfma_f32_16x16x32_bf16 v[164:167], a[212:215], a[72:75], v[164:167]
 ds_read_b64_tr_b16 a[204:205], v33 offset:32
 global_load_lds_dwordx4 v27, s[88:89] offset:-928
 v_mfma_f32_16x16x32_bf16 v[168:171], a[212:215], a[76:79], v[168:171]
 ds_read_b64_tr_b16 a[206:207], v33 offset:4256
 s_add_u32 m0, s64, 12928
 v_mfma_f32_16x16x32_bf16 v[172:175], a[216:219], a[72:75], v[172:175]
 ds_read_b64_tr_b16 a[208:209], v34 offset:0
 v_cvt_pk_bf16_f32 v199, v86, v87
 v_mfma_f32_16x16x32_bf16 v[176:179], a[216:219], a[76:79], v[176:179]
 ds_read_b64_tr_b16 a[210:211], v34 offset:4224
 v_cvt_pk_bf16_f32 v202, v88, v89
 v_mfma_f32_16x16x32_bf16 v[180:183], a[220:223], a[72:75], v[180:183]
 ds_read_b64_tr_b16 a[212:213], v34 offset:32
 global_load_lds_dwordx4 v24, s[88:89] offset:0
 v_mfma_f32_16x16x32_bf16 v[184:187], a[220:223], a[76:79], v[184:187]
 ds_read_b64_tr_b16 a[214:215], v34 offset:4256
 s_waitcnt lgkmcnt(4)
 v_mfma_f32_16x16x32_bf16 v[124:127], a[192:195], a[80:83], v[124:127]
 ds_read_b64_tr_b16 a[216:217], v35 offset:0
 v_cvt_pk_bf16_f32 v203, v90, v91
 v_mfma_f32_16x16x32_bf16 v[128:131], a[192:195], a[84:87], v[128:131]
 ds_read_b64_tr_b16 a[218:219], v35 offset:4224
 v_cvt_pk_bf16_f32 v204, v92, v93
 v_mfma_f32_16x16x32_bf16 v[132:135], a[196:199], a[80:83], v[132:135]
 ds_read_b64_tr_b16 a[220:221], v35 offset:32
 v_cvt_pk_bf16_f32 v205, v94, v95
 v_mfma_f32_16x16x32_bf16 v[136:139], a[196:199], a[84:87], v[136:139]
 ds_read_b64_tr_b16 a[222:223], v35 offset:4256
 global_load_lds_dwordx4 v25, s[88:89] offset:1056
 v_mfma_f32_16x16x32_bf16 v[140:143], a[200:203], a[80:83], v[140:143]
 ds_read_b64_tr_b16 a[192:193], v32 offset:8448
 v_cvt_pk_bf16_f32 v208, v96, v97
 v_mfma_f32_16x16x32_bf16 v[144:147], a[200:203], a[84:87], v[144:147]
 ds_read_b64_tr_b16 a[194:195], v32 offset:12672
 v_cvt_pk_bf16_f32 v209, v98, v99
 v_mfma_f32_16x16x32_bf16 v[148:151], a[204:207], a[80:83], v[148:151]
 ds_read_b64_tr_b16 a[196:197], v32 offset:8480
 v_cvt_pk_bf16_f32 v206, v100, v101
 v_mfma_f32_16x16x32_bf16 v[152:155], a[204:207], a[84:87], v[152:155]
 ds_read_b64_tr_b16 a[198:199], v32 offset:12704
 global_load_lds_dwordx4 v26, s[88:89] offset:2112
 s_waitcnt lgkmcnt(4)
 v_mfma_f32_16x16x32_bf16 v[156:159], a[208:211], a[80:83], v[156:159]
 ds_read_b64_tr_b16 a[200:201], v33 offset:8448
 v_cvt_pk_bf16_f32 v207, v102, v103
 v_mfma_f32_16x16x32_bf16 v[160:163], a[208:211], a[84:87], v[160:163]
 ds_read_b64_tr_b16 a[202:203], v33 offset:12672
 v_cvt_pk_bf16_f32 v210, v104, v105
 v_mfma_f32_16x16x32_bf16 v[164:167], a[212:215], a[80:83], v[164:167]
 ds_read_b64_tr_b16 a[204:205], v33 offset:8480
 v_cvt_pk_bf16_f32 v211, v106, v107
 v_mfma_f32_16x16x32_bf16 v[168:171], a[212:215], a[84:87], v[168:171]
 ds_read_b64_tr_b16 a[206:207], v33 offset:12704
 v_cvt_pk_bf16_f32 v212, v108, v109
 v_mfma_f32_16x16x32_bf16 v[172:175], a[216:219], a[80:83], v[172:175]
 ds_read_b64_tr_b16 a[208:209], v34 offset:8448
 v_cvt_pk_bf16_f32 v213, v110, v111
 v_mfma_f32_16x16x32_bf16 v[176:179], a[216:219], a[84:87], v[176:179]
 ds_read_b64_tr_b16 a[210:211], v34 offset:12672
 v_cvt_pk_bf16_f32 v216, v112, v113
 v_mfma_f32_16x16x32_bf16 v[180:183], a[220:223], a[80:83], v[180:183]
 ds_read_b64_tr_b16 a[212:213], v34 offset:8480
 v_cvt_pk_bf16_f32 v217, v114, v115
 v_mfma_f32_16x16x32_bf16 v[184:187], a[220:223], a[84:87], v[184:187]
 ds_read_b64_tr_b16 a[214:215], v34 offset:12704
 s_waitcnt lgkmcnt(4)
 v_mfma_f32_16x16x32_bf16 v[124:127], a[192:195], a[88:91], v[124:127]
 ds_read_b64_tr_b16 a[216:217], v35 offset:8448
 v_cvt_pk_bf16_f32 v214, v116, v117
 v_mfma_f32_16x16x32_bf16 v[128:131], a[192:195], a[92:95], v[128:131]
 ds_read_b64_tr_b16 a[218:219], v35 offset:12672
 v_cvt_pk_bf16_f32 v215, v118, v119
 v_mfma_f32_16x16x32_bf16 v[132:135], a[196:199], a[88:91], v[132:135]
 ds_read_b64_tr_b16 a[220:221], v35 offset:8480
 v_cvt_pk_bf16_f32 v218, v120, v121
 v_mfma_f32_16x16x32_bf16 v[136:139], a[196:199], a[92:95], v[136:139]
 ds_read_b64_tr_b16 a[222:223], v35 offset:12704
 s_waitcnt vmcnt(11)
 s_barrier
 v_mfma_f32_16x16x32_bf16 v[140:143], a[200:203], a[88:91], v[140:143]
 ds_read_b64_tr_b16 a[192:193], v32 offset:16896
 v_cvt_pk_bf16_f32 v219, v122, v123
 v_mfma_f32_16x16x32_bf16 v[144:147], a[200:203], a[92:95], v[144:147]
 ds_read_b64_tr_b16 a[194:195], v32 offset:21120
 v_mfma_f32_16x16x32_bf16 v[148:151], a[204:207], a[88:91], v[148:151]
 ds_read_b64_tr_b16 a[196:197], v32 offset:16928
 v_mfma_f32_16x16x32_bf16 v[152:155], a[204:207], a[92:95], v[152:155]
 ds_read_b64_tr_b16 a[198:199], v32 offset:21152
 s_waitcnt lgkmcnt(4)
 v_mfma_f32_16x16x32_bf16 v[156:159], a[208:211], a[88:91], v[156:159]
 ds_read_b64_tr_b16 a[200:201], v33 offset:16896
 v_mfma_f32_16x16x32_bf16 v[160:163], a[208:211], a[92:95], v[160:163]
 ds_read_b64_tr_b16 a[202:203], v33 offset:21120
 v_mfma_f32_16x16x32_bf16 v[164:167], a[212:215], a[88:91], v[164:167]
 ds_read_b64_tr_b16 a[204:205], v33 offset:16928
 v_mfma_f32_16x16x32_bf16 v[168:171], a[212:215], a[92:95], v[168:171]
 ds_read_b64_tr_b16 a[206:207], v33 offset:21152
 global_load_lds_dwordx4 v27, s[88:89] offset:3168
 v_mfma_f32_16x16x32_bf16 v[172:175], a[216:219], a[88:91], v[172:175]
 ds_read_b64_tr_b16 a[208:209], v34 offset:16896
 v_mfma_f32_16x16x32_bf16 v[176:179], a[216:219], a[92:95], v[176:179]
 ds_read_b64_tr_b16 a[210:211], v34 offset:21120
 v_mfma_f32_16x16x32_bf16 v[180:183], a[220:223], a[88:91], v[180:183]
 ds_read_b64_tr_b16 a[212:213], v34 offset:16928
 v_mfma_f32_16x16x32_bf16 v[184:187], a[220:223], a[92:95], v[184:187]
 ds_read_b64_tr_b16 a[214:215], v34 offset:21152
 s_waitcnt lgkmcnt(4)
 v_mfma_f32_16x16x32_bf16 v[124:127], a[192:195], a[96:99], v[124:127]
 ds_read_b64_tr_b16 a[216:217], v35 offset:16896
 v_mfma_f32_16x16x32_bf16 v[128:131], a[192:195], a[100:103], v[128:131]
 ds_read_b64_tr_b16 a[218:219], v35 offset:21120
 s_add_u32 m0, s64, 4096
 v_mfma_f32_16x16x32_bf16 v[132:135], a[196:199], a[96:99], v[132:135]
 ds_read_b64_tr_b16 a[220:221], v35 offset:16928
 global_load_lds_dwordx4 v24, s[60:61] offset:-4096
 v_mfma_f32_16x16x32_bf16 v[136:139], a[196:199], a[100:103], v[136:139]
 ds_read_b64_tr_b16 a[222:223], v35 offset:21152
 v_mfma_f32_16x16x32_bf16 v[140:143], a[200:203], a[96:99], v[140:143]
 ds_read_b64_tr_b16 a[192:193], v32 offset:25344
 v_mfma_f32_16x16x32_bf16 v[144:147], a[200:203], a[100:103], v[144:147]
 ds_read_b64_tr_b16 a[194:195], v32 offset:29568
 v_mfma_f32_16x16x32_bf16 v[148:151], a[204:207], a[96:99], v[148:151]
 ds_read_b64_tr_b16 a[196:197], v32 offset:25376
 v_mfma_f32_16x16x32_bf16 v[152:155], a[204:207], a[100:103], v[152:155]
 ds_read_b64_tr_b16 a[198:199], v32 offset:29600
 global_load_lds_dwordx4 v25, s[60:61] offset:-3040
 s_waitcnt lgkmcnt(4)
 v_mfma_f32_16x16x32_bf16 v[156:159], a[208:211], a[96:99], v[156:159]
 ds_read_b64_tr_b16 a[200:201], v33 offset:25344
 v_mfma_f32_16x16x32_bf16 v[160:163], a[208:211], a[100:103], v[160:163]
 ds_read_b64_tr_b16 a[202:203], v33 offset:29568
 v_mfma_f32_16x16x32_bf16 v[164:167], a[212:215], a[96:99], v[164:167]
 ds_read_b64_tr_b16 a[204:205], v33 offset:25376
 buffer_load_dword v43, v41, s[32:35], s73 offen offset:0 sc1
 v_mfma_f32_16x16x32_bf16 v[168:171], a[212:215], a[100:103], v[168:171]
 ds_read_b64_tr_b16 a[206:207], v33 offset:29600
 v_mfma_f32_16x16x32_bf16 v[172:175], a[216:219], a[96:99], v[172:175]
 ds_read_b64_tr_b16 a[208:209], v34 offset:25344
 v_mfma_f32_16x16x32_bf16 v[176:179], a[216:219], a[100:103], v[176:179]
 ds_read_b64_tr_b16 a[210:211], v34 offset:29568
 global_load_lds_dwordx4 v26, s[60:61] offset:-1984
 v_mfma_f32_16x16x32_bf16 v[180:183], a[220:223], a[96:99], v[180:183]
 ds_read_b64_tr_b16 a[212:213], v34 offset:25376
 v_mfma_f32_16x16x32_bf16 v[184:187], a[220:223], a[100:103], v[184:187]
 ds_read_b64_tr_b16 a[214:215], v34 offset:29600
 s_waitcnt lgkmcnt(4)
 v_mfma_f32_16x16x32_bf16 v[124:127], a[192:195], a[104:107], v[124:127]
 ds_read_b64_tr_b16 a[216:217], v35 offset:25344
 global_load_lds_dwordx4 v27, s[60:61] offset:-928
 v_mfma_f32_16x16x32_bf16 v[128:131], a[192:195], a[108:111], v[128:131]
 ds_read_b64_tr_b16 a[218:219], v35 offset:29568
 s_add_u32 m0, s64, 4224
 v_mfma_f32_16x16x32_bf16 v[132:135], a[196:199], a[104:107], v[132:135]
 ds_read_b64_tr_b16 a[220:221], v35 offset:25376
 v_mfma_f32_16x16x32_bf16 v[136:139], a[196:199], a[108:111], v[136:139]
 ds_read_b64_tr_b16 a[222:223], v35 offset:29600
 global_load_lds_dwordx4 v24, s[60:61] offset:0
 v_mfma_f32_16x16x32_bf16 v[140:143], a[200:203], a[104:107], v[140:143]
 ds_read_b64_tr_b16 a[192:193], v28 offset:0
 v_mfma_f32_16x16x32_bf16 v[144:147], a[200:203], a[108:111], v[144:147]
 ds_read_b64_tr_b16 a[194:195], v28 offset:4224
 v_mfma_f32_16x16x32_bf16 v[148:151], a[204:207], a[104:107], v[148:151]
 ds_read_b64_tr_b16 a[196:197], v28 offset:32
 v_mfma_f32_16x16x32_bf16 v[152:155], a[204:207], a[108:111], v[152:155]
 ds_read_b64_tr_b16 a[198:199], v28 offset:4256
 global_load_lds_dwordx4 v25, s[60:61] offset:1056
 s_waitcnt lgkmcnt(4)
 v_mfma_f32_16x16x32_bf16 v[156:159], a[208:211], a[104:107], v[156:159]
 ds_read_b64_tr_b16 a[200:201], v29 offset:0
 v_mfma_f32_16x16x32_bf16 v[160:163], a[208:211], a[108:111], v[160:163]
 ds_read_b64_tr_b16 a[202:203], v29 offset:4224
 v_mfma_f32_16x16x32_bf16 v[164:167], a[212:215], a[104:107], v[164:167]
 ds_read_b64_tr_b16 a[204:205], v29 offset:32
 v_mfma_f32_16x16x32_bf16 v[168:171], a[212:215], a[108:111], v[168:171]
 ds_read_b64_tr_b16 a[206:207], v29 offset:4256
 v_mfma_f32_16x16x32_bf16 v[172:175], a[216:219], a[104:107], v[172:175]
 ds_read_b64_tr_b16 a[208:209], v30 offset:0
 global_load_lds_dwordx4 v26, s[60:61] offset:2112
 v_mfma_f32_16x16x32_bf16 v[176:179], a[216:219], a[108:111], v[176:179]
 ds_read_b64_tr_b16 a[210:211], v30 offset:4224
 v_mfma_f32_16x16x32_bf16 v[180:183], a[220:223], a[104:107], v[180:183]
 ds_read_b64_tr_b16 a[212:213], v30 offset:32
L_hop0_1_1:
L_pad0_1686:
 s_cbranch_execz L_pad0_2781
 v_mfma_f32_16x16x32_bf16 v[184:187], a[220:223], a[108:111], v[184:187]
 ds_read_b64_tr_b16 a[214:215], v30 offset:4256
 s_waitcnt lgkmcnt(4)
 v_mfma_f32_16x16x32_bf16 v[124:127], a[192:195], a[112:115], v[124:127]
 ds_read_b64_tr_b16 a[216:217], v31 offset:0
 global_load_lds_dwordx4 v27, s[60:61] offset:3168
 v_mfma_f32_16x16x32_bf16 v[128:131], a[192:195], a[116:119], v[128:131]
 ds_read_b64_tr_b16 a[218:219], v31 offset:4224
 v_mfma_f32_16x16x32_bf16 v[132:135], a[196:199], a[112:115], v[132:135]
 ds_read_b64_tr_b16 a[220:221], v31 offset:32
 v_mfma_f32_16x16x32_bf16 v[136:139], a[196:199], a[116:119], v[136:139]
 ds_read_b64_tr_b16 a[222:223], v31 offset:4256
 v_mfma_f32_16x16x32_bf16 v[140:143], a[200:203], a[112:115], v[140:143]
 ds_read_b64_tr_b16 a[192:193], v28 offset:8448
 s_add_u32 m0, s63, 33792
 v_mfma_f32_16x16x32_bf16 v[144:147], a[200:203], a[116:119], v[144:147]
 ds_read_b64_tr_b16 a[194:195], v28 offset:12672
 global_load_lds_dwordx4 v20, s[48:49] offset:0
 v_mfma_f32_16x16x32_bf16 v[148:151], a[204:207], a[112:115], v[148:151]
 ds_read_b64_tr_b16 a[196:197], v28 offset:8480
 v_mfma_f32_16x16x32_bf16 v[152:155], a[204:207], a[116:119], v[152:155]
 ds_read_b64_tr_b16 a[198:199], v28 offset:12704
 s_waitcnt lgkmcnt(4)
 v_mfma_f32_16x16x32_bf16 v[156:159], a[208:211], a[112:115], v[156:159]
 ds_read_b64_tr_b16 a[200:201], v29 offset:8448
 global_load_lds_dwordx4 v21, s[48:49] offset:1056
 v_mfma_f32_16x16x32_bf16 v[160:163], a[208:211], a[116:119], v[160:163]
 ds_read_b64_tr_b16 a[202:203], v29 offset:12672
 v_mfma_f32_16x16x32_bf16 v[164:167], a[212:215], a[112:115], v[164:167]
 ds_read_b64_tr_b16 a[204:205], v29 offset:8480
 v_mfma_f32_16x16x32_bf16 v[168:171], a[212:215], a[116:119], v[168:171]
 ds_read_b64_tr_b16 a[206:207], v29 offset:12704
 v_mfma_f32_16x16x32_bf16 v[172:175], a[216:219], a[112:115], v[172:175]
 ds_read_b64_tr_b16 a[208:209], v30 offset:8448
 v_mfma_f32_16x16x32_bf16 v[176:179], a[216:219], a[116:119], v[176:179]
 ds_read_b64_tr_b16 a[210:211], v30 offset:12672
 global_load_lds_dwordx4 v22, s[48:49] offset:2112
 v_mfma_f32_16x16x32_bf16 v[180:183], a[220:223], a[112:115], v[180:183]
 ds_read_b64_tr_b16 a[212:213], v30 offset:8480
 v_mfma_f32_16x16x32_bf16 v[184:187], a[220:223], a[116:119], v[184:187]
 ds_read_b64_tr_b16 a[214:215], v30 offset:12704
 s_waitcnt lgkmcnt(4)
 v_mfma_f32_16x16x32_bf16 v[124:127], a[192:195], a[120:123], v[124:127]
 ds_read_b64_tr_b16 a[216:217], v31 offset:8448
 v_mfma_f32_16x16x32_bf16 v[128:131], a[192:195], a[124:127], v[128:131]
 ds_read_b64_tr_b16 a[218:219], v31 offset:12672
 global_load_lds_dwordx4 v23, s[48:49] offset:3168
 v_mfma_f32_16x16x32_bf16 v[132:135], a[196:199], a[120:123], v[132:135]
 ds_read_b64_tr_b16 a[220:221], v31 offset:8480
 v_mfma_f32_16x16x32_bf16 v[136:139], a[196:199], a[124:127], v[136:139]
 ds_read_b64_tr_b16 a[222:223], v31 offset:12704
 s_waitcnt vmcnt(21)
 s_barrier
 v_mfma_f32_16x16x32_bf16 v[140:143], a[200:203], a[120:123], v[140:143]
 ds_read_b64_tr_b16 a[192:193], v28 offset:16896
 v_mfma_f32_16x16x32_bf16 v[144:147], a[200:203], a[124:127], v[144:147]
 ds_read_b64_tr_b16 a[194:195], v28 offset:21120
 v_mfma_f32_16x16x32_bf16 v[148:151], a[204:207], a[120:123], v[148:151]
 ds_read_b64_tr_b16 a[196:197], v28 offset:16928
 v_mfma_f32_16x16x32_bf16 v[152:155], a[204:207], a[124:127], v[152:155]
 ds_read_b64_tr_b16 a[198:199], v28 offset:21152
 s_waitcnt lgkmcnt(4)
 v_mfma_f32_16x16x32_bf16 v[156:159], a[208:211], a[120:123], v[156:159]
 ds_read_b64_tr_b16 a[200:201], v29 offset:16896
 v_mfma_f32_16x16x32_bf16 v[160:163], a[208:211], a[124:127], v[160:163]
 ds_read_b64_tr_b16 a[202:203], v29 offset:21120
 s_waitcnt vmcnt(10)
 v_cmp_ne_u32 vcc, 1, v43
 s_cbranch_vccnz L_slow0a
L_back0a:
 v_mfma_f32_16x16x32_bf16 v[164:167], a[212:215], a[120:123], v[164:167]
 ds_read_b64_tr_b16 a[204:205], v29 offset:16928
 s_xor_b32 s66, s72, 0x4000
 v_mfma_f32_16x16x32_bf16 v[168:171], a[212:215], a[124:127], v[168:171]
 ds_read_b64_tr_b16 a[206:207], v29 offset:21152
 s_add_u32 s86, s32, s66
 s_addc_u32 s87, s33, 0
 v_mfma_f32_16x16x32_bf16 v[172:175], a[216:219], a[120:123], v[172:175]
 ds_read_b64_tr_b16 a[208:209], v30 offset:16896
 global_load_dwordx4 a[224:227], v40, s[86:87] offset:0 sc1
 v_mfma_f32_16x16x32_bf16 v[176:179], a[216:219], a[124:127], v[176:179]
 ds_read_b64_tr_b16 a[210:211], v30 offset:21120
 v_mfma_f32_16x16x32_bf16 v[180:183], a[220:223], a[120:123], v[180:183]
 ds_read_b64_tr_b16 a[212:213], v30 offset:16928
 v_mfma_f32_16x16x32_bf16 v[184:187], a[220:223], a[124:127], v[184:187]
 ds_read_b64_tr_b16 a[214:215], v30 offset:21152
 global_load_dwordx4 a[228:231], v40, s[86:87] offset:1024 sc1
 s_waitcnt lgkmcnt(4)
 v_mfma_f32_16x16x32_bf16 v[60:63], a[192:195], v[188:191], 0
 ds_read_b64_tr_b16 a[216:217], v31 offset:16896
 v_mfma_f32_16x16x32_bf16 v[64:67], a[192:195], v[192:195], 0
 ds_read_b64_tr_b16 a[218:219], v31 offset:21120
 v_mfma_f32_16x16x32_bf16 v[68:71], a[196:199], v[188:191], 0
 ds_read_b64_tr_b16 a[220:221], v31 offset:16928
 s_xor_b32 s66, s72, 0x8000
 v_mfma_f32_16x16x32_bf16 v[72:75], a[196:199], v[192:195], 0
 ds_read_b64_tr_b16 a[222:223], v31 offset:21152
 s_add_u32 s86, s32, s66
 s_addc_u32 s87, s33, 0
 v_mfma_f32_16x16x32_bf16 v[76:79], a[200:203], v[188:191], 0
 ds_read_b64_tr_b16 a[192:193], v28 offset:25344
 global_load_dwordx4 a[232:235], v40, s[86:87] offset:0 sc1
 v_cvt_pk_bf16_f32 v220, v124, v125
 v_cvt_pk_bf16_f32 v228, v140, v141
 v_mfma_f32_16x16x32_bf16 v[80:83], a[200:203], v[192:195], 0
 ds_read_b64_tr_b16 a[194:195], v28 offset:29568
 v_cvt_pk_bf16_f32 v236, v156, v157
 v_cvt_pk_bf16_f32 v221, v126, v127
 v_cvt_pk_bf16_f32 v244, v172, v173
 v_mfma_f32_16x16x32_bf16 v[84:87], a[204:207], v[188:191], 0
 ds_read_b64_tr_b16 a[196:197], v28 offset:25376
 v_cvt_pk_bf16_f32 v229, v142, v143
 v_mfma_f32_16x16x32_bf16 v[88:91], a[204:207], v[192:195], 0
 ds_read_b64_tr_b16 a[198:199], v28 offset:29600
 global_load_dwordx4 a[236:239], v40, s[86:87] offset:1024 sc1
 v_cvt_pk_bf16_f32 v224, v128, v129
 v_cvt_pk_bf16_f32 v237, v158, v159
 s_waitcnt lgkmcnt(4)
 v_mfma_f32_16x16x32_bf16 v[92:95], a[208:211], v[188:191], 0
 ds_read_b64_tr_b16 a[200:201], v29 offset:25344
 s_xor_b32 s66, s72, 0xc000
 v_cvt_pk_bf16_f32 v225, v130, v131
 v_cvt_pk_bf16_f32 v232, v144, v145
 v_cvt_pk_bf16_f32 v245, v174, v175
 v_mfma_f32_16x16x32_bf16 v[96:99], a[208:211], v[192:195], 0
 ds_read_b64_tr_b16 a[202:203], v29 offset:29568
 s_add_u32 s86, s32, s66
 s_addc_u32 s87, s33, 0
 v_mfma_f32_16x16x32_bf16 v[100:103], a[212:215], v[188:191], 0
 ds_read_b64_tr_b16 a[204:205], v29 offset:25376
 global_load_dwordx4 a[240:243], v40, s[86:87] offset:0 sc1
 v_cvt_pk_bf16_f32 v222, v132, v133
 v_cvt_pk_bf16_f32 v240, v160, v161
 v_cvt_pk_bf16_f32 v233, v146, v147
 v_mfma_f32_16x16x32_bf16 v[104:107], a[212:215], v[192:195], 0
 ds_read_b64_tr_b16 a[206:207], v29 offset:29600
 v_cvt_pk_bf16_f32 v223, v134, v135
 v_cvt_pk_bf16_f32 v248, v176, v177
 v_mfma_f32_16x16x32_bf16 v[108:111], a[216:219], v[188:191], 0
 ds_read_b64_tr_b16 a[208:209], v30 offset:25344
 v_cvt_pk_bf16_f32 v230, v148, v149
 v_cvt_pk_bf16_f32 v241, v162, v163
 v_mfma_f32_16x16x32_bf16 v[112:115], a[216:219], v[192:195], 0
 ds_read_b64_tr_b16 a[210:211], v30 offset:29568
 global_load_dwordx4 a[244:247], v40, s[86:87] offset:1024 sc1
 v_cvt_pk_bf16_f32 v226, v136, v137
 v_mfma_f32_16x16x32_bf16 v[116:119], a[220:223], v[188:191], 0
 ds_read_b64_tr_b16 a[212:213], v30 offset:25376
 v_cvt_pk_bf16_f32 v227, v138, v139
 v_cvt_pk_bf16_f32 v231, v150, v151
 v_cvt_pk_bf16_f32 v249, v178, v179
 v_mfma_f32_16x16x32_bf16 v[120:123], a[220:223], v[192:195], 0
 ds_read_b64_tr_b16 a[214:215], v30 offset:29600
 v_cvt_pk_bf16_f32 v238, v164, v165
 v_mfma_f32_16x16x32_bf16 v[4:7], a[160:163], v[220:223], 0
 s_add_u32 m0, s63, 50688
 v_cvt_pk_bf16_f32 v234, v152, v153
 v_mfma_f32_16x16x32_bf16 v[12:15], a[160:163], v[224:227], 0
 global_load_lds_dwordx4 v20, s[46:47] offset:0
 v_cvt_pk_bf16_f32 v239, v166, v167
 v_cvt_pk_bf16_f32 v246, v180, v181
 v_mfma_f32_16x16x32_bf16 v[8:11], a[164:167], v[220:223], 0
 v_cvt_pk_bf16_f32 v235, v154, v155
 v_cvt_pk_bf16_f32 v242, v168, v169
 v_mfma_f32_16x16x32_bf16 v[16:19], a[164:167], v[224:227], 0
 v_cvt_pk_bf16_f32 v247, v182, v183
 v_cvt_pk_bf16_f32 v243, v170, v171
 v_mfma_f32_16x16x32_bf16 v[4:7], a[168:171], v[228:231], v[4:7]
 v_cvt_pk_bf16_f32 v250, v184, v185
 v_mfma_f32_16x16x32_bf16 v[12:15], a[168:171], v[232:235], v[12:15]
 v_cvt_pk_bf16_f32 v251, v186, v187
 v_mfma_f32_16x16x32_bf16 v[8:11], a[172:175], v[228:231], v[8:11]
 global_load_lds_dwordx4 v21, s[46:47] offset:1056
 v_mfma_f32_16x16x32_bf16 v[16:19], a[172:175], v[232:235], v[16:19]
 v_mfma_f32_16x16x32_bf16 v[4:7], a[176:179], v[236:239], v[4:7]
 v_mfma_f32_16x16x32_bf16 v[12:15], a[176:179], v[240:243], v[12:15]
 v_mfma_f32_16x16x32_bf16 v[8:11], a[180:183], v[236:239], v[8:11]
 v_mfma_f32_16x16x32_bf16 v[16:19], a[180:183], v[240:243], v[16:19]
 v_mfma_f32_16x16x32_bf16 v[4:7], a[184:187], v[244:247], v[4:7]
 v_mfma_f32_16x16x32_bf16 v[12:15], a[184:187], v[248:251], v[12:15]
 v_mfma_f32_16x16x32_bf16 v[8:11], a[188:191], v[244:247], v[8:11]
 v_mfma_f32_16x16x32_bf16 v[16:19], a[188:191], v[248:251], v[16:19]
 s_waitcnt lgkmcnt(4)
 v_mfma_f32_16x16x32_bf16 v[60:63], a[192:195], v[196:199], v[60:63]
 ds_read_b64_tr_b16 a[216:217], v31 offset:25344
 v_mfma_f32_16x16x32_bf16 v[64:67], a[192:195], v[200:203], v[64:67]
 ds_read_b64_tr_b16 a[218:219], v31 offset:29568
 v_mfma_f32_16x16x32_bf16 v[68:71], a[196:199], v[196:199], v[68:71]
 ds_read_b64_tr_b16 a[220:221], v31 offset:25376
 v_max3_f32 v2, v4, v5, v6
 v_max3_f32 v3, v12, v13, v14
 v_max3_f32 v2, v2, v7, v8
 v_max3_f32 v3, v3, v15, v16
 v_max3_f32 v2, v2, v9, v10
 v_max3_f32 v3, v3, v17, v18
 v_max_f32 v2, v2, v11
 v_max_f32 v3, v3, v19
 s_nop 1
 v_permlane32_swap_b32 v2, v3
 v_max_f32 v2, v2, v3
 v_mov_b32 v48, v2
 s_nop 1
 v_permlane16_swap_b32 v2, v48
 v_max_f32 v2, v2, v48
 v_mov_b32 v3, v2
 s_nop 1
 v_permlane32_swap_b32 v2, v3
 v_mul_f32 v2, s76, v2
 v_mul_f32 v3, s76, v3
 v_fma_f32 v4, v4, s76, -v2
 v_fma_f32 v5, v5, s76, -v2
 v_fma_f32 v6, v6, s76, -v2
 v_fma_f32 v7, v7, s76, -v2
 v_fma_f32 v8, v8, s76, -v2
 v_fma_f32 v9, v9, s76, -v2
 v_fma_f32 v10, v10, s76, -v2
 v_fma_f32 v11, v11, s76, -v2
 v_fma_f32 v12, v12, s76, -v3
 v_fma_f32 v13, v13, s76, -v3
 v_fma_f32 v14, v14, s76, -v3
 v_fma_f32 v15, v15, s76, -v3
 v_fma_f32 v16, v16, s76, -v3
 v_fma_f32 v17, v17, s76, -v3
 v_fma_f32 v18, v18, s76, -v3
 v_fma_f32 v19, v19, s76, -v3
 v_exp_f32 v4, v4
 v_exp_f32 v5, v5
 v_exp_f32 v6, v6
 v_exp_f32 v7, v7
 v_exp_f32 v8, v8
 v_exp_f32 v9, v9
 v_exp_f32 v10, v10
 v_exp_f32 v11, v11
 v_exp_f32 v12, v12
 v_exp_f32 v13, v13
 v_exp_f32 v14, v14
 v_mfma_f32_16x16x32_bf16 v[72:75], a[196:199], v[200:203], v[72:75]
 ds_read_b64_tr_b16 a[222:223], v31 offset:29600
 global_load_lds_dwordx4 v22, s[46:47] offset:2112
 v_exp_f32 v15, v15
 v_mfma_f32_16x16x32_bf16 v[76:79], a[200:203], v[196:199], v[76:79]
 ds_read_b64_tr_b16 a[192:193], v36 offset:8704
 v_exp_f32 v16, v16
 v_mfma_f32_16x16x32_bf16 v[80:83], a[200:203], v[200:203], v[80:83]
 ds_read_b64_tr_b16 a[194:195], v36 offset:12928
 v_exp_f32 v17, v17
 v_mfma_f32_16x16x32_bf16 v[84:87], a[204:207], v[196:199], v[84:87]
 ds_read_b64_tr_b16 a[196:197], v36 offset:8736
 global_load_lds_dwordx4 v23, s[46:47] offset:3168
 v_exp_f32 v18, v18
 v_mfma_f32_16x16x32_bf16 v[88:91], a[204:207], v[200:203], v[88:91]
 ds_read_b64_tr_b16 a[198:199], v36 offset:12960
 v_exp_f32 v19, v19
 s_waitcnt lgkmcnt(4)
 v_mfma_f32_16x16x32_bf16 v[92:95], a[208:211], v[196:199], v[92:95]
 ds_read_b64_tr_b16 a[200:201], v37 offset:8704
 v_add_f32 v2, v4, v5
 v_mfma_f32_16x16x32_bf16 v[96:99], a[208:211], v[200:203], v[96:99]
 ds_read_b64_tr_b16 a[202:203], v37 offset:12928
 v_add_f32 v3, v12, v13
 v_mfma_f32_16x16x32_bf16 v[100:103], a[212:215], v[196:199], v[100:103]
 ds_read_b64_tr_b16 a[204:205], v37 offset:8736
 s_add_u32 m0, s63, 67584
 v_add_f32 v2, v2, v6
 v_mfma_f32_16x16x32_bf16 v[104:107], a[212:215], v[200:203], v[104:107]
 ds_read_b64_tr_b16 a[206:207], v37 offset:12960
 global_load_lds_dwordx4 v20, s[44:45] offset:0
 v_add_f32 v3, v3, v14
 v_mfma_f32_16x16x32_bf16 v[108:111], a[216:219], v[196:199], v[108:111]
 ds_read_b64_tr_b16 a[208:209], v38 offset:8704
 v_add_f32 v2, v2, v7
 v_mfma_f32_16x16x32_bf16 v[112:115], a[216:219], v[200:203], v[112:115]
 ds_read_b64_tr_b16 a[210:211], v38 offset:12928
 v_add_f32 v3, v3, v15
 v_mfma_f32_16x16x32_bf16 v[116:119], a[220:223], v[196:199], v[116:119]
 ds_read_b64_tr_b16 a[212:213], v38 offset:8736
 v_add_f32 v2, v2, v8
 v_mfma_f32_16x16x32_bf16 v[120:123], a[220:223], v[200:203], v[120:123]
 ds_read_b64_tr_b16 a[214:215], v38 offset:12960
 v_add_f32 v3, v3, v16
 s_waitcnt lgkmcnt(4)
 s_waitcnt vmcnt(10)
 v_mfma_f32_16x16x32_bf16 v[124:127], a[192:195], a[224:227], 0
 ds_read_b64_tr_b16 a[216:217], v39 offset:8704
 global_load_lds_dwordx4 v21, s[44:45] offset:1056
 v_add_f32 v2, v2, v9
 s_waitcnt vmcnt(10)
L_hop0_1_2:
L_pad0_1973:
 s_cbranch_execz L_pad0_3049
 v_mfma_f32_16x16x32_bf16 v[128:131], a[192:195], a[228:231], 0
 ds_read_b64_tr_b16 a[218:219], v39 offset:12928
 v_add_f32 v3, v3, v17
 v_mfma_f32_16x16x32_bf16 v[132:135], a[196:199], a[224:227], 0
 ds_read_b64_tr_b16 a[220:221], v39 offset:8736
 v_add_f32 v2, v2, v10
 v_mfma_f32_16x16x32_bf16 v[136:139], a[196:199], a[228:231], 0
 ds_read_b64_tr_b16 a[222:223], v39 offset:12960
 global_load_lds_dwordx4 v22, s[44:45] offset:2112
 v_add_f32 v3, v3, v18
 s_barrier
 v_mfma_f32_16x16x32_bf16 v[140:143], a[200:203], a[224:227], 0
 ds_read_b64_tr_b16 a[192:193], v28 offset:33792
 v_add_f32 v2, v2, v11
 v_mfma_f32_16x16x32_bf16 v[144:147], a[200:203], a[228:231], 0
 ds_read_b64_tr_b16 a[194:195], v28 offset:38016
 v_add_f32 v3, v3, v19
 v_mfma_f32_16x16x32_bf16 v[148:151], a[204:207], a[224:227], 0
 ds_read_b64_tr_b16 a[196:197], v28 offset:33824
 global_load_lds_dwordx4 v23, s[44:45] offset:3168
 v_permlane32_swap_b32 v2, v3
 v_mfma_f32_16x16x32_bf16 v[152:155], a[204:207], a[228:231], 0
 ds_read_b64_tr_b16 a[198:199], v28 offset:38048
 v_add_f32 v2, v2, v3
 s_waitcnt lgkmcnt(4)
 v_mfma_f32_16x16x32_bf16 v[156:159], a[208:211], a[224:227], 0
 ds_read_b64_tr_b16 a[200:201], v29 offset:33792
 s_add_u32 m0, s63, 0
 v_mov_b32 v48, v2
 v_mfma_f32_16x16x32_bf16 v[160:163], a[208:211], a[228:231], 0
 ds_read_b64_tr_b16 a[202:203], v29 offset:38016
 global_load_lds_dwordx4 v20, s[42:43] offset:0
 v_permlane16_swap_b32 v2, v48
 v_mfma_f32_16x16x32_bf16 v[164:167], a[212:215], a[224:227], 0
 ds_read_b64_tr_b16 a[204:205], v29 offset:33824
 v_add_f32 v2, v2, v48
 v_mfma_f32_16x16x32_bf16 v[168:171], a[212:215], a[228:231], 0
 ds_read_b64_tr_b16 a[206:207], v29 offset:38048
 v_mov_b32 v3, v2
 v_mfma_f32_16x16x32_bf16 v[172:175], a[216:219], a[224:227], 0
 ds_read_b64_tr_b16 a[208:209], v30 offset:33792
 global_load_lds_dwordx4 v21, s[42:43] offset:1056
 v_permlane32_swap_b32 v2, v3
 v_mfma_f32_16x16x32_bf16 v[176:179], a[216:219], a[228:231], 0
 ds_read_b64_tr_b16 a[210:211], v30 offset:38016
 v_cvt_pk_bf16_f32 v188, v124, v125
 v_rcp_f32 v2, v2
 v_mfma_f32_16x16x32_bf16 v[180:183], a[220:223], a[224:227], 0
 ds_read_b64_tr_b16 a[212:213], v30 offset:33824
 v_rcp_f32 v3, v3
 v_mfma_f32_16x16x32_bf16 v[184:187], a[220:223], a[228:231], 0
 ds_read_b64_tr_b16 a[214:215], v30 offset:38048
 v_mul_f32 v4, v2, v4
 s_waitcnt lgkmcnt(4)
 v_mfma_f32_16x16x32_bf16 v[60:63], a[192:195], v[204:207], v[60:63]
 ds_read_b64_tr_b16 a[216:217], v31 offset:33792
 global_load_lds_dwordx4 v22, s[42:43] offset:2112
 v_mul_f32 v5, v2, v5
 v_mfma_f32_16x16x32_bf16 v[64:67], a[192:195], v[208:211], v[64:67]
 ds_read_b64_tr_b16 a[218:219], v31 offset:38016
 v_mul_f32 v6, v2, v6
 v_mfma_f32_16x16x32_bf16 v[68:71], a[196:199], v[204:207], v[68:71]
 ds_read_b64_tr_b16 a[220:221], v31 offset:33824
 v_cvt_pk_bf16_f32 v189, v126, v127
 v_mul_f32 v7, v2, v7
 v_mfma_f32_16x16x32_bf16 v[72:75], a[196:199], v[208:211], v[72:75]
 ds_read_b64_tr_b16 a[222:223], v31 offset:38048
 v_cvt_pk_bf16_f32 v196, v140, v141
 v_mul_f32 v8, v2, v8
 v_mfma_f32_16x16x32_bf16 v[76:79], a[200:203], v[204:207], v[76:79]
 ds_read_b64_tr_b16 a[192:193], v28 offset:42240
 global_load_lds_dwordx4 v23, s[42:43] offset:3168
 v_mul_f32 v9, v2, v9
 v_mfma_f32_16x16x32_bf16 v[80:83], a[200:203], v[208:211], v[80:83]
 ds_read_b64_tr_b16 a[194:195], v28 offset:46464
 v_mul_f32 v10, v2, v10
 v_mfma_f32_16x16x32_bf16 v[84:87], a[204:207], v[204:207], v[84:87]
 ds_read_b64_tr_b16 a[196:197], v28 offset:42272
 v_mul_f32 v11, v2, v11
 v_mfma_f32_16x16x32_bf16 v[88:91], a[204:207], v[208:211], v[88:91]
 ds_read_b64_tr_b16 a[198:199], v28 offset:46496
 v_cvt_pk_bf16_f32 v192, v128, v129
 v_mul_f32 v12, v3, v12
 s_waitcnt lgkmcnt(4)
 v_mfma_f32_16x16x32_bf16 v[92:95], a[208:211], v[204:207], v[92:95]
 ds_read_b64_tr_b16 a[200:201], v29 offset:42240
 s_add_u32 m0, s64, 12800
 v_mul_f32 v13, v3, v13
 v_mfma_f32_16x16x32_bf16 v[96:99], a[208:211], v[208:211], v[96:99]
 ds_read_b64_tr_b16 a[202:203], v29 offset:46464
 global_load_lds_dwordx4 v24, s[58:59] offset:-4096
 v_mul_f32 v14, v3, v14
 v_mfma_f32_16x16x32_bf16 v[100:103], a[212:215], v[204:207], v[100:103]
 ds_read_b64_tr_b16 a[204:205], v29 offset:42272
 v_cvt_pk_bf16_f32 v197, v142, v143
 v_mul_f32 v15, v3, v15
 v_mfma_f32_16x16x32_bf16 v[104:107], a[212:215], v[208:211], v[104:107]
 ds_read_b64_tr_b16 a[206:207], v29 offset:46496
 v_cvt_pk_bf16_f32 v193, v130, v131
 v_mul_f32 v16, v3, v16
 v_mfma_f32_16x16x32_bf16 v[108:111], a[216:219], v[204:207], v[108:111]
 ds_read_b64_tr_b16 a[208:209], v30 offset:42240
 global_load_lds_dwordx4 v25, s[58:59] offset:-3040
 v_mul_f32 v17, v3, v17
 v_mfma_f32_16x16x32_bf16 v[112:115], a[216:219], v[208:211], v[112:115]
 ds_read_b64_tr_b16 a[210:211], v30 offset:46464
 v_mul_f32 v18, v3, v18
 v_mfma_f32_16x16x32_bf16 v[116:119], a[220:223], v[204:207], v[116:119]
 ds_read_b64_tr_b16 a[212:213], v30 offset:42272
 v_mul_f32 v19, v3, v19
 v_mfma_f32_16x16x32_bf16 v[120:123], a[220:223], v[208:211], v[120:123]
 ds_read_b64_tr_b16 a[214:215], v30 offset:46496
 global_load_lds_dwordx4 v26, s[58:59] offset:-1984
 v_cvt_pk_bf16_f32 v52, v4, v5
 s_waitcnt lgkmcnt(4)
 v_mfma_f32_16x16x32_bf16 v[60:63], a[192:195], v[212:215], v[60:63]
 ds_read_b64_tr_b16 a[216:217], v31 offset:42240
 v_cvt_pk_bf16_f32 v190, v132, v133
 v_cvt_pk_bf16_f32 v53, v6, v7
 v_mfma_f32_16x16x32_bf16 v[64:67], a[192:195], v[216:219], v[64:67]
 ds_read_b64_tr_b16 a[218:219], v31 offset:46464
 v_cvt_pk_bf16_f32 v200, v144, v145
 v_cvt_pk_bf16_f32 v54, v8, v9
 v_mfma_f32_16x16x32_bf16 v[68:71], a[196:199], v[212:215], v[68:71]
 ds_read_b64_tr_b16 a[220:221], v31 offset:42272
 v_cvt_pk_bf16_f32 v55, v10, v11
 v_mfma_f32_16x16x32_bf16 v[72:75], a[196:199], v[216:219], v[72:75]
 ds_read_b64_tr_b16 a[222:223], v31 offset:46496
 global_load_lds_dwordx4 v27, s[58:59] offset:-928
 v_cvt_pk_bf16_f32 v56, v12, v13
 s_waitcnt vmcnt(12)
 s_barrier
 v_mfma_f32_16x16x32_bf16 v[76:79], a[200:203], v[212:215], v[76:79]
 ds_read_b64_tr_b16 a[192:193], v32 offset:0
 s_add_u32 m0, s64, 12928
 v_cvt_pk_bf16_f32 v57, v14, v15
 v_mfma_f32_16x16x32_bf16 v[80:83], a[200:203], v[216:219], v[80:83]
 ds_read_b64_tr_b16 a[194:195], v32 offset:4224
 v_cvt_pk_bf16_f32 v191, v134, v135
 v_cvt_pk_bf16_f32 v204, v156, v157
 v_cvt_pk_bf16_f32 v58, v16, v17
 v_mfma_f32_16x16x32_bf16 v[84:87], a[204:207], v[212:215], v[84:87]
 ds_read_b64_tr_b16 a[196:197], v32 offset:32
 global_load_lds_dwordx4 v24, s[58:59] offset:0
 v_cvt_pk_bf16_f32 v59, v18, v19
 v_mfma_f32_16x16x32_bf16 v[88:91], a[204:207], v[216:219], v[88:91]
 ds_read_b64_tr_b16 a[198:199], v32 offset:4256
 s_waitcnt lgkmcnt(4)
 v_mfma_f32_16x16x32_bf16 v[92:95], a[208:211], v[212:215], v[92:95]
 ds_read_b64_tr_b16 a[200:201], v33 offset:0
 v_cvt_pk_bf16_f32 v201, v146, v147
 v_mfma_f32_16x16x32_bf16 v[96:99], a[208:211], v[216:219], v[96:99]
 ds_read_b64_tr_b16 a[202:203], v33 offset:4224
 s_xor_b32 s65, s72, 0x2000
 buffer_store_dwordx4 v[52:55], v40, s[32:35], s65 offen sc1
 v_mfma_f32_16x16x32_bf16 v[100:103], a[212:215], v[212:215], v[100:103]
 ds_read_b64_tr_b16 a[204:205], v33 offset:32
 v_cvt_pk_bf16_f32 v194, v136, v137
 v_cvt_pk_bf16_f32 v205, v158, v159
 v_mfma_f32_16x16x32_bf16 v[104:107], a[212:215], v[216:219], v[104:107]
 ds_read_b64_tr_b16 a[206:207], v33 offset:4256
 v_cvt_pk_bf16_f32 v195, v138, v139
 v_mfma_f32_16x16x32_bf16 v[108:111], a[216:219], v[212:215], v[108:111]
 ds_read_b64_tr_b16 a[208:209], v34 offset:0
 buffer_store_dwordx4 v[56:59], v40, s[32:35], s65 offen offset:1024 sc1
 v_mfma_f32_16x16x32_bf16 v[112:115], a[216:219], v[216:219], v[112:115]
 ds_read_b64_tr_b16 a[210:211], v34 offset:4224
 v_cvt_pk_bf16_f32 v198, v148, v149
 v_mfma_f32_16x16x32_bf16 v[116:119], a[220:223], v[212:215], v[116:119]
 ds_read_b64_tr_b16 a[212:213], v34 offset:32
 v_cvt_pk_bf16_f32 v208, v160, v161
 v_mfma_f32_16x16x32_bf16 v[120:123], a[220:223], v[216:219], v[120:123]
 ds_read_b64_tr_b16 a[214:215], v34 offset:4256
 global_load_lds_dwordx4 v25, s[58:59] offset:1056
 s_waitcnt lgkmcnt(4)
 v_mfma_f32_16x16x32_bf16 v[60:63], a[192:195], v[188:191], v[60:63]
 ds_read_b64_tr_b16 a[216:217], v35 offset:0
 v_cvt_pk_bf16_f32 v212, v172, v173
 v_mfma_f32_16x16x32_bf16 v[64:67], a[192:195], v[192:195], v[64:67]
 ds_read_b64_tr_b16 a[218:219], v35 offset:4224
 v_cvt_pk_bf16_f32 v209, v162, v163
 v_mfma_f32_16x16x32_bf16 v[68:71], a[196:199], v[188:191], v[68:71]
 ds_read_b64_tr_b16 a[220:221], v35 offset:32
 global_load_lds_dwordx4 v26, s[58:59] offset:2112
 v_mfma_f32_16x16x32_bf16 v[72:75], a[196:199], v[192:195], v[72:75]
 ds_read_b64_tr_b16 a[222:223], v35 offset:4256
 v_mfma_f32_16x16x32_bf16 v[76:79], a[200:203], v[188:191], v[76:79]
 ds_read_b64_tr_b16 a[192:193], v36 offset:0
 v_cvt_pk_bf16_f32 v199, v150, v151
 v_mfma_f32_16x16x32_bf16 v[80:83], a[200:203], v[192:195], v[80:83]
 ds_read_b64_tr_b16 a[194:195], v36 offset:4224
 global_load_lds_dwordx4 v27, s[58:59] offset:3168
 v_mfma_f32_16x16x32_bf16 v[84:87], a[204:207], v[188:191], v[84:87]
 ds_read_b64_tr_b16 a[196:197], v36 offset:32
 v_cvt_pk_bf16_f32 v213, v174, v175
 v_mfma_f32_16x16x32_bf16 v[88:91], a[204:207], v[192:195], v[88:91]
 ds_read_b64_tr_b16 a[198:199], v36 offset:4256
 s_add_u32 m0, s63, 16896
 s_waitcnt lgkmcnt(4)
 v_mfma_f32_16x16x32_bf16 v[92:95], a[208:211], v[188:191], v[92:95]
 ds_read_b64_tr_b16 a[200:201], v37 offset:0
 global_load_lds_dwordx4 v20, s[40:41] offset:0
 v_mfma_f32_16x16x32_bf16 v[96:99], a[208:211], v[192:195], v[96:99]
 ds_read_b64_tr_b16 a[202:203], v37 offset:4224
 v_cvt_pk_bf16_f32 v206, v164, v165
 v_mfma_f32_16x16x32_bf16 v[100:103], a[212:215], v[188:191], v[100:103]
 ds_read_b64_tr_b16 a[204:205], v37 offset:32
 v_cvt_pk_bf16_f32 v216, v176, v177
 v_mfma_f32_16x16x32_bf16 v[104:107], a[212:215], v[192:195], v[104:107]
 ds_read_b64_tr_b16 a[206:207], v37 offset:4256
 global_load_lds_dwordx4 v21, s[40:41] offset:1056
 v_mfma_f32_16x16x32_bf16 v[108:111], a[216:219], v[188:191], v[108:111]
 ds_read_b64_tr_b16 a[208:209], v38 offset:0
 v_cvt_pk_bf16_f32 v202, v152, v153
 v_mfma_f32_16x16x32_bf16 v[112:115], a[216:219], v[192:195], v[112:115]
 ds_read_b64_tr_b16 a[210:211], v38 offset:4224
 v_cvt_pk_bf16_f32 v207, v166, v167
 v_mfma_f32_16x16x32_bf16 v[116:119], a[220:223], v[188:191], v[116:119]
 ds_read_b64_tr_b16 a[212:213], v38 offset:32
 v_cvt_pk_bf16_f32 v217, v178, v179
 v_mfma_f32_16x16x32_bf16 v[120:123], a[220:223], v[192:195], v[120:123]
 ds_read_b64_tr_b16 a[214:215], v38 offset:4256
 global_load_lds_dwordx4 v22, s[40:41] offset:2112
 s_waitcnt lgkmcnt(4)
 v_mfma_f32_16x16x32_bf16 v[124:127], a[192:195], a[232:235], 0
 ds_read_b64_tr_b16 a[216:217], v39 offset:0
 v_cvt_pk_bf16_f32 v214, v180, v181
 v_mfma_f32_16x16x32_bf16 v[128:131], a[192:195], a[236:239], 0
 ds_read_b64_tr_b16 a[218:219], v39 offset:4224
 v_cvt_pk_bf16_f32 v210, v168, v169
 v_mfma_f32_16x16x32_bf16 v[132:135], a[196:199], a[232:235], 0
 ds_read_b64_tr_b16 a[220:221], v39 offset:32
 v_cvt_pk_bf16_f32 v203, v154, v155
 v_mfma_f32_16x16x32_bf16 v[136:139], a[196:199], a[236:239], 0
 ds_read_b64_tr_b16 a[222:223], v39 offset:4256
 v_cvt_pk_bf16_f32 v215, v182, v183
 v_mfma_f32_16x16x32_bf16 v[140:143], a[200:203], a[232:235], 0
 ds_read_b64_tr_b16 a[192:193], v32 offset:8448
 global_load_lds_dwordx4 v23, s[40:41] offset:3168
 v_mfma_f32_16x16x32_bf16 v[144:147], a[200:203], a[236:239], 0
 ds_read_b64_tr_b16 a[194:195], v32 offset:12672
 v_cvt_pk_bf16_f32 v211, v170, v171
 v_mfma_f32_16x16x32_bf16 v[148:151], a[204:207], a[232:235], 0
 ds_read_b64_tr_b16 a[196:197], v32 offset:8480
 v_cvt_pk_bf16_f32 v218, v184, v185
 v_mfma_f32_16x16x32_bf16 v[152:155], a[204:207], a[236:239], 0
 ds_read_b64_tr_b16 a[198:199], v32 offset:12704
 s_waitcnt lgkmcnt(4)
 v_mfma_f32_16x16x32_bf16 v[156:159], a[208:211], a[232:235], 0
 ds_read_b64_tr_b16 a[200:201], v33 offset:8448
 v_cvt_pk_bf16_f32 v219, v186, v187
 v_mfma_f32_16x16x32_bf16 v[160:163], a[208:211], a[236:239], 0
 ds_read_b64_tr_b16 a[202:203], v33 offset:12672
 v_cvt_pk_bf16_f32 v188, v124, v125
 v_mfma_f32_16x16x32_bf16 v[164:167], a[212:215], a[232:235], 0
 ds_read_b64_tr_b16 a[204:205], v33 offset:8480
 v_cvt_pk_bf16_f32 v189, v126, v127
 v_mfma_f32_16x16x32_bf16 v[168:171], a[212:215], a[236:239], 0
 ds_read_b64_tr_b16 a[206:207], v33 offset:12704
 v_cvt_pk_bf16_f32 v192, v128, v129
 v_mfma_f32_16x16x32_bf16 v[172:175], a[216:219], a[232:235], 0
 ds_read_b64_tr_b16 a[208:209], v34 offset:8448
 v_cvt_pk_bf16_f32 v193, v130, v131
 v_mfma_f32_16x16x32_bf16 v[176:179], a[216:219], a[236:239], 0
 ds_read_b64_tr_b16 a[210:211], v34 offset:12672
 v_cvt_pk_bf16_f32 v190, v132, v133
 v_mfma_f32_16x16x32_bf16 v[180:183], a[220:223], a[232:235], 0
 ds_read_b64_tr_b16 a[212:213], v34 offset:8480
 v_cvt_pk_bf16_f32 v191, v134, v135
 v_mfma_f32_16x16x32_bf16 v[184:187], a[220:223], a[236:239], 0
 ds_read_b64_tr_b16 a[214:215], v34 offset:12704
 s_waitcnt lgkmcnt(4)
 v_mfma_f32_16x16x32_bf16 v[60:63], a[192:195], v[196:199], v[60:63]
 ds_read_b64_tr_b16 a[216:217], v35 offset:8448
 s_add_u32 m0, s64, 4096
 v_mfma_f32_16x16x32_bf16 v[64:67], a[192:195], v[200:203], v[64:67]
 ds_read_b64_tr_b16 a[218:219], v35 offset:12672
 global_load_lds_dwordx4 v24, s[56:57] offset:-4096
L_hop0_1_3:
L_pad0_2251:
 s_cbranch_execz L_pad0_3315
 v_mfma_f32_16x16x32_bf16 v[68:71], a[196:199], v[196:199], v[68:71]
 ds_read_b64_tr_b16 a[220:221], v35 offset:8480
 v_cvt_pk_bf16_f32 v194, v136, v137
 v_mfma_f32_16x16x32_bf16 v[72:75], a[196:199], v[200:203], v[72:75]
 ds_read_b64_tr_b16 a[222:223], v35 offset:12704
 s_waitcnt vmcnt(19)
 s_barrier
 v_mfma_f32_16x16x32_bf16 v[76:79], a[200:203], v[196:199], v[76:79]
 ds_read_b64_tr_b16 a[192:193], v32 offset:16896
 global_load_lds_dwordx4 v25, s[56:57] offset:-3040
 v_mfma_f32_16x16x32_bf16 v[80:83], a[200:203], v[200:203], v[80:83]
 ds_read_b64_tr_b16 a[194:195], v32 offset:21120
 v_cvt_pk_bf16_f32 v195, v138, v139
 v_mfma_f32_16x16x32_bf16 v[84:87], a[204:207], v[196:199], v[84:87]
 ds_read_b64_tr_b16 a[196:197], v32 offset:16928
 v_mfma_f32_16x16x32_bf16 v[88:91], a[204:207], v[200:203], v[88:91]
 ds_read_b64_tr_b16 a[198:199], v32 offset:21152
 global_load_lds_dwordx4 v26, s[56:57] offset:-1984
 s_waitcnt lgkmcnt(4)
 v_mfma_f32_16x16x32_bf16 v[92:95], a[208:211], v[196:199], v[92:95]
 ds_read_b64_tr_b16 a[200:201], v33 offset:16896
 v_mfma_f32_16x16x32_bf16 v[96:99], a[208:211], v[200:203], v[96:99]
 ds_read_b64_tr_b16 a[202:203], v33 offset:21120
 v_mfma_f32_16x16x32_bf16 v[100:103], a[212:215], v[196:199], v[100:103]
 ds_read_b64_tr_b16 a[204:205], v33 offset:16928
 global_load_lds_dwordx4 v27, s[56:57] offset:-928
 v_mfma_f32_16x16x32_bf16 v[104:107], a[212:215], v[200:203], v[104:107]
 ds_read_b64_tr_b16 a[206:207], v33 offset:21152
 s_add_u32 m0, s64, 4224
 v_mfma_f32_16x16x32_bf16 v[108:111], a[216:219], v[196:199], v[108:111]
 ds_read_b64_tr_b16 a[208:209], v34 offset:16896
 v_mfma_f32_16x16x32_bf16 v[112:115], a[216:219], v[200:203], v[112:115]
 ds_read_b64_tr_b16 a[210:211], v34 offset:21120
 global_load_lds_dwordx4 v24, s[56:57] offset:0
 v_mfma_f32_16x16x32_bf16 v[116:119], a[220:223], v[196:199], v[116:119]
 ds_read_b64_tr_b16 a[212:213], v34 offset:16928
 v_mfma_f32_16x16x32_bf16 v[120:123], a[220:223], v[200:203], v[120:123]
 ds_read_b64_tr_b16 a[214:215], v34 offset:21152
 s_waitcnt lgkmcnt(4)
 v_mfma_f32_16x16x32_bf16 v[60:63], a[192:195], v[204:207], v[60:63]
 ds_read_b64_tr_b16 a[216:217], v35 offset:16896
 global_load_lds_dwordx4 v25, s[56:57] offset:1056
 v_mfma_f32_16x16x32_bf16 v[64:67], a[192:195], v[208:211], v[64:67]
 ds_read_b64_tr_b16 a[218:219], v35 offset:21120
 v_cvt_pk_bf16_f32 v196, v140, v141
 v_mfma_f32_16x16x32_bf16 v[68:71], a[196:199], v[204:207], v[68:71]
 ds_read_b64_tr_b16 a[220:221], v35 offset:16928
 v_cvt_pk_bf16_f32 v197, v142, v143
 v_mfma_f32_16x16x32_bf16 v[72:75], a[196:199], v[208:211], v[72:75]
 ds_read_b64_tr_b16 a[222:223], v35 offset:21152
 global_load_lds_dwordx4 v26, s[56:57] offset:2112
 v_mfma_f32_16x16x32_bf16 v[76:79], a[200:203], v[204:207], v[76:79]
 ds_read_b64_tr_b16 a[192:193], v32 offset:25344
 v_cvt_pk_bf16_f32 v200, v144, v145
 v_mfma_f32_16x16x32_bf16 v[80:83], a[200:203], v[208:211], v[80:83]
 ds_read_b64_tr_b16 a[194:195], v32 offset:29568
 v_cvt_pk_bf16_f32 v201, v146, v147
 v_mfma_f32_16x16x32_bf16 v[84:87], a[204:207], v[204:207], v[84:87]
 ds_read_b64_tr_b16 a[196:197], v32 offset:25376
 global_load_lds_dwordx4 v27, s[56:57] offset:3168
 v_mfma_f32_16x16x32_bf16 v[88:91], a[204:207], v[208:211], v[88:91]
 ds_read_b64_tr_b16 a[198:199], v32 offset:29600
 s_waitcnt lgkmcnt(4)
 v_mfma_f32_16x16x32_bf16 v[92:95], a[208:211], v[204:207], v[92:95]
 ds_read_b64_tr_b16 a[200:201], v33 offset:25344
 v_cvt_pk_bf16_f32 v198, v148, v149
 v_mfma_f32_16x16x32_bf16 v[96:99], a[208:211], v[208:211], v[96:99]
 ds_read_b64_tr_b16 a[202:203], v33 offset:29568
 v_cvt_pk_bf16_f32 v199, v150, v151
 v_mfma_f32_16x16x32_bf16 v[100:103], a[212:215], v[204:207], v[100:103]
 ds_read_b64_tr_b16 a[204:205], v33 offset:25376
 s_add_u32 m0, s63, 33792
 v_mfma_f32_16x16x32_bf16 v[104:107], a[212:215], v[208:211], v[104:107]
 ds_read_b64_tr_b16 a[206:207], v33 offset:29600
 global_load_lds_dwordx4 v20, s[38:39] offset:0
 v_mfma_f32_16x16x32_bf16 v[108:111], a[216:219], v[204:207], v[108:111]
 ds_read_b64_tr_b16 a[208:209], v34 offset:25344
 v_cvt_pk_bf16_f32 v202, v152, v153
 v_mfma_f32_16x16x32_bf16 v[112:115], a[216:219], v[208:211], v[112:115]
 ds_read_b64_tr_b16 a[210:211], v34 offset:29568
 v_cvt_pk_bf16_f32 v203, v154, v155
 v_mfma_f32_16x16x32_bf16 v[116:119], a[220:223], v[204:207], v[116:119]
 ds_read_b64_tr_b16 a[212:213], v34 offset:25376
 global_load_lds_dwordx4 v21, s[38:39] offset:1056
 v_mfma_f32_16x16x32_bf16 v[120:123], a[220:223], v[208:211], v[120:123]
 ds_read_b64_tr_b16 a[214:215], v34 offset:29600
 s_waitcnt lgkmcnt(4)
 v_mfma_f32_16x16x32_bf16 v[60:63], a[192:195], v[212:215], v[60:63]
 ds_read_b64_tr_b16 a[216:217], v35 offset:25344
 v_cvt_pk_bf16_f32 v204, v156, v157
 v_mfma_f32_16x16x32_bf16 v[64:67], a[192:195], v[216:219], v[64:67]
 ds_read_b64_tr_b16 a[218:219], v35 offset:29568
 v_cvt_pk_bf16_f32 v205, v158, v159
 v_mfma_f32_16x16x32_bf16 v[68:71], a[196:199], v[212:215], v[68:71]
 ds_read_b64_tr_b16 a[220:221], v35 offset:25376
 v_cvt_pk_bf16_f32 v208, v160, v161
 v_mfma_f32_16x16x32_bf16 v[72:75], a[196:199], v[216:219], v[72:75]
 ds_read_b64_tr_b16 a[222:223], v35 offset:29600
 global_load_lds_dwordx4 v22, s[38:39] offset:2112
 s_waitcnt vmcnt(25)
 s_barrier
 v_mfma_f32_16x16x32_bf16 v[76:79], a[200:203], v[212:215], v[76:79]
 ds_read_b64_tr_b16 a[192:193], v28 offset:0
 v_cvt_pk_bf16_f32 v209, v162, v163
 v_mfma_f32_16x16x32_bf16 v[80:83], a[200:203], v[216:219], v[80:83]
 ds_read_b64_tr_b16 a[194:195], v28 offset:4224
 v_cvt_pk_bf16_f32 v206, v164, v165
 v_mfma_f32_16x16x32_bf16 v[84:87], a[204:207], v[212:215], v[84:87]
 ds_read_b64_tr_b16 a[196:197], v28 offset:32
 v_cvt_pk_bf16_f32 v207, v166, v167
 v_mfma_f32_16x16x32_bf16 v[88:91], a[204:207], v[216:219], v[88:91]
 ds_read_b64_tr_b16 a[198:199], v28 offset:4256
 s_waitcnt lgkmcnt(4)
 v_mfma_f32_16x16x32_bf16 v[92:95], a[208:211], v[212:215], v[92:95]
 ds_read_b64_tr_b16 a[200:201], v29 offset:0
 v_cvt_pk_bf16_f32 v210, v168, v169
 v_mfma_f32_16x16x32_bf16 v[96:99], a[208:211], v[216:219], v[96:99]
 ds_read_b64_tr_b16 a[202:203], v29 offset:4224
 v_cvt_pk_bf16_f32 v211, v170, v171
 v_mfma_f32_16x16x32_bf16 v[100:103], a[212:215], v[212:215], v[100:103]
 ds_read_b64_tr_b16 a[204:205], v29 offset:32
 v_mfma_f32_16x16x32_bf16 v[104:107], a[212:215], v[216:219], v[104:107]
 ds_read_b64_tr_b16 a[206:207], v29 offset:4256
 v_mfma_f32_16x16x32_bf16 v[108:111], a[216:219], v[212:215], v[108:111]
 ds_read_b64_tr_b16 a[208:209], v30 offset:0
 v_mfma_f32_16x16x32_bf16 v[112:115], a[216:219], v[216:219], v[112:115]
 ds_read_b64_tr_b16 a[210:211], v30 offset:4224
 v_mfma_f32_16x16x32_bf16 v[116:119], a[220:223], v[212:215], v[116:119]
 ds_read_b64_tr_b16 a[212:213], v30 offset:32
 v_mfma_f32_16x16x32_bf16 v[120:123], a[220:223], v[216:219], v[120:123]
 ds_read_b64_tr_b16 a[214:215], v30 offset:4256
 s_waitcnt lgkmcnt(4)
 v_mfma_f32_16x16x32_bf16 v[60:63], a[192:195], v[188:191], v[60:63]
 ds_read_b64_tr_b16 a[216:217], v31 offset:0
 v_cvt_pk_bf16_f32 v212, v172, v173
 v_mfma_f32_16x16x32_bf16 v[64:67], a[192:195], v[192:195], v[64:67]
 ds_read_b64_tr_b16 a[218:219], v31 offset:4224
 v_cvt_pk_bf16_f32 v213, v174, v175
 v_mfma_f32_16x16x32_bf16 v[68:71], a[196:199], v[188:191], v[68:71]
 ds_read_b64_tr_b16 a[220:221], v31 offset:32
 v_cvt_pk_bf16_f32 v216, v176, v177
 v_mfma_f32_16x16x32_bf16 v[72:75], a[196:199], v[192:195], v[72:75]
 ds_read_b64_tr_b16 a[222:223], v31 offset:4256
 v_cvt_pk_bf16_f32 v217, v178, v179
 v_mfma_f32_16x16x32_bf16 v[76:79], a[200:203], v[188:191], v[76:79]
 ds_read_b64_tr_b16 a[192:193], v28 offset:8448
 v_cvt_pk_bf16_f32 v214, v180, v181
 v_mfma_f32_16x16x32_bf16 v[80:83], a[200:203], v[192:195], v[80:83]
 ds_read_b64_tr_b16 a[194:195], v28 offset:12672
 v_cvt_pk_bf16_f32 v215, v182, v183
 v_mfma_f32_16x16x32_bf16 v[84:87], a[204:207], v[188:191], v[84:87]
 ds_read_b64_tr_b16 a[196:197], v28 offset:8480
 global_load_lds_dwordx4 v23, s[38:39] offset:3168
 v_mfma_f32_16x16x32_bf16 v[88:91], a[204:207], v[192:195], v[88:91]
 ds_read_b64_tr_b16 a[198:199], v28 offset:12704
 s_waitcnt lgkmcnt(4)
 v_mfma_f32_16x16x32_bf16 v[92:95], a[208:211], v[188:191], v[92:95]
 ds_read_b64_tr_b16 a[200:201], v29 offset:8448
 v_cvt_pk_bf16_f32 v218, v184, v185
 v_mfma_f32_16x16x32_bf16 v[96:99], a[208:211], v[192:195], v[96:99]
 ds_read_b64_tr_b16 a[202:203], v29 offset:12672
 v_cvt_pk_bf16_f32 v219, v186, v187
 v_mfma_f32_16x16x32_bf16 v[100:103], a[212:215], v[188:191], v[100:103]
 ds_read_b64_tr_b16 a[204:205], v29 offset:8480
 s_waitcnt vmcnt(19)
 s_mov_b64 exec, 1
 buffer_store_dword v44, v45, s[32:35], s74 offen offset:4 sc1
 s_mov_b64 exec, -1
 v_mfma_f32_16x16x32_bf16 v[104:107], a[212:215], v[192:195], v[104:107]
 ds_read_b64_tr_b16 a[206:207], v29 offset:12704
 v_mfma_f32_16x16x32_bf16 v[108:111], a[216:219], v[188:191], v[108:111]
 ds_read_b64_tr_b16 a[208:209], v30 offset:8448
 s_add_u32 m0, s63, 50688
 v_mfma_f32_16x16x32_bf16 v[112:115], a[216:219], v[192:195], v[112:115]
 ds_read_b64_tr_b16 a[210:211], v30 offset:12672
 global_load_lds_dwordx4 v20, s[36:37] offset:0
 v_mfma_f32_16x16x32_bf16 v[116:119], a[220:223], v[188:191], v[116:119]
 ds_read_b64_tr_b16 a[212:213], v30 offset:8480
 v_mfma_f32_16x16x32_bf16 v[120:123], a[220:223], v[192:195], v[120:123]
 ds_read_b64_tr_b16 a[214:215], v30 offset:12704
 s_waitcnt lgkmcnt(4)
 v_mfma_f32_16x16x32_bf16 v[60:63], a[192:195], v[196:199], v[60:63]
 ds_read_b64_tr_b16 a[216:217], v31 offset:8448
 v_mfma_f32_16x16x32_bf16 v[64:67], a[192:195], v[200:203], v[64:67]
 ds_read_b64_tr_b16 a[218:219], v31 offset:12672
 v_mfma_f32_16x16x32_bf16 v[68:71], a[196:199], v[196:199], v[68:71]
 ds_read_b64_tr_b16 a[220:221], v31 offset:8480
 global_load_lds_dwordx4 v21, s[36:37] offset:1056
 v_mfma_f32_16x16x32_bf16 v[72:75], a[196:199], v[200:203], v[72:75]
 ds_read_b64_tr_b16 a[222:223], v31 offset:12704
 s_waitcnt vmcnt(19)
 v_mfma_f32_16x16x32_bf16 v[76:79], a[200:203], v[196:199], v[76:79]
 ds_read_b64_tr_b16 a[192:193], v36 offset:8704
 v_mfma_f32_16x16x32_bf16 v[80:83], a[200:203], v[200:203], v[80:83]
 ds_read_b64_tr_b16 a[194:195], v36 offset:12928
 v_mfma_f32_16x16x32_bf16 v[84:87], a[204:207], v[196:199], v[84:87]
 ds_read_b64_tr_b16 a[196:197], v36 offset:8736
 v_mfma_f32_16x16x32_bf16 v[88:91], a[204:207], v[200:203], v[88:91]
 ds_read_b64_tr_b16 a[198:199], v36 offset:12960
 s_waitcnt lgkmcnt(4)
 v_mfma_f32_16x16x32_bf16 v[92:95], a[208:211], v[196:199], v[92:95]
 ds_read_b64_tr_b16 a[200:201], v37 offset:8704
 global_load_lds_dwordx4 v22, s[36:37] offset:2112
 v_mfma_f32_16x16x32_bf16 v[96:99], a[208:211], v[200:203], v[96:99]
 ds_read_b64_tr_b16 a[202:203], v37 offset:12928
 v_mfma_f32_16x16x32_bf16 v[100:103], a[212:215], v[196:199], v[100:103]
 ds_read_b64_tr_b16 a[204:205], v37 offset:8736
 v_mfma_f32_16x16x32_bf16 v[104:107], a[212:215], v[200:203], v[104:107]
 ds_read_b64_tr_b16 a[206:207], v37 offset:12960
 v_mfma_f32_16x16x32_bf16 v[108:111], a[216:219], v[196:199], v[108:111]
 ds_read_b64_tr_b16 a[208:209], v38 offset:8704
 v_mfma_f32_16x16x32_bf16 v[112:115], a[216:219], v[200:203], v[112:115]
 ds_read_b64_tr_b16 a[210:211], v38 offset:12928
 v_mfma_f32_16x16x32_bf16 v[116:119], a[220:223], v[196:199], v[116:119]
 ds_read_b64_tr_b16 a[212:213], v38 offset:8736
 global_load_lds_dwordx4 v23, s[36:37] offset:3168
 v_mfma_f32_16x16x32_bf16 v[120:123], a[220:223], v[200:203], v[120:123]
 ds_read_b64_tr_b16 a[214:215], v38 offset:12960
 s_waitcnt lgkmcnt(4)
 v_mfma_f32_16x16x32_bf16 v[124:127], a[192:195], a[240:243], 0
 ds_read_b64_tr_b16 a[216:217], v39 offset:8704
 v_mfma_f32_16x16x32_bf16 v[128:131], a[192:195], a[244:247], 0
 ds_read_b64_tr_b16 a[218:219], v39 offset:12928
 v_mfma_f32_16x16x32_bf16 v[132:135], a[196:199], a[240:243], 0
 ds_read_b64_tr_b16 a[220:221], v39 offset:8736
 v_mfma_f32_16x16x32_bf16 v[136:139], a[196:199], a[244:247], 0
 ds_read_b64_tr_b16 a[222:223], v39 offset:12960
 s_waitcnt vmcnt(17)
 s_barrier
 v_mfma_f32_16x16x32_bf16 v[140:143], a[200:203], a[240:243], 0
 ds_read_b64_tr_b16 a[192:193], v28 offset:16896
 s_add_u32 m0, s63, 67584
 v_mfma_f32_16x16x32_bf16 v[144:147], a[200:203], a[244:247], 0
 ds_read_b64_tr_b16 a[194:195], v28 offset:21120
 global_load_lds_dwordx4 v20, s[30:31] offset:0
 v_mfma_f32_16x16x32_bf16 v[148:151], a[204:207], a[240:243], 0
 ds_read_b64_tr_b16 a[196:197], v28 offset:16928
 v_mfma_f32_16x16x32_bf16 v[152:155], a[204:207], a[244:247], 0
 ds_read_b64_tr_b16 a[198:199], v28 offset:21152
 s_waitcnt lgkmcnt(4)
 v_mfma_f32_16x16x32_bf16 v[156:159], a[208:211], a[240:243], 0
 ds_read_b64_tr_b16 a[200:201], v29 offset:16896
 v_cvt_pk_bf16_f32 v188, v124, v125
 v_mfma_f32_16x16x32_bf16 v[160:163], a[208:211], a[244:247], 0
 ds_read_b64_tr_b16 a[202:203], v29 offset:21120
 v_cvt_pk_bf16_f32 v189, v126, v127
 v_mfma_f32_16x16x32_bf16 v[164:167], a[212:215], a[240:243], 0
 ds_read_b64_tr_b16 a[204:205], v29 offset:16928
 global_load_lds_dwordx4 v21, s[30:31] offset:1056
 v_mfma_f32_16x16x32_bf16 v[168:171], a[212:215], a[244:247], 0
 ds_read_b64_tr_b16 a[206:207], v29 offset:21152
 v_cvt_pk_bf16_f32 v192, v128, v129
 v_mfma_f32_16x16x32_bf16 v[172:175], a[216:219], a[240:243], 0
 ds_read_b64_tr_b16 a[208:209], v30 offset:16896
 v_cvt_pk_bf16_f32 v196, v140, v141
 v_mfma_f32_16x16x32_bf16 v[176:179], a[216:219], a[244:247], 0
 ds_read_b64_tr_b16 a[210:211], v30 offset:21120
 v_cvt_pk_bf16_f32 v197, v142, v143
 v_mfma_f32_16x16x32_bf16 v[180:183], a[220:223], a[240:243], 0
 ds_read_b64_tr_b16 a[212:213], v30 offset:16928
 v_cvt_pk_bf16_f32 v193, v130, v131
 v_mfma_f32_16x16x32_bf16 v[184:187], a[220:223], a[244:247], 0
 ds_read_b64_tr_b16 a[214:215], v30 offset:21152
 s_waitcnt lgkmcnt(4)
 v_mfma_f32_16x16x32_bf16 v[60:63], a[192:195], v[204:207], v[60:63]
 ds_read_b64_tr_b16 a[216:217], v31 offset:16896
L_pad0_2517:
 s_cbranch_execz L_pad0_3584
 global_load_lds_dwordx4 v22, s[30:31] offset:2112
 v_mfma_f32_16x16x32_bf16 v[64:67], a[192:195], v[208:211], v[64:67]
 ds_read_b64_tr_b16 a[218:219], v31 offset:21120
 v_cvt_pk_bf16_f32 v190, v132, v133
 v_mfma_f32_16x16x32_bf16 v[68:71], a[196:199], v[204:207], v[68:71]
 ds_read_b64_tr_b16 a[220:221], v31 offset:16928
 v_cvt_pk_bf16_f32 v200, v144, v145
 v_mfma_f32_16x16x32_bf16 v[72:75], a[196:199], v[208:211], v[72:75]
 ds_read_b64_tr_b16 a[222:223], v31 offset:21152
 v_cvt_pk_bf16_f32 v191, v134, v135
 v_mfma_f32_16x16x32_bf16 v[76:79], a[200:203], v[204:207], v[76:79]
 ds_read_b64_tr_b16 a[192:193], v28 offset:25344
 global_load_lds_dwordx4 v23, s[30:31] offset:3168
 v_mfma_f32_16x16x32_bf16 v[80:83], a[200:203], v[208:211], v[80:83]
 ds_read_b64_tr_b16 a[194:195], v28 offset:29568
 v_cvt_pk_bf16_f32 v201, v146, v147
 v_mfma_f32_16x16x32_bf16 v[84:87], a[204:207], v[204:207], v[84:87]
 ds_read_b64_tr_b16 a[196:197], v28 offset:25376
 v_cvt_pk_bf16_f32 v194, v136, v137
 v_mfma_f32_16x16x32_bf16 v[88:91], a[204:207], v[208:211], v[88:91]
 ds_read_b64_tr_b16 a[198:199], v28 offset:29600
 s_waitcnt lgkmcnt(4)
 v_mfma_f32_16x16x32_bf16 v[92:95], a[208:211], v[204:207], v[92:95]
 ds_read_b64_tr_b16 a[200:201], v29 offset:25344
 s_add_u32 m0, s64, 12800
 v_mfma_f32_16x16x32_bf16 v[96:99], a[208:211], v[208:211], v[96:99]
 ds_read_b64_tr_b16 a[202:203], v29 offset:29568
 global_load_lds_dwordx4 v24, s[54:55] offset:-4096
 v_mfma_f32_16x16x32_bf16 v[100:103], a[212:215], v[204:207], v[100:103]
 ds_read_b64_tr_b16 a[204:205], v29 offset:25376
 v_cvt_pk_bf16_f32 v195, v138, v139
 v_mfma_f32_16x16x32_bf16 v[104:107], a[212:215], v[208:211], v[104:107]
 ds_read_b64_tr_b16 a[206:207], v29 offset:29600
 v_cvt_pk_bf16_f32 v198, v148, v149
 v_mfma_f32_16x16x32_bf16 v[108:111], a[216:219], v[204:207], v[108:111]
 ds_read_b64_tr_b16 a[208:209], v30 offset:25344
 global_load_lds_dwordx4 v25, s[54:55] offset:-3040
 v_mfma_f32_16x16x32_bf16 v[112:115], a[216:219], v[208:211], v[112:115]
 ds_read_b64_tr_b16 a[210:211], v30 offset:29568
 v_cvt_pk_bf16_f32 v199, v150, v151
 v_mfma_f32_16x16x32_bf16 v[116:119], a[220:223], v[204:207], v[116:119]
 ds_read_b64_tr_b16 a[212:213], v30 offset:25376
 v_cvt_pk_bf16_f32 v202, v152, v153
 v_mfma_f32_16x16x32_bf16 v[120:123], a[220:223], v[208:211], v[120:123]
 ds_read_b64_tr_b16 a[214:215], v30 offset:29600
 s_waitcnt lgkmcnt(4)
 v_mfma_f32_16x16x32_bf16 v[60:63], a[192:195], v[212:215], v[60:63]
 ds_read_b64_tr_b16 a[216:217], v31 offset:25344
 v_cvt_pk_bf16_f32 v204, v156, v157
 v_mfma_f32_16x16x32_bf16 v[64:67], a[192:195], v[216:219], v[64:67]
 ds_read_b64_tr_b16 a[218:219], v31 offset:29568
 global_load_lds_dwordx4 v26, s[54:55] offset:-1984
 v_mfma_f32_16x16x32_bf16 v[68:71], a[196:199], v[212:215], v[68:71]
 ds_read_b64_tr_b16 a[220:221], v31 offset:25376
 v_cvt_pk_bf16_f32 v205, v158, v159
 v_mfma_f32_16x16x32_bf16 v[72:75], a[196:199], v[216:219], v[72:75]
 ds_read_b64_tr_b16 a[222:223], v31 offset:29600
 s_waitcnt vmcnt(12)
 s_barrier
 v_mfma_f32_16x16x32_bf16 v[76:79], a[200:203], v[212:215], v[76:79]
 ds_read_b64_tr_b16 a[192:193], v28 offset:33792
 v_cvt_pk_bf16_f32 v208, v160, v161
 v_mfma_f32_16x16x32_bf16 v[80:83], a[200:203], v[216:219], v[80:83]
 ds_read_b64_tr_b16 a[194:195], v28 offset:38016
 global_load_lds_dwordx4 v27, s[54:55] offset:-928
 v_mfma_f32_16x16x32_bf16 v[84:87], a[204:207], v[212:215], v[84:87]
 ds_read_b64_tr_b16 a[196:197], v28 offset:33824
 s_add_u32 m0, s64, 12928
 v_mfma_f32_16x16x32_bf16 v[88:91], a[204:207], v[216:219], v[88:91]
 ds_read_b64_tr_b16 a[198:199], v28 offset:38048
 s_waitcnt lgkmcnt(4)
 v_mfma_f32_16x16x32_bf16 v[92:95], a[208:211], v[212:215], v[92:95]
 ds_read_b64_tr_b16 a[200:201], v29 offset:33792
 v_cvt_pk_bf16_f32 v209, v162, v163
 v_mfma_f32_16x16x32_bf16 v[96:99], a[208:211], v[216:219], v[96:99]
 ds_read_b64_tr_b16 a[202:203], v29 offset:38016
 global_load_lds_dwordx4 v24, s[54:55] offset:0
 v_mfma_f32_16x16x32_bf16 v[100:103], a[212:215], v[212:215], v[100:103]
 ds_read_b64_tr_b16 a[204:205], v29 offset:33824
 v_cvt_pk_bf16_f32 v206, v164, v165
 v_mfma_f32_16x16x32_bf16 v[104:107], a[212:215], v[216:219], v[104:107]
 ds_read_b64_tr_b16 a[206:207], v29 offset:38048
 v_cvt_pk_bf16_f32 v207, v166, v167
 v_mfma_f32_16x16x32_bf16 v[108:111], a[216:219], v[212:215], v[108:111]
 ds_read_b64_tr_b16 a[208:209], v30 offset:33792
 v_cvt_pk_bf16_f32 v210, v168, v169
 v_mfma_f32_16x16x32_bf16 v[112:115], a[216:219], v[216:219], v[112:115]
 ds_read_b64_tr_b16 a[210:211], v30 offset:38016
 v_cvt_pk_bf16_f32 v203, v154, v155
 v_mfma_f32_16x16x32_bf16 v[116:119], a[220:223], v[212:215], v[116:119]
 ds_read_b64_tr_b16 a[212:213], v30 offset:33824
 global_load_lds_dwordx4 v25, s[54:55] offset:1056
 v_mfma_f32_16x16x32_bf16 v[120:123], a[220:223], v[216:219], v[120:123]
 ds_read_b64_tr_b16 a[214:215], v30 offset:38048
 s_waitcnt lgkmcnt(4)
 v_mfma_f32_16x16x32_bf16 v[60:63], a[192:195], v[188:191], v[60:63]
 ds_read_b64_tr_b16 a[216:217], v31 offset:33792
 v_cvt_pk_bf16_f32 v212, v172, v173
 v_mfma_f32_16x16x32_bf16 v[64:67], a[192:195], v[192:195], v[64:67]
 ds_read_b64_tr_b16 a[218:219], v31 offset:38016
 v_cvt_pk_bf16_f32 v213, v174, v175
 v_mfma_f32_16x16x32_bf16 v[68:71], a[196:199], v[188:191], v[68:71]
 ds_read_b64_tr_b16 a[220:221], v31 offset:33824
 global_load_lds_dwordx4 v26, s[54:55] offset:2112
 v_mfma_f32_16x16x32_bf16 v[72:75], a[196:199], v[192:195], v[72:75]
 ds_read_b64_tr_b16 a[222:223], v31 offset:38048
 v_mfma_f32_16x16x32_bf16 v[76:79], a[200:203], v[188:191], v[76:79]
 ds_read_b64_tr_b16 a[192:193], v36 offset:0
 v_cvt_pk_bf16_f32 v216, v176, v177
 v_mfma_f32_16x16x32_bf16 v[80:83], a[200:203], v[192:195], v[80:83]
 ds_read_b64_tr_b16 a[194:195], v36 offset:4224
 v_cvt_pk_bf16_f32 v217, v178, v179
 v_mfma_f32_16x16x32_bf16 v[84:87], a[204:207], v[188:191], v[84:87]
 ds_read_b64_tr_b16 a[196:197], v36 offset:32
 global_load_lds_dwordx4 v27, s[54:55] offset:3168
 v_mfma_f32_16x16x32_bf16 v[88:91], a[204:207], v[192:195], v[88:91]
 ds_read_b64_tr_b16 a[198:199], v36 offset:4256
 s_waitcnt lgkmcnt(4)
 v_mfma_f32_16x16x32_bf16 v[92:95], a[208:211], v[188:191], v[92:95]
 ds_read_b64_tr_b16 a[200:201], v37 offset:0
 v_cvt_pk_bf16_f32 v214, v180, v181
 v_mfma_f32_16x16x32_bf16 v[96:99], a[208:211], v[192:195], v[96:99]
 ds_read_b64_tr_b16 a[202:203], v37 offset:4224
 v_cvt_pk_bf16_f32 v215, v182, v183
 v_mfma_f32_16x16x32_bf16 v[100:103], a[212:215], v[188:191], v[100:103]
 ds_read_b64_tr_b16 a[204:205], v37 offset:32
 s_add_u32 m0, s63, 0
 v_mfma_f32_16x16x32_bf16 v[104:107], a[212:215], v[192:195], v[104:107]
 ds_read_b64_tr_b16 a[206:207], v37 offset:4256
 global_load_lds_dwordx4 v20, s[26:27] offset:0
 v_mfma_f32_16x16x32_bf16 v[108:111], a[216:219], v[188:191], v[108:111]
 ds_read_b64_tr_b16 a[208:209], v38 offset:0
 v_cvt_pk_bf16_f32 v211, v170, v171
 v_mfma_f32_16x16x32_bf16 v[112:115], a[216:219], v[192:195], v[112:115]
 ds_read_b64_tr_b16 a[210:211], v38 offset:4224
 v_cvt_pk_bf16_f32 v218, v184, v185
 v_mfma_f32_16x16x32_bf16 v[116:119], a[220:223], v[188:191], v[116:119]
 ds_read_b64_tr_b16 a[212:213], v38 offset:32
 v_cvt_pk_bf16_f32 v219, v186, v187
 v_mfma_f32_16x16x32_bf16 v[120:123], a[220:223], v[192:195], v[120:123]
 ds_read_b64_tr_b16 a[214:215], v38 offset:4256
 global_load_lds_dwordx4 v21, s[26:27] offset:1056
 s_waitcnt lgkmcnt(4)
 v_mfma_f32_16x16x32_bf16 v[124:127], a[192:195], v[52:55], 0
 ds_read_b64_tr_b16 a[216:217], v39 offset:0
 v_mfma_f32_16x16x32_bf16 v[128:131], a[192:195], v[56:59], 0
 ds_read_b64_tr_b16 a[218:219], v39 offset:4224
 v_mfma_f32_16x16x32_bf16 v[132:135], a[196:199], v[52:55], 0
 ds_read_b64_tr_b16 a[220:221], v39 offset:32
 v_mfma_f32_16x16x32_bf16 v[136:139], a[196:199], v[56:59], 0
 ds_read_b64_tr_b16 a[222:223], v39 offset:4256
 global_load_lds_dwordx4 v22, s[26:27] offset:2112
 v_mfma_f32_16x16x32_bf16 v[140:143], a[200:203], v[52:55], 0
 ds_read_b64_tr_b16 a[192:193], v28 offset:42240
 v_mfma_f32_16x16x32_bf16 v[144:147], a[200:203], v[56:59], 0
 ds_read_b64_tr_b16 a[194:195], v28 offset:46464
 v_mfma_f32_16x16x32_bf16 v[148:151], a[204:207], v[52:55], 0
 ds_read_b64_tr_b16 a[196:197], v28 offset:42272
 v_mfma_f32_16x16x32_bf16 v[152:155], a[204:207], v[56:59], 0
 ds_read_b64_tr_b16 a[198:199], v28 offset:46496
 global_load_lds_dwordx4 v23, s[26:27] offset:3168
 s_waitcnt lgkmcnt(4)
 v_mfma_f32_16x16x32_bf16 v[156:159], a[208:211], v[52:55], 0
 ds_read_b64_tr_b16 a[200:201], v29 offset:42240
 v_cvt_pk_bf16_f32 v4, v124, v125
 v_mfma_f32_16x16x32_bf16 v[160:163], a[208:211], v[56:59], 0
 ds_read_b64_tr_b16 a[202:203], v29 offset:46464
 v_cvt_pk_bf16_f32 v5, v126, v127
 v_mfma_f32_16x16x32_bf16 v[164:167], a[212:215], v[52:55], 0
 ds_read_b64_tr_b16 a[204:205], v29 offset:42272
 v_cvt_pk_bf16_f32 v8, v128, v129
 v_mfma_f32_16x16x32_bf16 v[168:171], a[212:215], v[56:59], 0
 ds_read_b64_tr_b16 a[206:207], v29 offset:46496
 v_cvt_pk_bf16_f32 v9, v130, v131
 v_mfma_f32_16x16x32_bf16 v[172:175], a[216:219], v[52:55], 0
 ds_read_b64_tr_b16 a[208:209], v30 offset:42240
 v_cvt_pk_bf16_f32 v12, v140, v141
 v_mfma_f32_16x16x32_bf16 v[176:179], a[216:219], v[56:59], 0
 ds_read_b64_tr_b16 a[210:211], v30 offset:46464
 v_cvt_pk_bf16_f32 v13, v142, v143
 v_mfma_f32_16x16x32_bf16 v[180:183], a[220:223], v[52:55], 0
 ds_read_b64_tr_b16 a[212:213], v30 offset:42272
 v_cvt_pk_bf16_f32 v16, v144, v145
 v_mfma_f32_16x16x32_bf16 v[184:187], a[220:223], v[56:59], 0
 ds_read_b64_tr_b16 a[214:215], v30 offset:46496
 s_waitcnt lgkmcnt(4)
 v_mfma_f32_16x16x32_bf16 v[60:63], a[192:195], v[196:199], v[60:63]
 ds_read_b64_tr_b16 a[216:217], v31 offset:42240
 s_add_u32 m0, s64, 4096
 v_mfma_f32_16x16x32_bf16 v[64:67], a[192:195], v[200:203], v[64:67]
 ds_read_b64_tr_b16 a[218:219], v31 offset:46464
 global_load_lds_dwordx4 v24, s[52:53] offset:-4096
 v_mfma_f32_16x16x32_bf16 v[68:71], a[196:199], v[196:199], v[68:71]
 ds_read_b64_tr_b16 a[220:221], v31 offset:42272
 v_cvt_pk_bf16_f32 v0, v156, v157
 v_mfma_f32_16x16x32_bf16 v[72:75], a[196:199], v[200:203], v[72:75]
 ds_read_b64_tr_b16 a[222:223], v31 offset:46496
 s_waitcnt vmcnt(13)
 s_barrier
 v_mfma_f32_16x16x32_bf16 v[76:79], a[200:203], v[196:199], v[76:79]
 ds_read_b64_tr_b16 a[192:193], v32 offset:0
 global_load_lds_dwordx4 v25, s[52:53] offset:-3040
 v_mfma_f32_16x16x32_bf16 v[80:83], a[200:203], v[200:203], v[80:83]
 ds_read_b64_tr_b16 a[194:195], v32 offset:4224
 ds_read_b64_tr_b16 a[0:1], v32 offset:16896
 v_mfma_f32_16x16x32_bf16 v[84:87], a[204:207], v[196:199], v[84:87]
 ds_read_b64_tr_b16 a[196:197], v32 offset:32
 v_cvt_pk_bf16_f32 v52, v172, v173
 v_mfma_f32_16x16x32_bf16 v[88:91], a[204:207], v[200:203], v[88:91]
 ds_read_b64_tr_b16 a[198:199], v32 offset:4256
 global_load_lds_dwordx4 v26, s[52:53] offset:-1984
 s_waitcnt lgkmcnt(5)
 v_mfma_f32_16x16x32_bf16 v[92:95], a[208:211], v[196:199], v[92:95]
 ds_read_b64_tr_b16 a[200:201], v33 offset:0
 ds_read_b64_tr_b16 a[2:3], v32 offset:21120
 v_mfma_f32_16x16x32_bf16 v[96:99], a[208:211], v[200:203], v[96:99]
 ds_read_b64_tr_b16 a[202:203], v33 offset:4224
 v_cvt_pk_bf16_f32 v1, v158, v159
 v_mfma_f32_16x16x32_bf16 v[100:103], a[212:215], v[196:199], v[100:103]
 ds_read_b64_tr_b16 a[204:205], v33 offset:32
 buffer_load_dword v43, v41, s[32:35], s73 offen offset:4 sc1
 v_mfma_f32_16x16x32_bf16 v[104:107], a[212:215], v[200:203], v[104:107]
 ds_read_b64_tr_b16 a[206:207], v33 offset:4256
 v_cvt_pk_bf16_f32 v53, v174, v175
 v_mfma_f32_16x16x32_bf16 v[108:111], a[216:219], v[196:199], v[108:111]
 ds_read_b64_tr_b16 a[208:209], v34 offset:0
 ds_read_b64_tr_b16 a[4:5], v32 offset:16928
 v_mfma_f32_16x16x32_bf16 v[112:115], a[216:219], v[200:203], v[112:115]
 ds_read_b64_tr_b16 a[210:211], v34 offset:4224
 global_load_lds_dwordx4 v27, s[52:53] offset:-928
 v_mfma_f32_16x16x32_bf16 v[116:119], a[220:223], v[196:199], v[116:119]
 ds_read_b64_tr_b16 a[212:213], v34 offset:32
 s_add_u32 m0, s64, 4224
 v_mfma_f32_16x16x32_bf16 v[120:123], a[220:223], v[200:203], v[120:123]
 ds_read_b64_tr_b16 a[214:215], v34 offset:4256
 s_waitcnt lgkmcnt(5)
 v_mfma_f32_16x16x32_bf16 v[60:63], a[192:195], v[204:207], v[60:63]
 ds_read_b64_tr_b16 a[216:217], v35 offset:0
 global_load_lds_dwordx4 v24, s[52:53] offset:0
 v_mfma_f32_16x16x32_bf16 v[64:67], a[192:195], v[208:211], v[64:67]
 ds_read_b64_tr_b16 a[218:219], v35 offset:4224
 v_cvt_pk_bf16_f32 v6, v132, v133
 v_mfma_f32_16x16x32_bf16 v[68:71], a[196:199], v[204:207], v[68:71]
 ds_read_b64_tr_b16 a[220:221], v35 offset:32
 v_cvt_pk_bf16_f32 v252, v160, v161
 v_mfma_f32_16x16x32_bf16 v[72:75], a[196:199], v[208:211], v[72:75]
 ds_read_b64_tr_b16 a[222:223], v35 offset:4256
 global_load_lds_dwordx4 v25, s[52:53] offset:1056
 v_mfma_f32_16x16x32_bf16 v[76:79], a[200:203], v[204:207], v[76:79]
 ds_read_b64_tr_b16 a[192:193], v32 offset:8448
 v_cvt_pk_bf16_f32 v17, v146, v147
 v_mfma_f32_16x16x32_bf16 v[80:83], a[200:203], v[208:211], v[80:83]
 ds_read_b64_tr_b16 a[194:195], v32 offset:12672
 ds_read_b64_tr_b16 a[6:7], v32 offset:21152
 v_mfma_f32_16x16x32_bf16 v[84:87], a[204:207], v[204:207], v[84:87]
 ds_read_b64_tr_b16 a[196:197], v32 offset:8480
 global_load_lds_dwordx4 v26, s[52:53] offset:2112
 v_mfma_f32_16x16x32_bf16 v[88:91], a[204:207], v[208:211], v[88:91]
 ds_read_b64_tr_b16 a[198:199], v32 offset:12704
 s_waitcnt lgkmcnt(5)
 v_mfma_f32_16x16x32_bf16 v[92:95], a[208:211], v[204:207], v[92:95]
 ds_read_b64_tr_b16 a[200:201], v33 offset:8448
 v_cvt_pk_bf16_f32 v7, v134, v135
 v_mfma_f32_16x16x32_bf16 v[96:99], a[208:211], v[208:211], v[96:99]
L_pad0_2781:
 s_cbranch_execz L_pad0_3774
 ds_read_b64_tr_b16 a[202:203], v33 offset:12672
 global_load_lds_dwordx4 v27, s[52:53] offset:3168
 v_mfma_f32_16x16x32_bf16 v[100:103], a[212:215], v[204:207], v[100:103]
 ds_read_b64_tr_b16 a[204:205], v33 offset:8480
 v_cvt_pk_bf16_f32 v56, v176, v177
 v_mfma_f32_16x16x32_bf16 v[104:107], a[212:215], v[208:211], v[104:107]
 ds_read_b64_tr_b16 a[206:207], v33 offset:12704
 v_cvt_pk_bf16_f32 v14, v148, v149
 v_mfma_f32_16x16x32_bf16 v[108:111], a[216:219], v[204:207], v[108:111]
 ds_read_b64_tr_b16 a[208:209], v34 offset:8448
 v_cvt_pk_bf16_f32 v253, v162, v163
 v_mfma_f32_16x16x32_bf16 v[112:115], a[216:219], v[208:211], v[112:115]
 ds_read_b64_tr_b16 a[210:211], v34 offset:12672
 s_add_u32 m0, s63, 16896
 v_mfma_f32_16x16x32_bf16 v[116:119], a[220:223], v[204:207], v[116:119]
 ds_read_b64_tr_b16 a[212:213], v34 offset:8480
 global_load_lds_dwordx4 v20, s[22:23] offset:0
 v_mfma_f32_16x16x32_bf16 v[120:123], a[220:223], v[208:211], v[120:123]
 ds_read_b64_tr_b16 a[214:215], v34 offset:12704
 s_waitcnt lgkmcnt(4)
 v_mfma_f32_16x16x32_bf16 v[60:63], a[192:195], v[212:215], v[60:63]
 ds_read_b64_tr_b16 a[216:217], v35 offset:8448
 v_accvgpr_write_b32 a224, -1
 v_mfma_f32_16x16x32_bf16 v[64:67], a[192:195], v[216:219], v[64:67]
 ds_read_b64_tr_b16 a[218:219], v35 offset:12672
 ds_read_b64_tr_b16 a[8:9], v32 offset:25344
 v_mfma_f32_16x16x32_bf16 v[68:71], a[196:199], v[212:215], v[68:71]
 ds_read_b64_tr_b16 a[220:221], v35 offset:8480
 global_load_lds_dwordx4 v21, s[22:23] offset:1056
 v_mfma_f32_16x16x32_bf16 v[72:75], a[196:199], v[216:219], v[72:75]
 ds_read_b64_tr_b16 a[222:223], v35 offset:12704
 v_cvt_pk_bf16_f32 v10, v136, v137
 v_mfma_f32_16x16x32_bf16 v[76:79], a[200:203], v[212:215], v[76:79]
 ds_read_b64_tr_b16 a[192:193], v33 offset:16896
 v_cvt_pk_bf16_f32 v15, v150, v151
 v_mfma_f32_16x16x32_bf16 v[80:83], a[200:203], v[216:219], v[80:83]
 ds_read_b64_tr_b16 a[194:195], v33 offset:21120
 v_cvt_pk_bf16_f32 v57, v178, v179
 v_mfma_f32_16x16x32_bf16 v[84:87], a[204:207], v[212:215], v[84:87]
 ds_read_b64_tr_b16 a[196:197], v33 offset:16928
 global_load_lds_dwordx4 v22, s[22:23] offset:2112
 v_mfma_f32_16x16x32_bf16 v[88:91], a[204:207], v[216:219], v[88:91]
 ds_read_b64_tr_b16 a[198:199], v33 offset:21152
 s_waitcnt lgkmcnt(4)
 v_mfma_f32_16x16x32_bf16 v[92:95], a[208:211], v[212:215], v[92:95]
 ds_read_b64_tr_b16 a[200:201], v34 offset:16896
 v_cvt_pk_bf16_f32 v2, v164, v165
 v_mfma_f32_16x16x32_bf16 v[96:99], a[208:211], v[216:219], v[96:99]
 ds_read_b64_tr_b16 a[202:203], v34 offset:21120
 ds_read_b64_tr_b16 a[10:11], v32 offset:29568
 v_mfma_f32_16x16x32_bf16 v[100:103], a[212:215], v[212:215], v[100:103]
 ds_read_b64_tr_b16 a[204:205], v34 offset:16928
 global_load_lds_dwordx4 v23, s[22:23] offset:3168
 v_mfma_f32_16x16x32_bf16 v[104:107], a[212:215], v[216:219], v[104:107]
 ds_read_b64_tr_b16 a[206:207], v34 offset:21152
 s_waitcnt vmcnt(9)
 v_cmp_ne_u32 vcc, 1, v43
 s_cbranch_vccnz L_slow0b
L_back0b:
 v_mfma_f32_16x16x32_bf16 v[108:111], a[216:219], v[212:215], v[108:111]
 ds_read_b64_tr_b16 a[208:209], v35 offset:16896
 s_xor_b32 s66, s72, 0x6000
 v_mfma_f32_16x16x32_bf16 v[112:115], a[216:219], v[216:219], v[112:115]
 ds_read_b64_tr_b16 a[210:211], v35 offset:21120
 s_add_u32 s86, s32, s66
 s_addc_u32 s87, s33, 0
 v_mfma_f32_16x16x32_bf16 v[116:119], a[220:223], v[212:215], v[116:119]
 ds_read_b64_tr_b16 a[212:213], v35 offset:16928
 global_load_dwordx4 a[128:131], v40, s[86:87] offset:0 sc1
 v_cvt_pk_bf16_f32 v11, v138, v139
 v_mfma_f32_16x16x32_bf16 v[120:123], a[220:223], v[216:219], v[120:123]
 ds_read_b64_tr_b16 a[214:215], v35 offset:21152
 s_waitcnt lgkmcnt(4)
 v_mfma_f32_16x16x32_bf16 v[76:79], a[192:195], v[4:7], v[76:79]
 ds_read_b64_tr_b16 a[216:217], v33 offset:25344
 v_cvt_pk_bf16_f32 v18, v152, v153
 v_mfma_f32_16x16x32_bf16 v[80:83], a[192:195], v[8:11], v[80:83]
 ds_read_b64_tr_b16 a[218:219], v33 offset:29568
 global_load_dwordx4 a[132:135], v40, s[86:87] offset:1024 sc1
 v_mfma_f32_16x16x32_bf16 v[84:87], a[196:199], v[4:7], v[84:87]
 ds_read_b64_tr_b16 a[220:221], v33 offset:25376
 s_xor_b32 s66, s72, 0xa000
 v_mfma_f32_16x16x32_bf16 v[88:91], a[196:199], v[8:11], v[88:91]
 ds_read_b64_tr_b16 a[222:223], v33 offset:29600
 s_add_u32 s86, s32, s66
 s_addc_u32 s87, s33, 0
 ds_read_b64_tr_b16 a[12:13], v32 offset:25376
 v_mfma_f32_16x16x32_bf16 v[92:95], a[200:203], v[4:7], v[92:95]
 ds_read_b64_tr_b16 a[192:193], v34 offset:25344
 global_load_dwordx4 a[136:139], v40, s[86:87] offset:0 sc1
 v_mfma_f32_16x16x32_bf16 v[96:99], a[200:203], v[8:11], v[96:99]
 ds_read_b64_tr_b16 a[194:195], v34 offset:29568
 v_cvt_pk_bf16_f32 v3, v166, v167
 v_cvt_pk_bf16_f32 v54, v180, v181
 v_mfma_f32_16x16x32_bf16 v[100:103], a[204:207], v[4:7], v[100:103]
 ds_read_b64_tr_b16 a[196:197], v34 offset:25376
 ds_read_b64_tr_b16 a[14:15], v32 offset:29600
 v_mfma_f32_16x16x32_bf16 v[104:107], a[204:207], v[8:11], v[104:107]
 ds_read_b64_tr_b16 a[198:199], v34 offset:29600
 global_load_dwordx4 a[140:143], v40, s[86:87] offset:1024 sc1
 s_waitcnt lgkmcnt(6)
 v_mfma_f32_16x16x32_bf16 v[108:111], a[208:211], v[4:7], v[108:111]
 ds_read_b64_tr_b16 a[200:201], v35 offset:25344
 s_xor_b32 s66, s72, 0xe000
 v_mfma_f32_16x16x32_bf16 v[112:115], a[208:211], v[8:11], v[112:115]
 ds_read_b64_tr_b16 a[202:203], v35 offset:29568
 s_add_u32 s86, s32, s66
 s_addc_u32 s87, s33, 0
 v_mfma_f32_16x16x32_bf16 v[116:119], a[212:215], v[4:7], v[116:119]
 ds_read_b64_tr_b16 a[204:205], v35 offset:25376
 global_load_dwordx4 a[144:147], v40, s[86:87] offset:0 sc1
 v_cvt_pk_bf16_f32 v19, v154, v155
 v_mfma_f32_16x16x32_bf16 v[120:123], a[212:215], v[8:11], v[120:123]
 ds_read_b64_tr_b16 a[206:207], v35 offset:29600
 s_barrier
 v_mfma_f32_16x16x32_bf16 v[76:79], a[216:219], v[12:15], v[76:79]
 ds_read_b64_tr_b16 a[208:209], v29 offset:0
 v_cvt_pk_bf16_f32 v254, v168, v169
 v_mfma_f32_16x16x32_bf16 v[80:83], a[216:219], v[16:19], v[80:83]
 ds_read_b64_tr_b16 a[210:211], v29 offset:4224
 global_load_dwordx4 a[148:151], v40, s[86:87] offset:1024 sc1
 v_mfma_f32_16x16x32_bf16 v[84:87], a[220:223], v[12:15], v[84:87]
 ds_read_b64_tr_b16 a[212:213], v29 offset:32
 v_cvt_pk_bf16_f32 v55, v182, v183
 v_mfma_f32_16x16x32_bf16 v[88:91], a[220:223], v[16:19], v[88:91]
 ds_read_b64_tr_b16 a[214:215], v29 offset:4256
 s_add_u32 m0, s63, 33792
 ds_read_b64_tr_b16 a[16:17], v28 offset:0
 s_waitcnt lgkmcnt(5)
 v_mfma_f32_16x16x32_bf16 v[92:95], a[192:195], v[12:15], v[92:95]
 ds_read_b64_tr_b16 a[216:217], v30 offset:0
 global_load_lds_dwordx4 v20, s[18:19] offset:0
 v_mfma_f32_16x16x32_bf16 v[96:99], a[192:195], v[16:19], v[96:99]
 ds_read_b64_tr_b16 a[218:219], v30 offset:4224
 ds_read_b64_tr_b16 a[18:19], v28 offset:4224
 v_mfma_f32_16x16x32_bf16 v[100:103], a[196:199], v[12:15], v[100:103]
 ds_read_b64_tr_b16 a[220:221], v30 offset:32
 ds_read_b64_tr_b16 a[20:21], v28 offset:32
 v_mfma_f32_16x16x32_bf16 v[104:107], a[196:199], v[16:19], v[104:107]
 ds_read_b64_tr_b16 a[222:223], v30 offset:4256
 global_load_lds_dwordx4 v21, s[18:19] offset:1056
 v_mfma_f32_16x16x32_bf16 v[108:111], a[200:203], v[12:15], v[108:111]
 ds_read_b64_tr_b16 a[192:193], v31 offset:0
 v_cvt_pk_bf16_f32 v255, v170, v171
 v_mfma_f32_16x16x32_bf16 v[112:115], a[200:203], v[16:19], v[112:115]
 ds_read_b64_tr_b16 a[194:195], v31 offset:4224
 ds_read_b64_tr_b16 a[22:23], v28 offset:4256
 v_mfma_f32_16x16x32_bf16 v[116:119], a[204:207], v[12:15], v[116:119]
 ds_read_b64_tr_b16 a[196:197], v31 offset:32
 v_cvt_pk_bf16_f32 v58, v184, v185
 v_mfma_f32_16x16x32_bf16 v[120:123], a[204:207], v[16:19], v[120:123]
 ds_read_b64_tr_b16 a[198:199], v31 offset:4256
 s_waitcnt lgkmcnt(5)
 v_mfma_f32_16x16x32_bf16 v[76:79], a[208:211], v[0:3], v[76:79]
 ds_read_b64_tr_b16 a[200:201], v29 offset:8448
 global_load_lds_dwordx4 v22, s[18:19] offset:2112
 v_mfma_f32_16x16x32_bf16 v[80:83], a[208:211], v[252:255], v[80:83]
 ds_read_b64_tr_b16 a[202:203], v29 offset:12672
 ds_read_b64_tr_b16 a[24:25], v28 offset:8448
 v_mfma_f32_16x16x32_bf16 v[84:87], a[212:215], v[0:3], v[84:87]
 ds_read_b64_tr_b16 a[204:205], v29 offset:8480
 v_accvgpr_write_b32 a225, -1
 v_mfma_f32_16x16x32_bf16 v[88:91], a[212:215], v[252:255], v[88:91]
 ds_read_b64_tr_b16 a[206:207], v29 offset:12704
 ds_read_b64_tr_b16 a[26:27], v28 offset:12672
 v_mfma_f32_16x16x32_bf16 v[92:95], a[216:219], v[0:3], v[92:95]
 ds_read_b64_tr_b16 a[208:209], v30 offset:8448
 global_load_lds_dwordx4 v23, s[18:19] offset:3168
 v_mfma_f32_16x16x32_bf16 v[96:99], a[216:219], v[252:255], v[96:99]
 ds_read_b64_tr_b16 a[210:211], v30 offset:12672
 ds_read_b64_tr_b16 a[28:29], v28 offset:8480
 v_mfma_f32_16x16x32_bf16 v[100:103], a[220:223], v[0:3], v[100:103]
 ds_read_b64_tr_b16 a[212:213], v30 offset:8480
 ds_read_b64_tr_b16 a[30:31], v28 offset:12704
 v_mfma_f32_16x16x32_bf16 v[104:107], a[220:223], v[252:255], v[104:107]
 ds_read_b64_tr_b16 a[214:215], v30 offset:12704
 s_waitcnt lgkmcnt(7)
 v_mfma_f32_16x16x32_bf16 v[108:111], a[192:195], v[0:3], v[108:111]
 ds_read_b64_tr_b16 a[216:217], v31 offset:8448
 s_add_u32 m0, s63, 50688
 v_mfma_f32_16x16x32_bf16 v[112:115], a[192:195], v[252:255], v[112:115]
 ds_read_b64_tr_b16 a[218:219], v31 offset:12672
 global_load_lds_dwordx4 v20, s[14:15] offset:0
 v_mfma_f32_16x16x32_bf16 v[116:119], a[196:199], v[0:3], v[116:119]
 ds_read_b64_tr_b16 a[220:221], v31 offset:8480
 v_cvt_pk_bf16_f32 v59, v186, v187
 v_mfma_f32_16x16x32_bf16 v[120:123], a[196:199], v[252:255], v[120:123]
 ds_read_b64_tr_b16 a[222:223], v31 offset:12704
 v_mfma_f32_16x16x32_bf16 v[76:79], a[200:203], v[52:55], v[76:79]
 ds_read_b64_tr_b16 a[192:193], v36 offset:8704
 v_accvgpr_write_b32 a226, -1
 v_mfma_f32_16x16x32_bf16 v[80:83], a[200:203], v[56:59], v[80:83]
 ds_read_b64_tr_b16 a[194:195], v36 offset:12928
 v_accvgpr_write_b32 a227, -1
 v_mfma_f32_16x16x32_bf16 v[84:87], a[204:207], v[52:55], v[84:87]
 ds_read_b64_tr_b16 a[196:197], v36 offset:8736
 v_mfma_f32_16x16x32_bf16 v[88:91], a[204:207], v[56:59], v[88:91]
 ds_read_b64_tr_b16 a[198:199], v36 offset:12960
 s_waitcnt lgkmcnt(4)
 v_mfma_f32_16x16x32_bf16 v[92:95], a[208:211], v[52:55], v[92:95]
 ds_read_b64_tr_b16 a[200:201], v37 offset:8704
 v_mfma_f32_16x16x32_bf16 v[96:99], a[208:211], v[56:59], v[96:99]
 ds_read_b64_tr_b16 a[202:203], v37 offset:12928
 v_mfma_f32_16x16x32_bf16 v[100:103], a[212:215], v[52:55], v[100:103]
 ds_read_b64_tr_b16 a[204:205], v37 offset:8736
 v_mfma_f32_16x16x32_bf16 v[104:107], a[212:215], v[56:59], v[104:107]
 ds_read_b64_tr_b16 a[206:207], v37 offset:12960
 v_mfma_f32_16x16x32_bf16 v[108:111], a[216:219], v[52:55], v[108:111]
 ds_read_b64_tr_b16 a[208:209], v38 offset:8704
 v_mfma_f32_16x16x32_bf16 v[112:115], a[216:219], v[56:59], v[112:115]
 ds_read_b64_tr_b16 a[210:211], v38 offset:12928
 v_mfma_f32_16x16x32_bf16 v[116:119], a[220:223], v[52:55], v[116:119]
 ds_read_b64_tr_b16 a[212:213], v38 offset:8736
 v_mfma_f32_16x16x32_bf16 v[120:123], a[220:223], v[56:59], v[120:123]
 ds_read_b64_tr_b16 a[214:215], v38 offset:12960
 s_waitcnt lgkmcnt(4)
 s_waitcnt vmcnt(10)
 v_mfma_f32_16x16x32_bf16 v[124:127], a[192:195], a[128:131], 0
 ds_read_b64_tr_b16 a[216:217], v39 offset:8704
 global_load_lds_dwordx4 v21, s[14:15] offset:1056
 s_waitcnt vmcnt(10)
 v_mfma_f32_16x16x32_bf16 v[128:131], a[192:195], a[132:135], 0
 ds_read_b64_tr_b16 a[218:219], v39 offset:12928
 v_mfma_f32_16x16x32_bf16 v[132:135], a[196:199], a[128:131], 0
 ds_read_b64_tr_b16 a[220:221], v39 offset:8736
 v_mfma_f32_16x16x32_bf16 v[136:139], a[196:199], a[132:135], 0
 ds_read_b64_tr_b16 a[222:223], v39 offset:12960
 global_load_lds_dwordx4 v22, s[14:15] offset:2112
 s_barrier
 v_mfma_f32_16x16x32_bf16 v[140:143], a[200:203], a[128:131], 0
 ds_read_b64_tr_b16 a[192:193], v29 offset:16896
 ds_read_b64_tr_b16 a[32:33], v28 offset:16896
 v_mfma_f32_16x16x32_bf16 v[144:147], a[200:203], a[132:135], 0
 ds_read_b64_tr_b16 a[194:195], v29 offset:21120
 ds_read_b64_tr_b16 a[34:35], v28 offset:21120
 v_mfma_f32_16x16x32_bf16 v[148:151], a[204:207], a[128:131], 0
 ds_read_b64_tr_b16 a[196:197], v29 offset:16928
 global_load_lds_dwordx4 v23, s[14:15] offset:3168
 v_mfma_f32_16x16x32_bf16 v[152:155], a[204:207], a[132:135], 0
 ds_read_b64_tr_b16 a[198:199], v29 offset:21152
 s_add_u32 m0, s63, 67584
 s_waitcnt lgkmcnt(6)
 v_mfma_f32_16x16x32_bf16 v[156:159], a[208:211], a[128:131], 0
 ds_read_b64_tr_b16 a[200:201], v30 offset:16896
 v_cvt_pk_bf16_f32 v220, v124, v125
 v_cvt_pk_bf16_f32 v221, v126, v127
 v_mfma_f32_16x16x32_bf16 v[160:163], a[208:211], a[132:135], 0
 ds_read_b64_tr_b16 a[202:203], v30 offset:21120
 global_load_lds_dwordx4 v20, s[10:11] offset:0
 v_cvt_pk_bf16_f32 v224, v128, v129
 v_mfma_f32_16x16x32_bf16 v[164:167], a[212:215], a[128:131], 0
 ds_read_b64_tr_b16 a[204:205], v30 offset:16928
 v_cvt_pk_bf16_f32 v225, v130, v131
 v_mfma_f32_16x16x32_bf16 v[168:171], a[212:215], a[132:135], 0
 ds_read_b64_tr_b16 a[206:207], v30 offset:21152
 v_cvt_pk_bf16_f32 v222, v132, v133
 v_mfma_f32_16x16x32_bf16 v[172:175], a[216:219], a[128:131], 0
 ds_read_b64_tr_b16 a[208:209], v31 offset:16896
 global_load_lds_dwordx4 v21, s[10:11] offset:1056
 ds_read_b64_tr_b16 a[36:37], v28 offset:16928
 v_cvt_pk_bf16_f32 v223, v134, v135
 v_mfma_f32_16x16x32_bf16 v[176:179], a[216:219], a[132:135], 0
 ds_read_b64_tr_b16 a[210:211], v31 offset:21120
 v_cvt_pk_bf16_f32 v226, v136, v137
 v_mfma_f32_16x16x32_bf16 v[180:183], a[220:223], a[128:131], 0
 ds_read_b64_tr_b16 a[212:213], v31 offset:16928
 v_cvt_pk_bf16_f32 v228, v140, v141
 v_cvt_pk_bf16_f32 v227, v138, v139
L_pad0_3049:
 s_cbranch_execz L_ret0_1
 v_mfma_f32_16x16x32_bf16 v[184:187], a[220:223], a[132:135], 0
 ds_read_b64_tr_b16 a[214:215], v31 offset:21152
 global_load_lds_dwordx4 v22, s[10:11] offset:2112
 ds_read_b64_tr_b16 a[38:39], v28 offset:21152
 s_waitcnt lgkmcnt(6)
 v_mfma_f32_16x16x32_bf16 v[76:79], a[192:195], v[220:223], v[76:79]
 ds_read_b64_tr_b16 a[216:217], v29 offset:25344
 v_cvt_pk_bf16_f32 v229, v142, v143
 v_mfma_f32_16x16x32_bf16 v[80:83], a[192:195], v[224:227], v[80:83]
 ds_read_b64_tr_b16 a[218:219], v29 offset:29568
 ds_read_b64_tr_b16 a[40:41], v28 offset:25344
 v_mfma_f32_16x16x32_bf16 v[84:87], a[196:199], v[220:223], v[84:87]
 ds_read_b64_tr_b16 a[220:221], v29 offset:25376
 global_load_lds_dwordx4 v23, s[10:11] offset:3168
 v_cvt_pk_bf16_f32 v232, v144, v145
 v_mfma_f32_16x16x32_bf16 v[88:91], a[196:199], v[224:227], v[88:91]
 ds_read_b64_tr_b16 a[222:223], v29 offset:29600
 s_add_u32 m0, s64, 12800
 v_cvt_pk_bf16_f32 v236, v156, v157
 v_cvt_pk_bf16_f32 v233, v146, v147
 v_mfma_f32_16x16x32_bf16 v[92:95], a[200:203], v[220:223], v[92:95]
 ds_read_b64_tr_b16 a[192:193], v30 offset:25344
 ds_read_b64_tr_b16 a[42:43], v28 offset:29568
 v_mfma_f32_16x16x32_bf16 v[96:99], a[200:203], v[224:227], v[96:99]
 ds_read_b64_tr_b16 a[194:195], v30 offset:29568
 global_load_lds_dwordx4 v24, s[50:51] offset:-4096
 v_cvt_pk_bf16_f32 v230, v148, v149
 v_mfma_f32_16x16x32_bf16 v[100:103], a[204:207], v[220:223], v[100:103]
 ds_read_b64_tr_b16 a[196:197], v30 offset:25376
 v_cvt_pk_bf16_f32 v237, v158, v159
 v_mfma_f32_16x16x32_bf16 v[104:107], a[204:207], v[224:227], v[104:107]
 ds_read_b64_tr_b16 a[198:199], v30 offset:29600
 ds_read_b64_tr_b16 a[44:45], v28 offset:25376
 v_cvt_pk_bf16_f32 v231, v150, v151
 s_waitcnt lgkmcnt(6)
 v_mfma_f32_16x16x32_bf16 v[108:111], a[208:211], v[220:223], v[108:111]
 ds_read_b64_tr_b16 a[200:201], v31 offset:25344
 global_load_lds_dwordx4 v25, s[50:51] offset:-3040
 v_mfma_f32_16x16x32_bf16 v[112:115], a[208:211], v[224:227], v[112:115]
 ds_read_b64_tr_b16 a[202:203], v31 offset:29568
 v_cvt_pk_bf16_f32 v234, v152, v153
 v_cvt_pk_bf16_f32 v240, v160, v161
 ds_read_b64_tr_b16 a[46:47], v28 offset:29600
 v_mfma_f32_16x16x32_bf16 v[116:119], a[212:215], v[220:223], v[116:119]
 ds_read_b64_tr_b16 a[204:205], v31 offset:25376
 v_cvt_pk_bf16_f32 v244, v172, v173
 v_cvt_pk_bf16_f32 v235, v154, v155
 v_mfma_f32_16x16x32_bf16 v[120:123], a[212:215], v[224:227], v[120:123]
 ds_read_b64_tr_b16 a[206:207], v31 offset:29600
 global_load_lds_dwordx4 v26, s[50:51] offset:-1984
 v_cvt_pk_bf16_f32 v241, v162, v163
 s_waitcnt vmcnt(11)
 s_barrier
 v_mfma_f32_16x16x32_bf16 v[76:79], a[216:219], v[228:231], v[76:79]
 ds_read_b64_tr_b16 a[208:209], v29 offset:33792
 v_cvt_pk_bf16_f32 v238, v164, v165
 v_mfma_f32_16x16x32_bf16 v[80:83], a[216:219], v[232:235], v[80:83]
 ds_read_b64_tr_b16 a[210:211], v29 offset:38016
 v_cvt_pk_bf16_f32 v245, v174, v175
 v_mfma_f32_16x16x32_bf16 v[84:87], a[220:223], v[228:231], v[84:87]
 ds_read_b64_tr_b16 a[212:213], v29 offset:33824
 global_load_lds_dwordx4 v27, s[50:51] offset:-928
 v_mfma_f32_16x16x32_bf16 v[88:91], a[220:223], v[232:235], v[88:91]
 ds_read_b64_tr_b16 a[214:215], v29 offset:38048
 s_add_u32 m0, s64, 12928
 s_waitcnt lgkmcnt(4)
 v_mfma_f32_16x16x32_bf16 v[92:95], a[192:195], v[228:231], v[92:95]
 ds_read_b64_tr_b16 a[216:217], v30 offset:33792
 v_cvt_pk_bf16_f32 v239, v166, v167
 v_mfma_f32_16x16x32_bf16 v[96:99], a[192:195], v[232:235], v[96:99]
 ds_read_b64_tr_b16 a[218:219], v30 offset:38016
 global_load_lds_dwordx4 v24, s[50:51] offset:0
 ds_read_b64_tr_b16 a[48:49], v28 offset:33792
 v_mfma_f32_16x16x32_bf16 v[100:103], a[196:199], v[228:231], v[100:103]
 ds_read_b64_tr_b16 a[220:221], v30 offset:33824
 v_cvt_pk_bf16_f32 v242, v168, v169
 v_mfma_f32_16x16x32_bf16 v[104:107], a[196:199], v[232:235], v[104:107]
 ds_read_b64_tr_b16 a[222:223], v30 offset:38048
 v_cvt_pk_bf16_f32 v248, v176, v177
 v_mfma_f32_16x16x32_bf16 v[108:111], a[200:203], v[228:231], v[108:111]
 ds_read_b64_tr_b16 a[192:193], v31 offset:33792
 global_load_lds_dwordx4 v25, s[50:51] offset:1056
 v_mfma_f32_16x16x32_bf16 v[112:115], a[200:203], v[232:235], v[112:115]
 ds_read_b64_tr_b16 a[194:195], v31 offset:38016
 ds_read_b64_tr_b16 a[50:51], v28 offset:38016
 v_mfma_f32_16x16x32_bf16 v[116:119], a[204:207], v[228:231], v[116:119]
 ds_read_b64_tr_b16 a[196:197], v31 offset:33824
 v_cvt_pk_bf16_f32 v243, v170, v171
 v_mfma_f32_16x16x32_bf16 v[120:123], a[204:207], v[232:235], v[120:123]
 ds_read_b64_tr_b16 a[198:199], v31 offset:38048
 global_load_lds_dwordx4 v26, s[50:51] offset:2112
 s_waitcnt vmcnt(11)
 s_barrier
 s_waitcnt lgkmcnt(5)
 v_mfma_f32_16x16x32_bf16 v[76:79], a[208:211], v[236:239], v[76:79]
 ds_read_b64_tr_b16 a[200:201], v36 offset:0
 v_cvt_pk_bf16_f32 v249, v178, v179
 v_mfma_f32_16x16x32_bf16 v[80:83], a[208:211], v[240:243], v[80:83]
 ds_read_b64_tr_b16 a[202:203], v36 offset:4224
 ds_read_b64_tr_b16 a[52:53], v28 offset:33824
 v_mfma_f32_16x16x32_bf16 v[84:87], a[212:215], v[236:239], v[84:87]
 ds_read_b64_tr_b16 a[204:205], v36 offset:32
 global_load_lds_dwordx4 v27, s[50:51] offset:3168
 v_mfma_f32_16x16x32_bf16 v[88:91], a[212:215], v[240:243], v[88:91]
 ds_read_b64_tr_b16 a[206:207], v36 offset:4256
 s_add_u32 m0, s63, 0
 v_mfma_f32_16x16x32_bf16 v[92:95], a[216:219], v[236:239], v[92:95]
 ds_read_b64_tr_b16 a[208:209], v37 offset:0
 ds_read_b64_tr_b16 a[54:55], v28 offset:38048
 v_mfma_f32_16x16x32_bf16 v[96:99], a[216:219], v[240:243], v[96:99]
 ds_read_b64_tr_b16 a[210:211], v37 offset:4224
 global_load_lds_dwordx4 v20, s[6:7] offset:0
 v_mfma_f32_16x16x32_bf16 v[100:103], a[220:223], v[236:239], v[100:103]
 ds_read_b64_tr_b16 a[212:213], v37 offset:32
 v_cvt_pk_bf16_f32 v246, v180, v181
 v_mfma_f32_16x16x32_bf16 v[104:107], a[220:223], v[240:243], v[104:107]
 ds_read_b64_tr_b16 a[214:215], v37 offset:4256
 s_waitcnt lgkmcnt(5)
 v_mfma_f32_16x16x32_bf16 v[108:111], a[192:195], v[236:239], v[108:111]
 ds_read_b64_tr_b16 a[216:217], v38 offset:0
 global_load_lds_dwordx4 v21, s[6:7] offset:1056
 v_mfma_f32_16x16x32_bf16 v[112:115], a[192:195], v[240:243], v[112:115]
 ds_read_b64_tr_b16 a[218:219], v38 offset:4224
 ds_read_b64_tr_b16 a[56:57], v28 offset:42240
 v_mfma_f32_16x16x32_bf16 v[116:119], a[196:199], v[236:239], v[116:119]
 ds_read_b64_tr_b16 a[220:221], v38 offset:32
 v_cvt_pk_bf16_f32 v247, v182, v183
 v_mfma_f32_16x16x32_bf16 v[120:123], a[196:199], v[240:243], v[120:123]
 ds_read_b64_tr_b16 a[222:223], v38 offset:4256
 global_load_lds_dwordx4 v22, s[6:7] offset:2112
 v_mfma_f32_16x16x32_bf16 v[124:127], a[200:203], a[136:139], 0
 ds_read_b64_tr_b16 a[192:193], v39 offset:0
 ds_read_b64_tr_b16 a[58:59], v28 offset:46464
 v_mfma_f32_16x16x32_bf16 v[128:131], a[200:203], a[140:143], 0
 ds_read_b64_tr_b16 a[194:195], v39 offset:4224
 v_cvt_pk_bf16_f32 v250, v184, v185
 v_mfma_f32_16x16x32_bf16 v[132:135], a[204:207], a[136:139], 0
 ds_read_b64_tr_b16 a[196:197], v39 offset:32
 global_load_lds_dwordx4 v23, s[6:7] offset:3168
 v_mfma_f32_16x16x32_bf16 v[136:139], a[204:207], a[140:143], 0
 ds_read_b64_tr_b16 a[198:199], v39 offset:4256
 s_add_u32 m0, s63, 16896
 s_waitcnt lgkmcnt(5)
 v_mfma_f32_16x16x32_bf16 v[140:143], a[208:211], a[136:139], 0
 ds_read_b64_tr_b16 a[200:201], v29 offset:42240
 ds_read_b64_tr_b16 a[60:61], v28 offset:42272
 v_mfma_f32_16x16x32_bf16 v[144:147], a[208:211], a[140:143], 0
 ds_read_b64_tr_b16 a[202:203], v29 offset:46464
 global_load_lds_dwordx4 v20, s[0:1] offset:0
 v_mfma_f32_16x16x32_bf16 v[148:151], a[212:215], a[136:139], 0
 ds_read_b64_tr_b16 a[204:205], v29 offset:42272
 v_cvt_pk_bf16_f32 v251, v186, v187
 v_mfma_f32_16x16x32_bf16 v[152:155], a[212:215], a[140:143], 0
 ds_read_b64_tr_b16 a[206:207], v29 offset:46496
 ds_read_b64_tr_b16 a[62:63], v28 offset:46496
 v_mfma_f32_16x16x32_bf16 v[156:159], a[216:219], a[136:139], 0
 ds_read_b64_tr_b16 a[208:209], v30 offset:42240
 v_cvt_pk_bf16_f32 v188, v124, v125
 v_mfma_f32_16x16x32_bf16 v[160:163], a[216:219], a[140:143], 0
 ds_read_b64_tr_b16 a[210:211], v30 offset:46464
 global_load_lds_dwordx4 v21, s[0:1] offset:1056
 v_mfma_f32_16x16x32_bf16 v[164:167], a[220:223], a[136:139], 0
 ds_read_b64_tr_b16 a[212:213], v30 offset:42272
 v_cvt_pk_bf16_f32 v189, v126, v127
 v_mfma_f32_16x16x32_bf16 v[168:171], a[220:223], a[140:143], 0
 ds_read_b64_tr_b16 a[214:215], v30 offset:46496
 s_waitcnt lgkmcnt(5)
 v_mfma_f32_16x16x32_bf16 v[172:175], a[192:195], a[136:139], 0
 ds_read_b64_tr_b16 a[216:217], v31 offset:42240
 v_cvt_pk_bf16_f32 v196, v140, v141
 v_mfma_f32_16x16x32_bf16 v[176:179], a[192:195], a[140:143], 0
 ds_read_b64_tr_b16 a[218:219], v31 offset:46464
 global_load_lds_dwordx4 v22, s[0:1] offset:2112
 v_mfma_f32_16x16x32_bf16 v[180:183], a[196:199], a[136:139], 0
 ds_read_b64_tr_b16 a[220:221], v31 offset:42272
 v_cvt_pk_bf16_f32 v192, v128, v129
 v_mfma_f32_16x16x32_bf16 v[184:187], a[196:199], a[140:143], 0
 ds_read_b64_tr_b16 a[222:223], v31 offset:46496
 s_waitcnt vmcnt(7)
 v_mfma_f32_16x16x32_bf16 v[76:79], a[200:203], v[244:247], v[76:79]
 ds_read_b64_tr_b16 a[192:193], v36 offset:8704
 global_load_lds_dwordx4 v23, s[0:1] offset:3168
 v_mfma_f32_16x16x32_bf16 v[80:83], a[200:203], v[248:251], v[80:83]
 ds_read_b64_tr_b16 a[194:195], v36 offset:12928
 s_xor_b32 s66, s75, 0x10000
 v_cvt_pk_bf16_f32 v197, v142, v143
 v_mfma_f32_16x16x32_bf16 v[84:87], a[204:207], v[244:247], v[84:87]
 ds_read_b64_tr_b16 a[196:197], v36 offset:8736
 s_add_u32 s86, s32, s66
 s_addc_u32 s87, s33, 0
 v_cvt_pk_bf16_f32 v193, v130, v131
 v_mfma_f32_16x16x32_bf16 v[88:91], a[204:207], v[248:251], v[88:91]
 ds_read_b64_tr_b16 a[198:199], v36 offset:12960
 global_store_dwordx4 v40, a[224:227], s[86:87] offset:0 sc1
 v_cvt_pk_bf16_f32 v204, v156, v157
 s_waitcnt lgkmcnt(4)
 v_mfma_f32_16x16x32_bf16 v[92:95], a[208:211], v[244:247], v[92:95]
 ds_read_b64_tr_b16 a[200:201], v37 offset:8704
 v_cvt_pk_bf16_f32 v200, v144, v145
 v_cvt_pk_bf16_f32 v190, v132, v133
 v_mfma_f32_16x16x32_bf16 v[96:99], a[208:211], v[248:251], v[96:99]
 ds_read_b64_tr_b16 a[202:203], v37 offset:12928
 v_cvt_pk_bf16_f32 v205, v158, v159
 v_mfma_f32_16x16x32_bf16 v[100:103], a[212:215], v[244:247], v[100:103]
 ds_read_b64_tr_b16 a[204:205], v37 offset:8736
 global_store_dwordx4 v40, a[224:227], s[86:87] offset:1024 sc1
 v_cvt_pk_bf16_f32 v201, v146, v147
 v_mfma_f32_16x16x32_bf16 v[104:107], a[212:215], v[248:251], v[104:107]
 ds_read_b64_tr_b16 a[206:207], v37 offset:12960
 s_xor_b32 s66, s75, 0x18000
 v_cvt_pk_bf16_f32 v191, v134, v135
 v_cvt_pk_bf16_f32 v212, v172, v173
 v_mfma_f32_16x16x32_bf16 v[108:111], a[216:219], v[244:247], v[108:111]
 ds_read_b64_tr_b16 a[208:209], v38 offset:8704
 s_add_u32 s86, s32, s66
 s_addc_u32 s87, s33, 0
 v_cvt_pk_bf16_f32 v208, v160, v161
 v_cvt_pk_bf16_f32 v198, v148, v149
 v_mfma_f32_16x16x32_bf16 v[112:115], a[216:219], v[248:251], v[112:115]
 ds_read_b64_tr_b16 a[210:211], v38 offset:12928
 global_store_dwordx4 v40, a[224:227], s[86:87] offset:0 sc1
 v_cvt_pk_bf16_f32 v194, v136, v137
 v_cvt_pk_bf16_f32 v213, v174, v175
 v_mfma_f32_16x16x32_bf16 v[116:119], a[220:223], v[244:247], v[116:119]
 ds_read_b64_tr_b16 a[212:213], v38 offset:8736
 v_cvt_pk_bf16_f32 v209, v162, v163
 v_mfma_f32_16x16x32_bf16 v[120:123], a[220:223], v[248:251], v[120:123]
 ds_read_b64_tr_b16 a[214:215], v38 offset:12960
 v_cvt_pk_bf16_f32 v199, v150, v151
 v_cvt_pk_bf16_f32 v195, v138, v139
 s_waitcnt lgkmcnt(4)
 v_mfma_f32_16x16x32_bf16 v[124:127], a[192:195], a[144:147], 0
 ds_read_b64_tr_b16 a[216:217], v39 offset:8704
 global_store_dwordx4 v40, a[224:227], s[86:87] offset:1024 sc1
 v_cvt_pk_bf16_f32 v216, v176, v177
 v_cvt_pk_bf16_f32 v206, v164, v165
 v_mfma_f32_16x16x32_bf16 v[128:131], a[192:195], a[148:151], 0
 ds_read_b64_tr_b16 a[218:219], v39 offset:12928
 v_cvt_pk_bf16_f32 v202, v152, v153
 v_mfma_f32_16x16x32_bf16 v[132:135], a[196:199], a[144:147], 0
 ds_read_b64_tr_b16 a[220:221], v39 offset:8736
 v_cvt_pk_bf16_f32 v217, v178, v179
 v_mfma_f32_16x16x32_bf16 v[136:139], a[196:199], a[148:151], 0
 ds_read_b64_tr_b16 a[222:223], v39 offset:12960
 v_cvt_pk_bf16_f32 v207, v166, v167
 v_cvt_pk_bf16_f32 v203, v154, v155
 s_waitcnt vmcnt(8)
 s_barrier
 v_mfma_f32_16x16x32_bf16 v[140:143], a[200:203], a[144:147], 0
 ds_read_b64_tr_b16 a[192:193], v33 offset:0
 v_cvt_pk_bf16_f32 v214, v180, v181
 v_mfma_f32_16x16x32_bf16 v[144:147], a[200:203], a[148:151], 0
 ds_read_b64_tr_b16 a[194:195], v33 offset:4224
 v_cvt_pk_bf16_f32 v210, v168, v169
 v_mfma_f32_16x16x32_bf16 v[148:151], a[204:207], a[144:147], 0
 ds_read_b64_tr_b16 a[196:197], v33 offset:32
 v_cvt_pk_bf16_f32 v215, v182, v183
 v_mfma_f32_16x16x32_bf16 v[152:155], a[204:207], a[148:151], 0
 ds_read_b64_tr_b16 a[198:199], v33 offset:4256
 v_cvt_pk_bf16_f32 v211, v170, v171
 s_waitcnt lgkmcnt(4)
 v_mfma_f32_16x16x32_bf16 v[156:159], a[208:211], a[144:147], 0
 ds_read_b64_tr_b16 a[200:201], v33 offset:8448
 v_cvt_pk_bf16_f32 v218, v184, v185
 v_mfma_f32_16x16x32_bf16 v[160:163], a[208:211], a[148:151], 0
 ds_read_b64_tr_b16 a[202:203], v33 offset:12672
L_pad0_3315:
 s_cbranch_execz L_ret0_1
 v_cvt_pk_bf16_f32 v124, v124, v125
 v_mfma_f32_16x16x32_bf16 v[164:167], a[212:215], a[144:147], 0
 ds_read_b64_tr_b16 a[204:205], v33 offset:8480
 v_cvt_pk_bf16_f32 v125, v126, v127
 v_mfma_f32_16x16x32_bf16 v[168:171], a[212:215], a[148:151], 0
 ds_read_b64_tr_b16 a[206:207], v33 offset:12704
 v_cvt_pk_bf16_f32 v219, v186, v187
 v_mfma_f32_16x16x32_bf16 v[172:175], a[216:219], a[144:147], 0
 ds_read_b64_tr_b16 a[208:209], v33 offset:16896
 v_cvt_pk_bf16_f32 v126, v132, v133
 v_mfma_f32_16x16x32_bf16 v[176:179], a[216:219], a[148:151], 0
 ds_read_b64_tr_b16 a[210:211], v33 offset:21120
 v_cvt_pk_bf16_f32 v127, v134, v135
 v_mfma_f32_16x16x32_bf16 v[180:183], a[220:223], a[144:147], 0
 ds_read_b64_tr_b16 a[212:213], v33 offset:16928
 v_cvt_pk_bf16_f32 v128, v128, v129
 v_mfma_f32_16x16x32_bf16 v[184:187], a[220:223], a[148:151], 0
 ds_read_b64_tr_b16 a[214:215], v33 offset:21152
 s_waitcnt lgkmcnt(4)
 v_mfma_f32_16x16x32_bf16 v[76:79], a[192:195], v[188:191], v[76:79]
 ds_read_b64_tr_b16 a[216:217], v33 offset:25344
 v_cvt_pk_bf16_f32 v129, v130, v131
 v_mfma_f32_16x16x32_bf16 v[80:83], a[192:195], v[192:195], v[80:83]
 ds_read_b64_tr_b16 a[218:219], v33 offset:29568
 v_cvt_pk_bf16_f32 v130, v136, v137
 v_mfma_f32_16x16x32_bf16 v[84:87], a[196:199], v[188:191], v[84:87]
 ds_read_b64_tr_b16 a[220:221], v33 offset:25376
 v_cvt_pk_bf16_f32 v131, v138, v139
 v_mfma_f32_16x16x32_bf16 v[88:91], a[196:199], v[192:195], v[88:91]
 ds_read_b64_tr_b16 a[222:223], v33 offset:29600
 v_cvt_pk_bf16_f32 v132, v140, v141
 v_mfma_f32_16x16x32_bf16 v[76:79], a[200:203], v[196:199], v[76:79]
 ds_read_b64_tr_b16 a[192:193], v29 offset:0
 v_cvt_pk_bf16_f32 v133, v142, v143
 v_mfma_f32_16x16x32_bf16 v[80:83], a[200:203], v[200:203], v[80:83]
 ds_read_b64_tr_b16 a[194:195], v29 offset:4224
 v_cvt_pk_bf16_f32 v134, v148, v149
 v_mfma_f32_16x16x32_bf16 v[84:87], a[204:207], v[196:199], v[84:87]
 ds_read_b64_tr_b16 a[196:197], v29 offset:32
 v_cvt_pk_bf16_f32 v135, v150, v151
 v_mfma_f32_16x16x32_bf16 v[88:91], a[204:207], v[200:203], v[88:91]
 ds_read_b64_tr_b16 a[198:199], v29 offset:4256
 v_cvt_pk_bf16_f32 v136, v144, v145
 s_waitcnt lgkmcnt(4)
 v_mfma_f32_16x16x32_bf16 v[76:79], a[208:211], v[204:207], v[76:79]
 ds_read_b64_tr_b16 a[200:201], v29 offset:8448
 v_cvt_pk_bf16_f32 v137, v146, v147
 v_mfma_f32_16x16x32_bf16 v[80:83], a[208:211], v[208:211], v[80:83]
 ds_read_b64_tr_b16 a[202:203], v29 offset:12672
 v_cvt_pk_bf16_f32 v138, v152, v153
 v_mfma_f32_16x16x32_bf16 v[84:87], a[212:215], v[204:207], v[84:87]
 ds_read_b64_tr_b16 a[204:205], v29 offset:8480
 v_cvt_pk_bf16_f32 v139, v154, v155
 v_mfma_f32_16x16x32_bf16 v[88:91], a[212:215], v[208:211], v[88:91]
 ds_read_b64_tr_b16 a[206:207], v29 offset:12704
 v_cvt_pk_bf16_f32 v140, v156, v157
 s_waitcnt vmcnt(4)
 s_barrier
 v_mfma_f32_16x16x32_bf16 v[76:79], a[216:219], v[212:215], v[76:79]
 ds_read_b64_tr_b16 a[208:209], v29 offset:16896
 v_cvt_pk_bf16_f32 v141, v158, v159
 v_mfma_f32_16x16x32_bf16 v[80:83], a[216:219], v[216:219], v[80:83]
 ds_read_b64_tr_b16 a[210:211], v29 offset:21120
 v_cvt_pk_bf16_f32 v142, v164, v165
 v_mfma_f32_16x16x32_bf16 v[84:87], a[220:223], v[212:215], v[84:87]
 ds_read_b64_tr_b16 a[212:213], v29 offset:16928
 v_cvt_pk_bf16_f32 v143, v166, v167
 v_mfma_f32_16x16x32_bf16 v[88:91], a[220:223], v[216:219], v[88:91]
 ds_read_b64_tr_b16 a[214:215], v29 offset:21152
 v_cvt_pk_bf16_f32 v144, v160, v161
 s_waitcnt lgkmcnt(4)
 v_mfma_f32_16x16x32_bf16 v[76:79], a[192:195], v[124:127], v[76:79]
 ds_read_b64_tr_b16 a[216:217], v29 offset:25344
 v_cvt_pk_bf16_f32 v145, v162, v163
 v_mfma_f32_16x16x32_bf16 v[80:83], a[192:195], v[128:131], v[80:83]
 ds_read_b64_tr_b16 a[218:219], v29 offset:29568
 v_cvt_pk_bf16_f32 v146, v168, v169
 v_mfma_f32_16x16x32_bf16 v[84:87], a[196:199], v[124:127], v[84:87]
 ds_read_b64_tr_b16 a[220:221], v29 offset:25376
 v_cvt_pk_bf16_f32 v147, v170, v171
 v_mfma_f32_16x16x32_bf16 v[88:91], a[196:199], v[128:131], v[88:91]
 ds_read_b64_tr_b16 a[222:223], v29 offset:29600
 v_cvt_pk_bf16_f32 v148, v172, v173
 v_mfma_f32_16x16x32_bf16 v[76:79], a[200:203], v[132:135], v[76:79]
 ds_read_b64_tr_b16 a[192:193], v34 offset:0
 v_cvt_pk_bf16_f32 v149, v174, v175
 v_mfma_f32_16x16x32_bf16 v[80:83], a[200:203], v[136:139], v[80:83]
 ds_read_b64_tr_b16 a[194:195], v34 offset:4224
 v_cvt_pk_bf16_f32 v150, v180, v181
 v_mfma_f32_16x16x32_bf16 v[84:87], a[204:207], v[132:135], v[84:87]
 ds_read_b64_tr_b16 a[196:197], v34 offset:32
 v_cvt_pk_bf16_f32 v151, v182, v183
 v_mfma_f32_16x16x32_bf16 v[88:91], a[204:207], v[136:139], v[88:91]
 ds_read_b64_tr_b16 a[198:199], v34 offset:4256
 v_cvt_pk_bf16_f32 v152, v176, v177
 s_waitcnt lgkmcnt(4)
 v_mfma_f32_16x16x32_bf16 v[76:79], a[208:211], v[140:143], v[76:79]
 ds_read_b64_tr_b16 a[200:201], v34 offset:8448
 v_cvt_pk_bf16_f32 v153, v178, v179
 v_mfma_f32_16x16x32_bf16 v[80:83], a[208:211], v[144:147], v[80:83]
 ds_read_b64_tr_b16 a[202:203], v34 offset:12672
 v_cvt_pk_bf16_f32 v154, v184, v185
 v_mfma_f32_16x16x32_bf16 v[84:87], a[212:215], v[140:143], v[84:87]
 ds_read_b64_tr_b16 a[204:205], v34 offset:8480
 v_cvt_pk_bf16_f32 v155, v186, v187
 v_mfma_f32_16x16x32_bf16 v[88:91], a[212:215], v[144:147], v[88:91]
 ds_read_b64_tr_b16 a[206:207], v34 offset:12704
 v_mfma_f32_16x16x32_bf16 v[76:79], a[216:219], v[148:151], v[76:79]
 ds_read_b64_tr_b16 a[208:209], v34 offset:16896
 v_mfma_f32_16x16x32_bf16 v[80:83], a[216:219], v[152:155], v[80:83]
 ds_read_b64_tr_b16 a[210:211], v34 offset:21120
 v_mfma_f32_16x16x32_bf16 v[84:87], a[220:223], v[148:151], v[84:87]
 ds_read_b64_tr_b16 a[212:213], v34 offset:16928
 v_mfma_f32_16x16x32_bf16 v[88:91], a[220:223], v[152:155], v[88:91]
 ds_read_b64_tr_b16 a[214:215], v34 offset:21152
 s_waitcnt lgkmcnt(4)
 v_mfma_f32_16x16x32_bf16 v[92:95], a[192:195], v[188:191], v[92:95]
 ds_read_b64_tr_b16 a[216:217], v34 offset:25344
 v_mfma_f32_16x16x32_bf16 v[96:99], a[192:195], v[192:195], v[96:99]
 ds_read_b64_tr_b16 a[218:219], v34 offset:29568
 v_mfma_f32_16x16x32_bf16 v[100:103], a[196:199], v[188:191], v[100:103]
 ds_read_b64_tr_b16 a[220:221], v34 offset:25376
 v_mfma_f32_16x16x32_bf16 v[104:107], a[196:199], v[192:195], v[104:107]
 ds_read_b64_tr_b16 a[222:223], v34 offset:29600
 s_xor_b32 s66, s75, 0x8000
 s_add_u32 s86, s32, s66
 s_addc_u32 s87, s33, 0
 v_mfma_f32_16x16x32_bf16 v[92:95], a[200:203], v[196:199], v[92:95]
 ds_read_b64_tr_b16 a[192:193], v30 offset:0
 v_cvt_pk_bf16_f32 v156, v76, v77
 v_cvt_pk_bf16_f32 v157, v78, v79
 v_cvt_pk_bf16_f32 v158, v84, v85
 v_mfma_f32_16x16x32_bf16 v[96:99], a[200:203], v[200:203], v[96:99]
 ds_read_b64_tr_b16 a[194:195], v30 offset:4224
 v_cvt_pk_bf16_f32 v159, v86, v87
 global_store_dwordx4 v40, v[156:159], s[86:87] offset:0 sc1
 v_cvt_pk_bf16_f32 v160, v80, v81
 v_mfma_f32_16x16x32_bf16 v[100:103], a[204:207], v[196:199], v[100:103]
 ds_read_b64_tr_b16 a[196:197], v30 offset:32
 v_cvt_pk_bf16_f32 v161, v82, v83
 v_cvt_pk_bf16_f32 v162, v88, v89
 v_cvt_pk_bf16_f32 v163, v90, v91
 v_mfma_f32_16x16x32_bf16 v[104:107], a[204:207], v[200:203], v[104:107]
 ds_read_b64_tr_b16 a[198:199], v30 offset:4256
 global_store_dwordx4 v40, v[160:163], s[86:87] offset:1024 sc1
 s_waitcnt lgkmcnt(4)
 v_mfma_f32_16x16x32_bf16 v[92:95], a[208:211], v[204:207], v[92:95]
 ds_read_b64_tr_b16 a[200:201], v30 offset:8448
 v_mfma_f32_16x16x32_bf16 v[96:99], a[208:211], v[208:211], v[96:99]
 ds_read_b64_tr_b16 a[202:203], v30 offset:12672
 v_mfma_f32_16x16x32_bf16 v[100:103], a[212:215], v[204:207], v[100:103]
 ds_read_b64_tr_b16 a[204:205], v30 offset:8480
 v_mfma_f32_16x16x32_bf16 v[104:107], a[212:215], v[208:211], v[104:107]
 ds_read_b64_tr_b16 a[206:207], v30 offset:12704
 v_mfma_f32_16x16x32_bf16 v[92:95], a[216:219], v[212:215], v[92:95]
 ds_read_b64_tr_b16 a[208:209], v30 offset:16896
 v_mfma_f32_16x16x32_bf16 v[96:99], a[216:219], v[216:219], v[96:99]
 ds_read_b64_tr_b16 a[210:211], v30 offset:21120
 v_mfma_f32_16x16x32_bf16 v[100:103], a[220:223], v[212:215], v[100:103]
 ds_read_b64_tr_b16 a[212:213], v30 offset:16928
 v_mfma_f32_16x16x32_bf16 v[104:107], a[220:223], v[216:219], v[104:107]
 ds_read_b64_tr_b16 a[214:215], v30 offset:21152
 s_waitcnt lgkmcnt(4)
 v_mfma_f32_16x16x32_bf16 v[92:95], a[192:195], v[124:127], v[92:95]
 ds_read_b64_tr_b16 a[216:217], v30 offset:25344
 v_mfma_f32_16x16x32_bf16 v[96:99], a[192:195], v[128:131], v[96:99]
 ds_read_b64_tr_b16 a[218:219], v30 offset:29568
 v_mfma_f32_16x16x32_bf16 v[100:103], a[196:199], v[124:127], v[100:103]
 ds_read_b64_tr_b16 a[220:221], v30 offset:25376
 s_xor_b32 s3, s75, 8192
 v_mfma_f32_16x16x32_bf16 v[104:107], a[196:199], v[128:131], v[104:107]
 ds_read_b64_tr_b16 a[222:223], v30 offset:29600
 s_add_u32 s44, s32, s3
 s_addc_u32 s45, s33, 0
 v_mfma_f32_16x16x32_bf16 v[92:95], a[200:203], v[132:135], v[92:95]
 ds_read_b64_tr_b16 a[192:193], v35 offset:0
 s_xor_b32 s3, s75, 16384
 v_mfma_f32_16x16x32_bf16 v[96:99], a[200:203], v[136:139], v[96:99]
 ds_read_b64_tr_b16 a[194:195], v35 offset:4224
 s_add_u32 s40, s32, s3
 s_addc_u32 s41, s33, 0
 v_mfma_f32_16x16x32_bf16 v[100:103], a[204:207], v[132:135], v[100:103]
 ds_read_b64_tr_b16 a[196:197], v35 offset:32
 s_xor_b32 s3, s75, 24576
 v_mfma_f32_16x16x32_bf16 v[104:107], a[204:207], v[136:139], v[104:107]
 ds_read_b64_tr_b16 a[198:199], v35 offset:4256
 s_waitcnt lgkmcnt(4)
 v_mfma_f32_16x16x32_bf16 v[92:95], a[208:211], v[140:143], v[92:95]
 ds_read_b64_tr_b16 a[200:201], v35 offset:8448
 s_add_u32 s36, s32, s3
 s_addc_u32 s37, s33, 0
 v_mfma_f32_16x16x32_bf16 v[96:99], a[208:211], v[144:147], v[96:99]
 ds_read_b64_tr_b16 a[202:203], v35 offset:12672
 v_mfma_f32_16x16x32_bf16 v[100:103], a[212:215], v[140:143], v[100:103]
 ds_read_b64_tr_b16 a[204:205], v35 offset:8480
 v_mfma_f32_16x16x32_bf16 v[104:107], a[212:215], v[144:147], v[104:107]
 ds_read_b64_tr_b16 a[206:207], v35 offset:12704
 v_mfma_f32_16x16x32_bf16 v[92:95], a[216:219], v[148:151], v[92:95]
 ds_read_b64_tr_b16 a[208:209], v35 offset:16896
 v_mfma_f32_16x16x32_bf16 v[96:99], a[216:219], v[152:155], v[96:99]
 ds_read_b64_tr_b16 a[210:211], v35 offset:21120
 v_mfma_f32_16x16x32_bf16 v[100:103], a[220:223], v[148:151], v[100:103]
 ds_read_b64_tr_b16 a[212:213], v35 offset:16928
 v_mfma_f32_16x16x32_bf16 v[104:107], a[220:223], v[152:155], v[104:107]
 ds_read_b64_tr_b16 a[214:215], v35 offset:21152
 s_waitcnt lgkmcnt(4)
 v_mfma_f32_16x16x32_bf16 v[108:111], a[192:195], v[188:191], v[108:111]
 ds_read_b64_tr_b16 a[216:217], v35 offset:25344
 v_mfma_f32_16x16x32_bf16 v[112:115], a[192:195], v[192:195], v[112:115]
 ds_read_b64_tr_b16 a[218:219], v35 offset:29568
 v_mfma_f32_16x16x32_bf16 v[116:119], a[196:199], v[188:191], v[116:119]
 ds_read_b64_tr_b16 a[220:221], v35 offset:25376
 v_mfma_f32_16x16x32_bf16 v[120:123], a[196:199], v[192:195], v[120:123]
 ds_read_b64_tr_b16 a[222:223], v35 offset:29600
 s_xor_b32 s66, s75, 0x10000
 s_add_u32 s86, s32, s66
 s_addc_u32 s87, s33, 0
 v_mfma_f32_16x16x32_bf16 v[108:111], a[200:203], v[196:199], v[108:111]
 ds_read_b64_tr_b16 a[192:193], v31 offset:0
 v_cvt_pk_bf16_f32 v164, v92, v93
 v_cvt_pk_bf16_f32 v165, v94, v95
 v_cvt_pk_bf16_f32 v166, v100, v101
 v_mfma_f32_16x16x32_bf16 v[112:115], a[200:203], v[200:203], v[112:115]
 ds_read_b64_tr_b16 a[194:195], v31 offset:4224
 v_cvt_pk_bf16_f32 v167, v102, v103
 s_waitcnt vmcnt(4)
 global_store_dwordx4 v40, v[164:167], s[86:87] offset:0 sc1
 v_mfma_f32_16x16x32_bf16 v[116:119], a[204:207], v[196:199], v[116:119]
 ds_read_b64_tr_b16 a[196:197], v31 offset:32
 v_cvt_pk_bf16_f32 v168, v96, v97
 v_cvt_pk_bf16_f32 v169, v98, v99
 v_cvt_pk_bf16_f32 v170, v104, v105
 v_mfma_f32_16x16x32_bf16 v[120:123], a[204:207], v[200:203], v[120:123]
 ds_read_b64_tr_b16 a[198:199], v31 offset:4256
 v_cvt_pk_bf16_f32 v171, v106, v107
 global_store_dwordx4 v40, v[168:171], s[86:87] offset:1024 sc1
 s_waitcnt lgkmcnt(4)
 v_mfma_f32_16x16x32_bf16 v[108:111], a[208:211], v[204:207], v[108:111]
 ds_read_b64_tr_b16 a[200:201], v31 offset:8448
 v_mfma_f32_16x16x32_bf16 v[112:115], a[208:211], v[208:211], v[112:115]
 ds_read_b64_tr_b16 a[202:203], v31 offset:12672
 v_mfma_f32_16x16x32_bf16 v[116:119], a[212:215], v[204:207], v[116:119]
 ds_read_b64_tr_b16 a[204:205], v31 offset:8480
 v_mfma_f32_16x16x32_bf16 v[120:123], a[212:215], v[208:211], v[120:123]
 ds_read_b64_tr_b16 a[206:207], v31 offset:12704
 v_mfma_f32_16x16x32_bf16 v[108:111], a[216:219], v[212:215], v[108:111]
 ds_read_b64_tr_b16 a[208:209], v31 offset:16896
 v_mfma_f32_16x16x32_bf16 v[112:115], a[216:219], v[216:219], v[112:115]
 ds_read_b64_tr_b16 a[210:211], v31 offset:21120
 s_waitcnt vmcnt(2)
 s_mov_b64 exec, 1
 buffer_store_dword v44, v45, s[32:35], s74 offen offset:8 sc1
 s_mov_b64 exec, -1
 v_mfma_f32_16x16x32_bf16 v[116:119], a[220:223], v[212:215], v[116:119]
 ds_read_b64_tr_b16 a[212:213], v31 offset:16928
 v_mfma_f32_16x16x32_bf16 v[120:123], a[220:223], v[216:219], v[120:123]
 ds_read_b64_tr_b16 a[214:215], v31 offset:21152
 s_waitcnt lgkmcnt(4)
 v_mfma_f32_16x16x32_bf16 v[108:111], a[192:195], v[124:127], v[108:111]
 ds_read_b64_tr_b16 a[216:217], v31 offset:25344
 v_mfma_f32_16x16x32_bf16 v[112:115], a[192:195], v[128:131], v[112:115]
 ds_read_b64_tr_b16 a[218:219], v31 offset:29568
 v_mfma_f32_16x16x32_bf16 v[116:119], a[196:199], v[124:127], v[116:119]
 ds_read_b64_tr_b16 a[220:221], v31 offset:25376
 v_mfma_f32_16x16x32_bf16 v[120:123], a[196:199], v[128:131], v[120:123]
 ds_read_b64_tr_b16 a[222:223], v31 offset:29600
 v_mfma_f32_16x16x32_bf16 v[108:111], a[200:203], v[132:135], v[108:111]
 ds_read_b64_tr_b16 a[192:193], v32 offset:0
 v_mfma_f32_16x16x32_bf16 v[112:115], a[200:203], v[136:139], v[112:115]
L_pad0_3584:
 s_cbranch_execz L_ret0_1
 ds_read_b64_tr_b16 a[194:195], v32 offset:4224
 v_mfma_f32_16x16x32_bf16 v[116:119], a[204:207], v[132:135], v[116:119]
 ds_read_b64_tr_b16 a[196:197], v32 offset:32
 v_mfma_f32_16x16x32_bf16 v[120:123], a[204:207], v[136:139], v[120:123]
 ds_read_b64_tr_b16 a[198:199], v32 offset:4256
 s_waitcnt lgkmcnt(4)
 v_mfma_f32_16x16x32_bf16 v[108:111], a[208:211], v[140:143], v[108:111]
 ds_read_b64_tr_b16 a[200:201], v32 offset:8448
 v_mfma_f32_16x16x32_bf16 v[112:115], a[208:211], v[144:147], v[112:115]
 ds_read_b64_tr_b16 a[202:203], v32 offset:12672
 v_mfma_f32_16x16x32_bf16 v[116:119], a[212:215], v[140:143], v[116:119]
 ds_read_b64_tr_b16 a[204:205], v32 offset:8480
 v_mfma_f32_16x16x32_bf16 v[120:123], a[212:215], v[144:147], v[120:123]
 ds_read_b64_tr_b16 a[206:207], v32 offset:12704
 v_mfma_f32_16x16x32_bf16 v[108:111], a[216:219], v[148:151], v[108:111]
 ds_read_b64_tr_b16 a[208:209], v32 offset:16896
 v_mfma_f32_16x16x32_bf16 v[112:115], a[216:219], v[152:155], v[112:115]
 ds_read_b64_tr_b16 a[210:211], v32 offset:21120
 v_mfma_f32_16x16x32_bf16 v[116:119], a[220:223], v[148:151], v[116:119]
 ds_read_b64_tr_b16 a[212:213], v32 offset:16928
 v_mfma_f32_16x16x32_bf16 v[120:123], a[220:223], v[152:155], v[120:123]
 ds_read_b64_tr_b16 a[214:215], v32 offset:21152
 s_waitcnt lgkmcnt(4)
 v_mfma_f32_16x16x32_bf16 v[60:63], a[192:195], v[188:191], v[60:63]
 ds_read_b64_tr_b16 a[216:217], v32 offset:25344
 v_mfma_f32_16x16x32_bf16 v[64:67], a[192:195], v[192:195], v[64:67]
 ds_read_b64_tr_b16 a[218:219], v32 offset:29568
 buffer_load_dword v43, v42, s[32:35], s73 offen offset:8 sc1
 v_mfma_f32_16x16x32_bf16 v[68:71], a[196:199], v[188:191], v[68:71]
 ds_read_b64_tr_b16 a[220:221], v32 offset:25376
 v_mfma_f32_16x16x32_bf16 v[72:75], a[196:199], v[192:195], v[72:75]
 ds_read_b64_tr_b16 a[222:223], v32 offset:29600
 s_xor_b32 s66, s75, 0x18000
 s_add_u32 s86, s32, s66
 s_addc_u32 s87, s33, 0
 v_mfma_f32_16x16x32_bf16 v[60:63], a[200:203], v[196:199], v[60:63]
 ds_read_b64_tr_b16 a[192:193], v28 offset:0
 v_cvt_pk_bf16_f32 v172, v108, v109
 v_cvt_pk_bf16_f32 v173, v110, v111
 v_cvt_pk_bf16_f32 v174, v116, v117
 v_mfma_f32_16x16x32_bf16 v[64:67], a[200:203], v[200:203], v[64:67]
 ds_read_b64_tr_b16 a[194:195], v28 offset:4224
 v_cvt_pk_bf16_f32 v175, v118, v119
 global_store_dwordx4 v40, v[172:175], s[86:87] offset:0 sc1
 v_mfma_f32_16x16x32_bf16 v[68:71], a[204:207], v[196:199], v[68:71]
 ds_read_b64_tr_b16 a[196:197], v28 offset:32
 v_cvt_pk_bf16_f32 v176, v112, v113
 v_cvt_pk_bf16_f32 v177, v114, v115
 v_cvt_pk_bf16_f32 v178, v120, v121
 v_mfma_f32_16x16x32_bf16 v[72:75], a[204:207], v[200:203], v[72:75]
 ds_read_b64_tr_b16 a[198:199], v28 offset:4256
 v_cvt_pk_bf16_f32 v179, v122, v123
 global_store_dwordx4 v40, v[176:179], s[86:87] offset:1024 sc1
 s_waitcnt lgkmcnt(4)
 v_mfma_f32_16x16x32_bf16 v[60:63], a[208:211], v[204:207], v[60:63]
 ds_read_b64_tr_b16 a[200:201], v28 offset:8448
 v_mfma_f32_16x16x32_bf16 v[64:67], a[208:211], v[208:211], v[64:67]
 ds_read_b64_tr_b16 a[202:203], v28 offset:12672
 v_mfma_f32_16x16x32_bf16 v[68:71], a[212:215], v[204:207], v[68:71]
 ds_read_b64_tr_b16 a[204:205], v28 offset:8480
 v_mfma_f32_16x16x32_bf16 v[72:75], a[212:215], v[208:211], v[72:75]
 ds_read_b64_tr_b16 a[206:207], v28 offset:12704
 v_mfma_f32_16x16x32_bf16 v[60:63], a[216:219], v[212:215], v[60:63]
 ds_read_b64_tr_b16 a[208:209], v28 offset:16896
 v_mfma_f32_16x16x32_bf16 v[64:67], a[216:219], v[216:219], v[64:67]
 ds_read_b64_tr_b16 a[210:211], v28 offset:21120
 v_mfma_f32_16x16x32_bf16 v[68:71], a[220:223], v[212:215], v[68:71]
 ds_read_b64_tr_b16 a[212:213], v28 offset:16928
 v_mfma_f32_16x16x32_bf16 v[72:75], a[220:223], v[216:219], v[72:75]
 ds_read_b64_tr_b16 a[214:215], v28 offset:21152
 s_waitcnt lgkmcnt(4)
 v_mfma_f32_16x16x32_bf16 v[60:63], a[192:195], v[124:127], v[60:63]
 ds_read_b64_tr_b16 a[216:217], v28 offset:25344
 v_mfma_f32_16x16x32_bf16 v[64:67], a[192:195], v[128:131], v[64:67]
 ds_read_b64_tr_b16 a[218:219], v28 offset:29568
 v_mfma_f32_16x16x32_bf16 v[68:71], a[196:199], v[124:127], v[68:71]
 ds_read_b64_tr_b16 a[220:221], v28 offset:25376
 v_mfma_f32_16x16x32_bf16 v[72:75], a[196:199], v[128:131], v[72:75]
 ds_read_b64_tr_b16 a[222:223], v28 offset:29600
 v_mfma_f32_16x16x32_bf16 v[60:63], a[200:203], v[132:135], v[60:63]
 v_mfma_f32_16x16x32_bf16 v[64:67], a[200:203], v[136:139], v[64:67]
 v_mfma_f32_16x16x32_bf16 v[68:71], a[204:207], v[132:135], v[68:71]
 v_mfma_f32_16x16x32_bf16 v[72:75], a[204:207], v[136:139], v[72:75]
 s_waitcnt vmcnt(2)
 v_cmp_ne_u32 vcc, 1, v43
 s_cbranch_vccnz L_slow0p
L_back0p:
 global_load_dwordx4 v[76:79], v40, s[44:45] offset:0 sc1
 s_waitcnt lgkmcnt(0)
 v_mfma_f32_16x16x32_bf16 v[60:63], a[208:211], v[140:143], v[60:63]
 global_load_dwordx4 v[80:83], v40, s[44:45] offset:1024 sc1
 v_mfma_f32_16x16x32_bf16 v[64:67], a[208:211], v[144:147], v[64:67]
 global_load_dwordx4 v[84:87], v40, s[40:41] offset:0 sc1
 v_mfma_f32_16x16x32_bf16 v[68:71], a[212:215], v[140:143], v[68:71]
 global_load_dwordx4 v[88:91], v40, s[40:41] offset:1024 sc1
 v_mfma_f32_16x16x32_bf16 v[72:75], a[212:215], v[144:147], v[72:75]
 v_mfma_f32_16x16x32_bf16 v[60:63], a[216:219], v[148:151], v[60:63]
 v_mfma_f32_16x16x32_bf16 v[64:67], a[216:219], v[152:155], v[64:67]
 v_mfma_f32_16x16x32_bf16 v[68:71], a[220:223], v[148:151], v[68:71]
 v_mfma_f32_16x16x32_bf16 v[72:75], a[220:223], v[152:155], v[72:75]
 v_mfma_f32_16x16x32_bf16 v[60:63], a[0:3], v[4:7], v[60:63]
 global_load_dwordx4 v[92:95], v40, s[36:37] offset:0 sc1
 v_mfma_f32_16x16x32_bf16 v[64:67], a[0:3], v[8:11], v[64:67]
 global_load_dwordx4 v[96:99], v40, s[36:37] offset:1024 sc1
 v_mfma_f32_16x16x32_bf16 v[68:71], a[4:7], v[4:7], v[68:71]
 v_mfma_f32_16x16x32_bf16 v[72:75], a[4:7], v[8:11], v[72:75]
 v_mfma_f32_16x16x32_bf16 v[60:63], a[8:11], v[12:15], v[60:63]
 v_mfma_f32_16x16x32_bf16 v[64:67], a[8:11], v[16:19], v[64:67]
 v_mfma_f32_16x16x32_bf16 v[68:71], a[12:15], v[12:15], v[68:71]
 v_mfma_f32_16x16x32_bf16 v[72:75], a[12:15], v[16:19], v[72:75]
 v_mfma_f32_16x16x32_bf16 v[60:63], a[16:19], v[0:3], v[60:63]
 v_mfma_f32_16x16x32_bf16 v[64:67], a[16:19], v[252:255], v[64:67]
 v_mfma_f32_16x16x32_bf16 v[68:71], a[20:23], v[0:3], v[68:71]
 v_mfma_f32_16x16x32_bf16 v[72:75], a[20:23], v[252:255], v[72:75]
 v_mfma_f32_16x16x32_bf16 v[60:63], a[24:27], v[52:55], v[60:63]
 v_mfma_f32_16x16x32_bf16 v[64:67], a[24:27], v[56:59], v[64:67]
 v_mfma_f32_16x16x32_bf16 v[68:71], a[28:31], v[52:55], v[68:71]
 v_mfma_f32_16x16x32_bf16 v[72:75], a[28:31], v[56:59], v[72:75]
 v_mfma_f32_16x16x32_bf16 v[60:63], a[32:35], v[220:223], v[60:63]
 v_mfma_f32_16x16x32_bf16 v[64:67], a[32:35], v[224:227], v[64:67]
 v_mfma_f32_16x16x32_bf16 v[68:71], a[36:39], v[220:223], v[68:71]
 v_mfma_f32_16x16x32_bf16 v[72:75], a[36:39], v[224:227], v[72:75]
 v_mfma_f32_16x16x32_bf16 v[60:63], a[40:43], v[228:231], v[60:63]
 v_mfma_f32_16x16x32_bf16 v[64:67], a[40:43], v[232:235], v[64:67]
 v_mfma_f32_16x16x32_bf16 v[68:71], a[44:47], v[228:231], v[68:71]
 v_mfma_f32_16x16x32_bf16 v[72:75], a[44:47], v[232:235], v[72:75]
 v_mfma_f32_16x16x32_bf16 v[60:63], a[48:51], v[236:239], v[60:63]
 v_mfma_f32_16x16x32_bf16 v[64:67], a[48:51], v[240:243], v[64:67]
 v_mfma_f32_16x16x32_bf16 v[68:71], a[52:55], v[236:239], v[68:71]
 v_mfma_f32_16x16x32_bf16 v[72:75], a[52:55], v[240:243], v[72:75]
 v_mfma_f32_16x16x32_bf16 v[60:63], a[56:59], v[244:247], v[60:63]
 v_mfma_f32_16x16x32_bf16 v[64:67], a[56:59], v[248:251], v[64:67]
 v_mfma_f32_16x16x32_bf16 v[68:71], a[60:63], v[244:247], v[68:71]
 v_mfma_f32_16x16x32_bf16 v[72:75], a[60:63], v[248:251], v[72:75]
 s_nop 4
 v_cvt_pk_bf16_f32 v180, v60, v61
 v_cvt_pk_bf16_f32 v181, v62, v63
 v_cvt_pk_bf16_f32 v182, v68, v69
 v_cvt_pk_bf16_f32 v183, v70, v71
 v_cvt_pk_bf16_f32 v184, v64, v65
 v_cvt_pk_bf16_f32 v185, v66, v67
 v_cvt_pk_bf16_f32 v186, v72, v73
 v_cvt_pk_bf16_f32 v187, v74, v75
 v_add_u32 v48, 32768, v46
 v_mfma_f32_16x16x32_bf16 v[100:103], v[180:183], a[248:251], 0
 v_mfma_f32_16x16x32_bf16 v[104:107], v[180:183], a[252:255], 0
 v_mfma_f32_16x16x32_bf16 v[108:111], v[184:187], a[248:251], 0
 v_mfma_f32_16x16x32_bf16 v[112:115], v[184:187], a[252:255], 0
 s_waitcnt vmcnt(5)
 v_mfma_f32_16x16x32_bf16 v[100:103], v[76:79], a[248:251], v[100:103]
 v_mfma_f32_16x16x32_bf16 v[104:107], v[76:79], a[252:255], v[104:107]
 s_waitcnt vmcnt(4)
 v_mfma_f32_16x16x32_bf16 v[108:111], v[80:83], a[248:251], v[108:111]
 v_mfma_f32_16x16x32_bf16 v[112:115], v[80:83], a[252:255], v[112:115]
 s_waitcnt vmcnt(2)
 v_max_u32 v43, v84, v88
 v_cmp_eq_u32 vcc, -1, v43
 s_cbranch_vccnz L_slow0s2
L_back0s2:
 v_mfma_f32_16x16x32_bf16 v[100:103], v[84:87], a[248:251], v[100:103]
 v_mfma_f32_16x16x32_bf16 v[104:107], v[84:87], a[252:255], v[104:107]
 v_mfma_f32_16x16x32_bf16 v[108:111], v[88:91], a[248:251], v[108:111]
 v_mfma_f32_16x16x32_bf16 v[112:115], v[88:91], a[252:255], v[112:115]
 s_waitcnt vmcnt(0)
 v_max_u32 v43, v92, v96
 v_cmp_eq_u32 vcc, -1, v43
 s_cbranch_vccnz L_slow0s3
L_back0s3:
 v_mfma_f32_16x16x32_bf16 v[100:103], v[92:95], a[248:251], v[100:103]
 v_mfma_f32_16x16x32_bf16 v[104:107], v[92:95], a[252:255], v[104:107]
 v_mfma_f32_16x16x32_bf16 v[108:111], v[96:99], a[248:251], v[108:111]
 v_mfma_f32_16x16x32_bf16 v[112:115], v[96:99], a[252:255], v[112:115]
 s_nop 5
 v_cvt_pk_bf16_f32 v60, v100, v104
 global_store_dword v46, v60, s[24:25] offset:-4096 sc0 sc1
 v_cvt_pk_bf16_f32 v61, v101, v105
 global_store_dword v46, v61, s[24:25] offset:-2048 sc0 sc1
 v_cvt_pk_bf16_f32 v62, v102, v106
 global_store_dword v46, v62, s[24:25] offset:0 sc0 sc1
 v_cvt_pk_bf16_f32 v63, v103, v107
 global_store_dword v46, v63, s[24:25] offset:2048 sc0 sc1
 v_cvt_pk_bf16_f32 v64, v108, v112
 global_store_dword v48, v64, s[24:25] offset:-4096 sc0 sc1
 v_cvt_pk_bf16_f32 v65, v109, v113
 global_store_dword v48, v65, s[24:25] offset:-2048 sc0 sc1
 v_cvt_pk_bf16_f32 v66, v110, v114
 global_store_dword v48, v66, s[24:25] offset:0 sc0 sc1
 v_cvt_pk_bf16_f32 v67, v111, v115
 global_store_dword v48, v67, s[24:25] offset:2048 sc0 sc1
 s_endpgm
L_pad0_3774:
 s_branch L_ret0_1
L_slow0p:
 s_mov_b32 s67, 400000
L_spin0p:
 buffer_load_dword v43, v42, s[32:35], s73 offen offset:8 sc1
 s_waitcnt vmcnt(0)
 v_cmp_ne_u32 vcc, 1, v43
 s_cbranch_vccz L_back0p
 s_sub_u32 s67, s67, 1
 s_cmp_lg_u32 s67, 0
 s_cbranch_scc1 L_spin0p
 s_branch L_back0p
L_init0:
 s_mov_b64 exec, 1
 global_store_dword v45, v44, s[28:29] sc1
 s_mov_b64 exec, -1
 s_branch L_noinit0
L_slow0s2:
 s_mov_b32 s67, 400000
L_spin0s2:
 global_load_dwordx4 v[84:87], v40, s[40:41] offset:0 sc1
 global_load_dwordx4 v[88:91], v40, s[40:41] offset:1024 sc1
 s_waitcnt vmcnt(0)
 v_max_u32 v43, v84, v88
 v_cmp_eq_u32 vcc, -1, v43
 s_cbranch_vccz L_back0s2
 s_sub_u32 s67, s67, 1
 s_cmp_lg_u32 s67, 0
 s_cbranch_scc1 L_spin0s2
 s_branch L_back0s2
L_slow0s3:
 s_mov_b32 s67, 400000
L_spin0s3:
 global_load_dwordx4 v[92:95], v40, s[36:37] offset:0 sc1
 global_load_dwordx4 v[96:99], v40, s[36:37] offset:1024 sc1
 s_waitcnt vmcnt(0)
 v_max_u32 v43, v92, v96
 v_cmp_eq_u32 vcc, -1, v43
 s_cbranch_vccz L_back0s3
 s_sub_u32 s67, s67, 1
 s_cmp_lg_u32 s67, 0
 s_cbranch_scc1 L_spin0s3
 s_branch L_back0s3
L_slow0i:
 s_mov_b32 s67, 400000
L_spin0i:
 global_load_dword v43, v45, s[28:29] sc1
 s_waitcnt vmcnt(0)
 v_cmp_ne_u32 vcc, 1, v43
 s_cbranch_vccz L_back0i
 s_sub_u32 s67, s67, 1
 s_cmp_lg_u32 s67, 0
 s_cbranch_scc1 L_spin0i
 s_branch L_back0i
L_slow0a:
 s_mov_b32 s67, 400000
L_spin0a:
 buffer_load_dword v43, v41, s[32:35], s73 offen offset:0 sc1
 s_waitcnt vmcnt(0)
 v_cmp_ne_u32 vcc, 1, v43
 s_cbranch_vccz L_back0a
 s_sub_u32 s67, s67, 1
 s_cmp_lg_u32 s67, 0
 s_cbranch_scc1 L_spin0a
 s_branch L_back0a
L_slow0b:
 s_mov_b32 s67, 400000
L_spin0b:
 buffer_load_dword v43, v41, s[32:35], s73 offen offset:4 sc1
 s_waitcnt vmcnt(0)
 v_cmp_ne_u32 vcc, 1, v43
 s_cbranch_vccz L_back0b
 s_sub_u32 s67, s67, 1
 s_cmp_lg_u32 s67, 0
 s_cbranch_scc1 L_spin0b
 s_branch L_back0b
.p2align 12
L_v1:
 s_mov_b64 exec, 0
 s_cmp_eq_u32 s62, 0
 s_cbranch_scc1 L_hop1_0_0
 s_cmp_eq_u32 s62, 1
 s_cbranch_scc1 L_hop1_0_1
 s_cmp_eq_u32 s62, 2
 s_cbranch_scc1 L_hop1_0_2
 s_branch L_hop1_0_3
L_ret1_0:
 s_mov_b64 exec, -1
 s_waitcnt vmcnt(8)
 s_barrier
 ds_read_b128 a[0:3], v16 offset:0
 ds_read_b128 a[4:7], v16 offset:2176
 ds_read_b128 a[8:11], v16 offset:64
 ds_read_b128 a[12:15], v16 offset:2240
 ds_read_b64_tr_b16 a[192:193], v28 offset:0
 ds_read_b64_tr_b16 a[194:195], v28 offset:4224
 ds_read_b64_tr_b16 a[196:197], v28 offset:32
 ds_read_b64_tr_b16 a[198:199], v28 offset:4256
 ds_read_b64_tr_b16 a[200:201], v29 offset:0
 ds_read_b64_tr_b16 a[202:203], v29 offset:4224
 ds_read_b64_tr_b16 a[204:205], v29 offset:32
 ds_read_b64_tr_b16 a[206:207], v29 offset:4256
 ds_read_b64_tr_b16 a[208:209], v30 offset:0
 ds_read_b64_tr_b16 a[210:211], v30 offset:4224
 ds_read_b64_tr_b16 a[212:213], v30 offset:32
 ds_read_b64_tr_b16 a[214:215], v30 offset:4256
 s_waitcnt lgkmcnt(4)
 v_mfma_f32_16x16x32_bf16 v[60:63], a[192:195], a[0:3], 0
 ds_read_b64_tr_b16 a[216:217], v31 offset:0
 s_add_u32 m0, s63, 33792
 s_xor_b32 s66, s81, 0x100000
 v_mfma_f32_16x16x32_bf16 v[64:67], a[192:195], a[4:7], 0
 ds_read_b64_tr_b16 a[218:219], v31 offset:4224
 s_add_u32 s86, s16, s66
 s_addc_u32 s87, s17, 0
 v_mfma_f32_16x16x32_bf16 v[68:71], a[196:199], a[0:3], 0
 ds_read_b64_tr_b16 a[220:221], v31 offset:32
 global_load_lds_dwordx4 v4, s[86:87] offset:0
 v_mfma_f32_16x16x32_bf16 v[72:75], a[196:199], a[4:7], 0
 ds_read_b64_tr_b16 a[222:223], v31 offset:4256
 s_xor_b32 s3, s79, 0xf0000
 v_mfma_f32_16x16x32_bf16 v[76:79], a[200:203], a[0:3], 0
 ds_read_b64_tr_b16 a[192:193], v28 offset:8448
 s_add_u32 s0, s20, s3
 s_addc_u32 s1, s21, 0
 v_mfma_f32_16x16x32_bf16 v[80:83], a[200:203], a[4:7], 0
 ds_read_b64_tr_b16 a[194:195], v28 offset:12672
 global_load_lds_dwordx4 v5, s[86:87] offset:1056
 v_mfma_f32_16x16x32_bf16 v[84:87], a[204:207], a[0:3], 0
 ds_read_b64_tr_b16 a[196:197], v28 offset:8480
 s_xor_b32 s3, s79, 0xe0000
 v_mfma_f32_16x16x32_bf16 v[88:91], a[204:207], a[4:7], 0
 ds_read_b64_tr_b16 a[198:199], v28 offset:12704
 s_waitcnt lgkmcnt(4)
 v_mfma_f32_16x16x32_bf16 v[92:95], a[208:211], a[0:3], 0
 ds_read_b64_tr_b16 a[200:201], v29 offset:8448
 global_load_lds_dwordx4 v6, s[86:87] offset:2112
 v_mfma_f32_16x16x32_bf16 v[96:99], a[208:211], a[4:7], 0
 ds_read_b64_tr_b16 a[202:203], v29 offset:12672
 s_add_u32 s6, s20, s3
 s_addc_u32 s7, s21, 0
 v_mfma_f32_16x16x32_bf16 v[100:103], a[212:215], a[0:3], 0
 ds_read_b64_tr_b16 a[204:205], v29 offset:8480
 s_xor_b32 s3, s79, 0xb0000
 v_mfma_f32_16x16x32_bf16 v[104:107], a[212:215], a[4:7], 0
 ds_read_b64_tr_b16 a[206:207], v29 offset:12704
 global_load_lds_dwordx4 v7, s[86:87] offset:3168
 v_mfma_f32_16x16x32_bf16 v[108:111], a[216:219], a[0:3], 0
 ds_read_b64_tr_b16 a[208:209], v30 offset:8448
 s_add_u32 m0, s64, 0
 s_xor_b32 s66, s80, 0x100
 v_mfma_f32_16x16x32_bf16 v[112:115], a[216:219], a[4:7], 0
 ds_read_b64_tr_b16 a[210:211], v30 offset:12672
 s_add_u32 s86, s4, s66
 s_addc_u32 s87, s5, 0
 v_mfma_f32_16x16x32_bf16 v[116:119], a[220:223], a[0:3], 0
 ds_read_b64_tr_b16 a[212:213], v30 offset:8480
 global_load_lds_dwordx4 v8, s[86:87] offset:0
 v_mfma_f32_16x16x32_bf16 v[120:123], a[220:223], a[4:7], 0
 ds_read_b64_tr_b16 a[214:215], v30 offset:12704
 s_waitcnt lgkmcnt(4)
 v_mfma_f32_16x16x32_bf16 v[60:63], a[192:195], a[8:11], v[60:63]
 ds_read_b64_tr_b16 a[216:217], v31 offset:8448
 s_add_u32 s10, s20, s3
 s_addc_u32 s11, s21, 0
 v_mfma_f32_16x16x32_bf16 v[64:67], a[192:195], a[12:15], v[64:67]
 ds_read_b64_tr_b16 a[218:219], v31 offset:12672
 global_load_lds_dwordx4 v9, s[86:87] offset:1088
 v_mfma_f32_16x16x32_bf16 v[68:71], a[196:199], a[8:11], v[68:71]
 ds_read_b64_tr_b16 a[220:221], v31 offset:8480
 s_xor_b32 s3, s79, 0xa0000
 v_mfma_f32_16x16x32_bf16 v[72:75], a[196:199], a[12:15], v[72:75]
 ds_read_b64_tr_b16 a[222:223], v31 offset:12704
 s_waitcnt vmcnt(10)
 s_barrier
 s_cmp_lg_u32 s68, 0
 s_cbranch_scc0 L_init1
L_noinit1:
 v_mfma_f32_16x16x32_bf16 v[76:79], a[200:203], a[8:11], v[76:79]
 ds_read_b64_tr_b16 a[192:193], v28 offset:16896
 global_load_lds_dwordx4 v10, s[86:87] offset:2176
 v_mfma_f32_16x16x32_bf16 v[80:83], a[200:203], a[12:15], v[80:83]
 ds_read_b64_tr_b16 a[194:195], v28 offset:21120
 s_waitcnt vmcnt(7)
 ds_read_b128 a[16:19], v16 offset:4352
 v_mfma_f32_16x16x32_bf16 v[84:87], a[204:207], a[8:11], v[84:87]
 ds_read_b64_tr_b16 a[196:197], v28 offset:16928
 s_add_u32 s14, s20, s3
 s_addc_u32 s15, s21, 0
 v_mfma_f32_16x16x32_bf16 v[88:91], a[204:207], a[12:15], v[88:91]
 ds_read_b64_tr_b16 a[198:199], v28 offset:21152
 global_load_lds_dwordx4 v11, s[86:87] offset:3264
 s_waitcnt lgkmcnt(5)
 v_mfma_f32_16x16x32_bf16 v[92:95], a[208:211], a[8:11], v[92:95]
 ds_read_b64_tr_b16 a[200:201], v29 offset:16896
 s_add_u32 m0, s64, 12800
 s_xor_b32 s66, s69, 0x1000
 ds_read_b128 a[20:23], v16 offset:6528
 v_mfma_f32_16x16x32_bf16 v[96:99], a[208:211], a[12:15], v[96:99]
 ds_read_b64_tr_b16 a[202:203], v29 offset:21120
 s_add_u32 s86, s8, s66
 s_addc_u32 s87, s9, 0
 v_mfma_f32_16x16x32_bf16 v[100:103], a[212:215], a[8:11], v[100:103]
 ds_read_b64_tr_b16 a[204:205], v29 offset:16928
 global_load_lds_dwordx4 v17, s[86:87] offset:-4096 nt
 ds_read_b128 a[24:27], v16 offset:4416
 v_mfma_f32_16x16x32_bf16 v[104:107], a[212:215], a[12:15], v[104:107]
 ds_read_b64_tr_b16 a[206:207], v29 offset:21152
 s_add_u32 m0, s64, 12864
 s_xor_b32 s3, s79, 0x70000
 v_mfma_f32_16x16x32_bf16 v[108:111], a[216:219], a[8:11], v[108:111]
 ds_read_b64_tr_b16 a[208:209], v30 offset:16896
 ds_read_b128 a[28:31], v16 offset:6592
 v_mfma_f32_16x16x32_bf16 v[112:115], a[216:219], a[12:15], v[112:115]
 ds_read_b64_tr_b16 a[210:211], v30 offset:21120
 global_load_lds_dwordx4 v17, s[86:87] offset:-3072 nt
 v_mfma_f32_16x16x32_bf16 v[116:119], a[220:223], a[8:11], v[116:119]
 ds_read_b64_tr_b16 a[212:213], v30 offset:16928
 s_add_u32 m0, s64, 12928
 s_add_u32 s18, s20, s3
 s_addc_u32 s19, s21, 0
 v_mfma_f32_16x16x32_bf16 v[120:123], a[220:223], a[12:15], v[120:123]
 ds_read_b64_tr_b16 a[214:215], v30 offset:21152
 s_waitcnt lgkmcnt(5)
 v_mfma_f32_16x16x32_bf16 v[60:63], a[192:195], a[16:19], v[60:63]
 ds_read_b64_tr_b16 a[216:217], v31 offset:16896
 global_load_lds_dwordx4 v17, s[86:87] offset:-2048 nt
 v_mfma_f32_16x16x32_bf16 v[64:67], a[192:195], a[20:23], v[64:67]
 ds_read_b64_tr_b16 a[218:219], v31 offset:21120
 s_add_u32 m0, s64, 12992
 s_xor_b32 s3, s79, 0x60000
 v_mfma_f32_16x16x32_bf16 v[68:71], a[196:199], a[16:19], v[68:71]
 ds_read_b64_tr_b16 a[220:221], v31 offset:16928
 s_add_u32 s22, s20, s3
 s_addc_u32 s23, s21, 0
 v_mfma_f32_16x16x32_bf16 v[72:75], a[196:199], a[20:23], v[72:75]
 ds_read_b64_tr_b16 a[222:223], v31 offset:21152
 global_load_lds_dwordx4 v17, s[86:87] offset:-1024 nt
 v_mfma_f32_16x16x32_bf16 v[76:79], a[200:203], a[16:19], v[76:79]
 ds_read_b64_tr_b16 a[192:193], v28 offset:25344
 s_add_u32 m0, s64, 13056
 v_mfma_f32_16x16x32_bf16 v[80:83], a[200:203], a[20:23], v[80:83]
 ds_read_b64_tr_b16 a[194:195], v28 offset:29568
 s_xor_b32 s3, s79, 0x30000
 v_mfma_f32_16x16x32_bf16 v[84:87], a[204:207], a[16:19], v[84:87]
 ds_read_b64_tr_b16 a[196:197], v28 offset:25376
 global_load_lds_dwordx4 v17, s[86:87] offset:0 nt
 v_mfma_f32_16x16x32_bf16 v[88:91], a[204:207], a[20:23], v[88:91]
 ds_read_b64_tr_b16 a[198:199], v28 offset:29600
 s_add_u32 m0, s64, 13120
 s_waitcnt lgkmcnt(4)
 v_mfma_f32_16x16x32_bf16 v[92:95], a[208:211], a[16:19], v[92:95]
 ds_read_b64_tr_b16 a[200:201], v29 offset:25344
 s_add_u32 s26, s20, s3
 s_addc_u32 s27, s21, 0
 v_mfma_f32_16x16x32_bf16 v[96:99], a[208:211], a[20:23], v[96:99]
 ds_read_b64_tr_b16 a[202:203], v29 offset:29568
 s_xor_b32 s3, s79, 0x20000
 v_mfma_f32_16x16x32_bf16 v[100:103], a[212:215], a[16:19], v[100:103]
 ds_read_b64_tr_b16 a[204:205], v29 offset:25376
 global_load_lds_dwordx4 v17, s[86:87] offset:1024 nt
 v_mfma_f32_16x16x32_bf16 v[104:107], a[212:215], a[20:23], v[104:107]
 ds_read_b64_tr_b16 a[206:207], v29 offset:29600
 s_add_u32 m0, s64, 13184
 v_mfma_f32_16x16x32_bf16 v[108:111], a[216:219], a[16:19], v[108:111]
 ds_read_b64_tr_b16 a[208:209], v30 offset:25344
 s_add_u32 s30, s20, s3
 s_addc_u32 s31, s21, 0
 v_mfma_f32_16x16x32_bf16 v[112:115], a[216:219], a[20:23], v[112:115]
 ds_read_b64_tr_b16 a[210:211], v30 offset:29568
 s_xor_b32 s3, s79, 0xd0000
 v_mfma_f32_16x16x32_bf16 v[116:119], a[220:223], a[16:19], v[116:119]
 ds_read_b64_tr_b16 a[212:213], v30 offset:25376
 s_add_u32 s36, s20, s3
 s_addc_u32 s37, s21, 0
 v_mfma_f32_16x16x32_bf16 v[120:123], a[220:223], a[20:23], v[120:123]
 ds_read_b64_tr_b16 a[214:215], v30 offset:29600
 s_waitcnt lgkmcnt(4)
 v_mfma_f32_16x16x32_bf16 v[60:63], a[192:195], a[24:27], v[60:63]
 ds_read_b64_tr_b16 a[216:217], v31 offset:25344
 global_load_lds_dwordx4 v17, s[86:87] offset:2048 nt
 v_mfma_f32_16x16x32_bf16 v[64:67], a[192:195], a[28:31], v[64:67]
 ds_read_b64_tr_b16 a[218:219], v31 offset:29568
 s_add_u32 m0, s64, 13248
 v_mfma_f32_16x16x32_bf16 v[68:71], a[196:199], a[24:27], v[68:71]
 ds_read_b64_tr_b16 a[220:221], v31 offset:25376
 s_xor_b32 s3, s79, 0xc0000
 v_mfma_f32_16x16x32_bf16 v[72:75], a[196:199], a[28:31], v[72:75]
 ds_read_b64_tr_b16 a[222:223], v31 offset:29600
 s_waitcnt vmcnt(11)
 s_barrier
 v_mfma_f32_16x16x32_bf16 v[76:79], a[200:203], a[24:27], v[76:79]
 ds_read_b64_tr_b16 a[192:193], v28 offset:33792
 s_add_u32 s38, s20, s3
 s_addc_u32 s39, s21, 0
 v_mfma_f32_16x16x32_bf16 v[80:83], a[200:203], a[28:31], v[80:83]
 ds_read_b64_tr_b16 a[194:195], v28 offset:38016
 s_xor_b32 s3, s79, 0x90000
 v_mfma_f32_16x16x32_bf16 v[84:87], a[204:207], a[24:27], v[84:87]
 ds_read_b64_tr_b16 a[196:197], v28 offset:33824
 global_load_lds_dwordx4 v17, s[86:87] offset:3072 nt
 v_mfma_f32_16x16x32_bf16 v[88:91], a[204:207], a[28:31], v[88:91]
 ds_read_b64_tr_b16 a[198:199], v28 offset:38048
 s_add_u32 m0, s63, 50688
 s_xor_b32 s66, s81, 0x180000
 s_waitcnt lgkmcnt(4)
 v_mfma_f32_16x16x32_bf16 v[92:95], a[208:211], a[24:27], v[92:95]
 ds_read_b64_tr_b16 a[200:201], v29 offset:33792
 s_add_u32 s86, s16, s66
 s_addc_u32 s87, s17, 0
 v_mfma_f32_16x16x32_bf16 v[96:99], a[208:211], a[28:31], v[96:99]
 ds_read_b64_tr_b16 a[202:203], v29 offset:38016
 s_waitcnt vmcnt(8)
 ds_read_b128 a[32:35], v16 offset:0
 global_load_lds_dwordx4 v4, s[86:87] offset:0
 v_mfma_f32_16x16x32_bf16 v[100:103], a[212:215], a[24:27], v[100:103]
 ds_read_b64_tr_b16 a[204:205], v29 offset:33824
 ds_read_b128 a[36:39], v16 offset:2176
 v_mfma_f32_16x16x32_bf16 v[104:107], a[212:215], a[28:31], v[104:107]
 ds_read_b64_tr_b16 a[206:207], v29 offset:38048
 ds_read_b128 a[40:43], v16 offset:64
 v_mfma_f32_16x16x32_bf16 v[108:111], a[216:219], a[24:27], v[108:111]
 ds_read_b64_tr_b16 a[208:209], v30 offset:33792
 global_load_lds_dwordx4 v5, s[86:87] offset:1056
 ds_read_b128 a[44:47], v16 offset:2240
 v_mfma_f32_16x16x32_bf16 v[112:115], a[216:219], a[28:31], v[112:115]
 ds_read_b64_tr_b16 a[210:211], v30 offset:38016
 s_add_u32 s40, s20, s3
 s_addc_u32 s41, s21, 0
 v_mfma_f32_16x16x32_bf16 v[116:119], a[220:223], a[24:27], v[116:119]
 ds_read_b64_tr_b16 a[212:213], v30 offset:33824
 s_xor_b32 s3, s79, 0x80000
 v_mfma_f32_16x16x32_bf16 v[120:123], a[220:223], a[28:31], v[120:123]
 ds_read_b64_tr_b16 a[214:215], v30 offset:38048
 global_load_lds_dwordx4 v6, s[86:87] offset:2112
 s_waitcnt lgkmcnt(6)
 v_mfma_f32_16x16x32_bf16 v[60:63], a[192:195], a[32:35], v[60:63]
 ds_read_b64_tr_b16 a[216:217], v31 offset:33792
 s_add_u32 s42, s20, s3
 s_addc_u32 s43, s21, 0
 v_mfma_f32_16x16x32_bf16 v[64:67], a[192:195], a[36:39], v[64:67]
 ds_read_b64_tr_b16 a[218:219], v31 offset:38016
 s_xor_b32 s3, s79, 0x50000
 v_mfma_f32_16x16x32_bf16 v[68:71], a[196:199], a[32:35], v[68:71]
 ds_read_b64_tr_b16 a[220:221], v31 offset:33824
 global_load_lds_dwordx4 v7, s[86:87] offset:3168
 v_mfma_f32_16x16x32_bf16 v[72:75], a[196:199], a[36:39], v[72:75]
 ds_read_b64_tr_b16 a[222:223], v31 offset:38048
 s_add_u32 m0, s64, 4352
 s_xor_b32 s66, s80, 0x180
 v_mfma_f32_16x16x32_bf16 v[76:79], a[200:203], a[32:35], v[76:79]
 ds_read_b64_tr_b16 a[192:193], v28 offset:42240
 s_add_u32 s86, s4, s66
 s_addc_u32 s87, s5, 0
 v_mfma_f32_16x16x32_bf16 v[80:83], a[200:203], a[36:39], v[80:83]
 ds_read_b64_tr_b16 a[194:195], v28 offset:46464
 global_load_lds_dwordx4 v8, s[86:87] offset:0
 v_mfma_f32_16x16x32_bf16 v[84:87], a[204:207], a[32:35], v[84:87]
 ds_read_b64_tr_b16 a[196:197], v28 offset:42272
 s_add_u32 s44, s20, s3
 s_addc_u32 s45, s21, 0
 v_mfma_f32_16x16x32_bf16 v[88:91], a[204:207], a[36:39], v[88:91]
 ds_read_b64_tr_b16 a[198:199], v28 offset:46496
 s_waitcnt lgkmcnt(4)
 v_mfma_f32_16x16x32_bf16 v[92:95], a[208:211], a[32:35], v[92:95]
 ds_read_b64_tr_b16 a[200:201], v29 offset:42240
 s_xor_b32 s3, s79, 0x40000
 v_mfma_f32_16x16x32_bf16 v[96:99], a[208:211], a[36:39], v[96:99]
 ds_read_b64_tr_b16 a[202:203], v29 offset:46464
L_hop1_0_0:
L_pad1_292:
 s_cbranch_execz L_ret1_0
 s_add_u32 s46, s20, s3
 s_addc_u32 s47, s21, 0
 v_mfma_f32_16x16x32_bf16 v[100:103], a[212:215], a[32:35], v[100:103]
 ds_read_b64_tr_b16 a[204:205], v29 offset:42272
 global_load_lds_dwordx4 v9, s[86:87] offset:1088
 v_mfma_f32_16x16x32_bf16 v[104:107], a[212:215], a[36:39], v[104:107]
 ds_read_b64_tr_b16 a[206:207], v29 offset:46496
 s_xor_b32 s3, s79, 0x10000
 v_mfma_f32_16x16x32_bf16 v[108:111], a[216:219], a[32:35], v[108:111]
 ds_read_b64_tr_b16 a[208:209], v30 offset:42240
 s_add_u32 s48, s20, s3
 s_addc_u32 s49, s21, 0
 v_mfma_f32_16x16x32_bf16 v[112:115], a[216:219], a[36:39], v[112:115]
 ds_read_b64_tr_b16 a[210:211], v30 offset:46464
 s_xor_b32 s3, s69, 0xf000
 v_mfma_f32_16x16x32_bf16 v[116:119], a[220:223], a[32:35], v[116:119]
 ds_read_b64_tr_b16 a[212:213], v30 offset:42272
 s_add_u32 s50, s12, s3
 s_addc_u32 s51, s13, 0
 v_mfma_f32_16x16x32_bf16 v[120:123], a[220:223], a[36:39], v[120:123]
 ds_read_b64_tr_b16 a[214:215], v30 offset:46496
 s_waitcnt lgkmcnt(4)
 v_mfma_f32_16x16x32_bf16 v[60:63], a[192:195], a[40:43], v[60:63]
 ds_read_b64_tr_b16 a[216:217], v31 offset:42240
 global_load_lds_dwordx4 v10, s[86:87] offset:2176
 v_mfma_f32_16x16x32_bf16 v[64:67], a[192:195], a[44:47], v[64:67]
 ds_read_b64_tr_b16 a[218:219], v31 offset:46464
 s_xor_b32 s3, s69, 0xb000
 v_mfma_f32_16x16x32_bf16 v[68:71], a[196:199], a[40:43], v[68:71]
 ds_read_b64_tr_b16 a[220:221], v31 offset:42272
 s_add_u32 s52, s12, s3
 s_addc_u32 s53, s13, 0
 v_mfma_f32_16x16x32_bf16 v[72:75], a[196:199], a[44:47], v[72:75]
 ds_read_b64_tr_b16 a[222:223], v31 offset:46496
 s_waitcnt vmcnt(3)
 s_barrier
 v_mfma_f32_16x16x32_bf16 v[76:79], a[200:203], a[40:43], v[76:79]
 ds_read_b64_tr_b16 a[192:193], v32 offset:0
 global_load_lds_dwordx4 v11, s[86:87] offset:3264
 v_mfma_f32_16x16x32_bf16 v[80:83], a[200:203], a[44:47], v[80:83]
 ds_read_b64_tr_b16 a[194:195], v32 offset:4224
 s_add_u32 m0, s63, 67584
 s_xor_b32 s66, s71, 0x200000
 v_mfma_f32_16x16x32_bf16 v[84:87], a[204:207], a[40:43], v[84:87]
 ds_read_b64_tr_b16 a[196:197], v32 offset:32
 s_add_u32 s86, s16, s66
 s_addc_u32 s87, s17, 0
 ds_read_b64 a[128:129], v18 offset:8704
 v_mfma_f32_16x16x32_bf16 v[88:91], a[204:207], a[44:47], v[88:91]
 ds_read_b64_tr_b16 a[198:199], v32 offset:4256
 global_load_lds_dwordx4 v4, s[86:87] offset:0
 s_waitcnt lgkmcnt(5)
 v_mfma_f32_16x16x32_bf16 v[92:95], a[208:211], a[40:43], v[92:95]
 ds_read_b64_tr_b16 a[200:201], v33 offset:0
 ds_read_b64 a[130:131], v19 offset:8704
 v_mfma_f32_16x16x32_bf16 v[96:99], a[208:211], a[44:47], v[96:99]
 ds_read_b64_tr_b16 a[202:203], v33 offset:4224
 s_waitcnt vmcnt(1)
 ds_read_b128 a[48:51], v16 offset:4352
 v_mfma_f32_16x16x32_bf16 v[100:103], a[212:215], a[40:43], v[100:103]
 ds_read_b64_tr_b16 a[204:205], v33 offset:32
 global_load_lds_dwordx4 v5, s[86:87] offset:1056
 ds_read_b64 a[132:133], v18 offset:13056
 ds_read_b128 a[52:55], v16 offset:6528
 v_mfma_f32_16x16x32_bf16 v[104:107], a[212:215], a[44:47], v[104:107]
 ds_read_b64_tr_b16 a[206:207], v33 offset:4256
 ds_read_b128 a[56:59], v16 offset:4416
 v_mfma_f32_16x16x32_bf16 v[108:111], a[216:219], a[40:43], v[108:111]
 ds_read_b64_tr_b16 a[208:209], v34 offset:0
 ds_read_b64 a[134:135], v19 offset:13056
 ds_read_b128 a[60:63], v16 offset:6592
 v_mfma_f32_16x16x32_bf16 v[112:115], a[216:219], a[44:47], v[112:115]
 ds_read_b64_tr_b16 a[210:211], v34 offset:4224
 global_load_lds_dwordx4 v6, s[86:87] offset:2112
 v_mfma_f32_16x16x32_bf16 v[116:119], a[220:223], a[40:43], v[116:119]
 ds_read_b64_tr_b16 a[212:213], v34 offset:32
 ds_read_b64 a[136:137], v18 offset:8768
 v_mfma_f32_16x16x32_bf16 v[120:123], a[220:223], a[44:47], v[120:123]
 ds_read_b64_tr_b16 a[214:215], v34 offset:4256
 s_waitcnt lgkmcnt(8)
 v_mfma_f32_16x16x32_bf16 v[60:63], a[192:195], a[48:51], v[60:63]
 ds_read_b64_tr_b16 a[216:217], v35 offset:0
 global_load_lds_dwordx4 v7, s[86:87] offset:3168
 ds_read_b64 a[138:139], v19 offset:8768
 v_mfma_f32_16x16x32_bf16 v[64:67], a[192:195], a[52:55], v[64:67]
 ds_read_b64_tr_b16 a[218:219], v35 offset:4224
 s_add_u32 m0, s64, 0
 s_xor_b32 s66, s70, 0x200
 v_mfma_f32_16x16x32_bf16 v[68:71], a[196:199], a[48:51], v[68:71]
 ds_read_b64_tr_b16 a[220:221], v35 offset:32
 s_add_u32 s86, s4, s66
 s_addc_u32 s87, s5, 0
 ds_read_b64 a[140:141], v18 offset:13120
 v_mfma_f32_16x16x32_bf16 v[72:75], a[196:199], a[52:55], v[72:75]
 ds_read_b64_tr_b16 a[222:223], v35 offset:4256
 global_load_lds_dwordx4 v8, s[86:87] offset:0
 v_mfma_f32_16x16x32_bf16 v[76:79], a[200:203], a[48:51], v[76:79]
 ds_read_b64_tr_b16 a[192:193], v32 offset:8448
 ds_read_b64 a[142:143], v19 offset:13120
 v_mfma_f32_16x16x32_bf16 v[80:83], a[200:203], a[52:55], v[80:83]
 ds_read_b64_tr_b16 a[194:195], v32 offset:12672
 ds_read_b64 a[144:145], v18 offset:8832
 v_mfma_f32_16x16x32_bf16 v[84:87], a[204:207], a[48:51], v[84:87]
 ds_read_b64_tr_b16 a[196:197], v32 offset:8480
 global_load_lds_dwordx4 v9, s[86:87] offset:1088
 v_mfma_f32_16x16x32_bf16 v[88:91], a[204:207], a[52:55], v[88:91]
 ds_read_b64_tr_b16 a[198:199], v32 offset:12704
 s_waitcnt lgkmcnt(6)
 v_mfma_f32_16x16x32_bf16 v[92:95], a[208:211], a[48:51], v[92:95]
 ds_read_b64_tr_b16 a[200:201], v33 offset:8448
 ds_read_b64 a[146:147], v19 offset:8832
 v_mfma_f32_16x16x32_bf16 v[96:99], a[208:211], a[52:55], v[96:99]
 ds_read_b64_tr_b16 a[202:203], v33 offset:12672
 global_load_lds_dwordx4 v10, s[86:87] offset:2176
 s_xor_b32 s3, s69, 0x7000
 v_mfma_f32_16x16x32_bf16 v[100:103], a[212:215], a[48:51], v[100:103]
 ds_read_b64_tr_b16 a[204:205], v33 offset:8480
 ds_read_b64 a[148:149], v18 offset:13184
 v_mfma_f32_16x16x32_bf16 v[104:107], a[212:215], a[52:55], v[104:107]
 ds_read_b64_tr_b16 a[206:207], v33 offset:12704
 s_add_u32 s54, s12, s3
 s_addc_u32 s55, s13, 0
 v_mfma_f32_16x16x32_bf16 v[108:111], a[216:219], a[48:51], v[108:111]
 ds_read_b64_tr_b16 a[208:209], v34 offset:8448
 global_load_lds_dwordx4 v11, s[86:87] offset:3264
 ds_read_b64 a[150:151], v19 offset:13184
 v_mfma_f32_16x16x32_bf16 v[112:115], a[216:219], a[52:55], v[112:115]
 ds_read_b64_tr_b16 a[210:211], v34 offset:12672
 s_add_u32 m0, s63, 0
 s_xor_b32 s66, s81, 0x100
 v_mfma_f32_16x16x32_bf16 v[116:119], a[220:223], a[48:51], v[116:119]
 ds_read_b64_tr_b16 a[212:213], v34 offset:8480
 s_add_u32 s86, s16, s66
 s_addc_u32 s87, s17, 0
 ds_read_b64 a[152:153], v18 offset:8896
 v_mfma_f32_16x16x32_bf16 v[120:123], a[220:223], a[52:55], v[120:123]
 ds_read_b64_tr_b16 a[214:215], v34 offset:12704
 global_load_lds_dwordx4 v4, s[86:87] offset:0
 s_xor_b32 s3, s69, 0x3000
 s_waitcnt lgkmcnt(6)
 v_mfma_f32_16x16x32_bf16 v[60:63], a[192:195], a[56:59], v[60:63]
 ds_read_b64_tr_b16 a[216:217], v35 offset:8448
 ds_read_b64 a[154:155], v19 offset:8896
 v_mfma_f32_16x16x32_bf16 v[64:67], a[192:195], a[60:63], v[64:67]
 ds_read_b64_tr_b16 a[218:219], v35 offset:12672
 s_add_u32 s56, s12, s3
 s_addc_u32 s57, s13, 0
 v_mfma_f32_16x16x32_bf16 v[68:71], a[196:199], a[56:59], v[68:71]
 ds_read_b64_tr_b16 a[220:221], v35 offset:8480
 global_load_lds_dwordx4 v5, s[86:87] offset:1056
 ds_read_b64 a[156:157], v18 offset:13248
 v_mfma_f32_16x16x32_bf16 v[72:75], a[196:199], a[60:63], v[72:75]
 ds_read_b64_tr_b16 a[222:223], v35 offset:12704
 s_waitcnt vmcnt(6)
 s_barrier
 v_mfma_f32_16x16x32_bf16 v[76:79], a[200:203], a[56:59], v[76:79]
 ds_read_b64_tr_b16 a[192:193], v32 offset:16896
 ds_read_b64 a[158:159], v19 offset:13248
 v_mfma_f32_16x16x32_bf16 v[80:83], a[200:203], a[60:63], v[80:83]
 ds_read_b64_tr_b16 a[194:195], v32 offset:21120
 global_load_lds_dwordx4 v6, s[86:87] offset:2112
 s_xor_b32 s3, s69, 0xd000
 v_mfma_f32_16x16x32_bf16 v[84:87], a[204:207], a[56:59], v[84:87]
 ds_read_b64_tr_b16 a[196:197], v32 offset:16928
 s_add_u32 s58, s12, s3
 s_addc_u32 s59, s13, 0
 v_mfma_f32_16x16x32_bf16 v[88:91], a[204:207], a[60:63], v[88:91]
 ds_read_b64_tr_b16 a[198:199], v32 offset:21152
 s_waitcnt lgkmcnt(5)
 v_mfma_f32_16x16x32_bf16 v[92:95], a[208:211], a[56:59], v[92:95]
 ds_read_b64_tr_b16 a[200:201], v33 offset:16896
 global_load_lds_dwordx4 v7, s[86:87] offset:3168
 v_mfma_f32_16x16x32_bf16 v[96:99], a[208:211], a[60:63], v[96:99]
 ds_read_b64_tr_b16 a[202:203], v33 offset:21120
 s_add_u32 m0, s63, 16896
 s_xor_b32 s66, s71, 0x280000
 s_waitcnt vmcnt(4)
 ds_read_b128 a[64:67], v16 offset:0
 v_mfma_f32_16x16x32_bf16 v[100:103], a[212:215], a[56:59], v[100:103]
 ds_read_b64_tr_b16 a[204:205], v33 offset:16928
 s_add_u32 s86, s16, s66
 s_addc_u32 s87, s17, 0
 ds_read_b128 a[68:71], v16 offset:2176
 v_mfma_f32_16x16x32_bf16 v[104:107], a[212:215], a[60:63], v[104:107]
 ds_read_b64_tr_b16 a[206:207], v33 offset:21152
 global_load_lds_dwordx4 v4, s[86:87] offset:0
 s_xor_b32 s3, s69, 0x9000
 ds_read_b128 a[72:75], v16 offset:64
 v_mfma_f32_16x16x32_bf16 v[108:111], a[216:219], a[56:59], v[108:111]
 ds_read_b64_tr_b16 a[208:209], v34 offset:16896
 ds_read_b128 a[76:79], v16 offset:2240
 v_mfma_f32_16x16x32_bf16 v[112:115], a[216:219], a[60:63], v[112:115]
 ds_read_b64_tr_b16 a[210:211], v34 offset:21120
 s_add_u32 s60, s12, s3
 s_addc_u32 s61, s13, 0
 v_mfma_f32_16x16x32_bf16 v[116:119], a[220:223], a[56:59], v[116:119]
 ds_read_b64_tr_b16 a[212:213], v34 offset:16928
 global_load_lds_dwordx4 v5, s[86:87] offset:1056
 v_mfma_f32_16x16x32_bf16 v[120:123], a[220:223], a[60:63], v[120:123]
 ds_read_b64_tr_b16 a[214:215], v34 offset:21152
 s_waitcnt lgkmcnt(6)
 v_mfma_f32_16x16x32_bf16 v[60:63], a[192:195], a[64:67], v[60:63]
 ds_read_b64_tr_b16 a[216:217], v35 offset:16896
 s_xor_b32 s3, s69, 0x5000
 v_mfma_f32_16x16x32_bf16 v[64:67], a[192:195], a[68:71], v[64:67]
 ds_read_b64_tr_b16 a[218:219], v35 offset:21120
 global_load_lds_dwordx4 v6, s[86:87] offset:2112
 v_mfma_f32_16x16x32_bf16 v[68:71], a[196:199], a[64:67], v[68:71]
 ds_read_b64_tr_b16 a[220:221], v35 offset:16928
 s_add_u32 s88, s12, s3
 s_addc_u32 s89, s13, 0
 v_mfma_f32_16x16x32_bf16 v[72:75], a[196:199], a[68:71], v[72:75]
 ds_read_b64_tr_b16 a[222:223], v35 offset:21152
 s_xor_b32 s3, s69, 0x3000
 v_mfma_f32_16x16x32_bf16 v[76:79], a[200:203], a[64:67], v[76:79]
 ds_read_b64_tr_b16 a[192:193], v32 offset:25344
 global_load_lds_dwordx4 v7, s[86:87] offset:3168
 v_mfma_f32_16x16x32_bf16 v[80:83], a[200:203], a[68:71], v[80:83]
 ds_read_b64_tr_b16 a[194:195], v32 offset:29568
 s_add_u32 m0, s64, 4352
 s_xor_b32 s66, s70, 0x280
 v_mfma_f32_16x16x32_bf16 v[84:87], a[204:207], a[64:67], v[84:87]
 ds_read_b64_tr_b16 a[196:197], v32 offset:25376
 s_add_u32 s86, s4, s66
 s_addc_u32 s87, s5, 0
 v_mfma_f32_16x16x32_bf16 v[88:91], a[204:207], a[68:71], v[88:91]
 ds_read_b64_tr_b16 a[198:199], v32 offset:29600
 global_load_lds_dwordx4 v8, s[86:87] offset:0
 s_waitcnt lgkmcnt(4)
 v_mfma_f32_16x16x32_bf16 v[92:95], a[208:211], a[64:67], v[92:95]
 ds_read_b64_tr_b16 a[200:201], v33 offset:25344
 s_add_u32 s90, s8, s3
 s_addc_u32 s91, s9, 0
 v_mfma_f32_16x16x32_bf16 v[96:99], a[208:211], a[68:71], v[96:99]
 ds_read_b64_tr_b16 a[202:203], v33 offset:29568
 s_xor_b32 s3, s71, 0x380100
 v_mfma_f32_16x16x32_bf16 v[100:103], a[212:215], a[64:67], v[100:103]
 ds_read_b64_tr_b16 a[204:205], v33 offset:25376
 global_load_lds_dwordx4 v9, s[86:87] offset:1088
 v_mfma_f32_16x16x32_bf16 v[104:107], a[212:215], a[68:71], v[104:107]
 ds_read_b64_tr_b16 a[206:207], v33 offset:29600
 s_add_u32 s92, s16, s3
 s_addc_u32 s93, s17, 0
 v_mfma_f32_16x16x32_bf16 v[108:111], a[216:219], a[64:67], v[108:111]
 ds_read_b64_tr_b16 a[208:209], v34 offset:25344
 s_xor_b32 s3, s71, 0x300100
 v_mfma_f32_16x16x32_bf16 v[112:115], a[216:219], a[68:71], v[112:115]
 ds_read_b64_tr_b16 a[210:211], v34 offset:29568
 global_load_lds_dwordx4 v10, s[86:87] offset:2176
 v_mfma_f32_16x16x32_bf16 v[116:119], a[220:223], a[64:67], v[116:119]
 ds_read_b64_tr_b16 a[212:213], v34 offset:25376
 s_add_u32 s94, s16, s3
 s_addc_u32 s95, s17, 0
 v_mfma_f32_16x16x32_bf16 v[120:123], a[220:223], a[68:71], v[120:123]
 ds_read_b64_tr_b16 a[214:215], v34 offset:29600
 s_waitcnt lgkmcnt(4)
 v_mfma_f32_16x16x32_bf16 v[60:63], a[192:195], a[72:75], v[60:63]
 ds_read_b64_tr_b16 a[216:217], v35 offset:25344
 global_load_lds_dwordx4 v11, s[86:87] offset:3264
 v_mfma_f32_16x16x32_bf16 v[64:67], a[192:195], a[76:79], v[64:67]
 ds_read_b64_tr_b16 a[218:219], v35 offset:29568
 s_add_u32 m0, s63, 33792
 s_xor_b32 s66, s71, 0x300000
 v_mfma_f32_16x16x32_bf16 v[68:71], a[196:199], a[72:75], v[68:71]
 ds_read_b64_tr_b16 a[220:221], v35 offset:25376
 s_add_u32 s86, s16, s66
 s_addc_u32 s87, s17, 0
 v_mfma_f32_16x16x32_bf16 v[72:75], a[196:199], a[76:79], v[72:75]
 ds_read_b64_tr_b16 a[222:223], v35 offset:29600
 global_load_lds_dwordx4 v4, s[86:87] offset:0
 s_mov_b64 exec, 0
 s_cmp_eq_u32 s62, 0
 s_cbranch_scc1 L_hop1_1_0
 s_cmp_eq_u32 s62, 1
 s_cbranch_scc1 L_hop1_1_1
 s_cmp_eq_u32 s62, 2
 s_cbranch_scc1 L_hop1_1_2
 s_branch L_hop1_1_3
L_ret1_1:
 s_mov_b64 exec, -1
 s_waitcnt vmcnt(9)
 s_barrier
 v_mfma_f32_16x16x32_bf16 v[76:79], a[200:203], a[72:75], v[76:79]
 ds_read_b64_tr_b16 a[192:193], v28 offset:0
 s_xor_b32 s3, s71, 0x280100
 v_mfma_f32_16x16x32_bf16 v[80:83], a[200:203], a[76:79], v[80:83]
 ds_read_b64_tr_b16 a[194:195], v28 offset:4224
 s_add_u32 s96, s16, s3
 s_addc_u32 s97, s17, 0
 v_mfma_f32_16x16x32_bf16 v[84:87], a[204:207], a[72:75], v[84:87]
L_hop1_0_1:
L_pad1_582:
 s_cbranch_execz L_ret1_0
 ds_read_b64_tr_b16 a[196:197], v28 offset:32
 global_load_lds_dwordx4 v5, s[86:87] offset:1056
 v_mfma_f32_16x16x32_bf16 v[88:91], a[204:207], a[76:79], v[88:91]
 ds_read_b64_tr_b16 a[198:199], v28 offset:4256
 s_waitcnt lgkmcnt(4)
 v_mfma_f32_16x16x32_bf16 v[92:95], a[208:211], a[72:75], v[92:95]
 ds_read_b64_tr_b16 a[200:201], v29 offset:0
 s_xor_b32 s3, s71, 0x200100
 v_mfma_f32_16x16x32_bf16 v[96:99], a[208:211], a[76:79], v[96:99]
 ds_read_b64_tr_b16 a[202:203], v29 offset:4224
 global_load_lds_dwordx4 v6, s[86:87] offset:2112
 v_mfma_f32_16x16x32_bf16 v[100:103], a[212:215], a[72:75], v[100:103]
 ds_read_b64_tr_b16 a[204:205], v29 offset:32
 s_add_u32 s98, s16, s3
 s_addc_u32 s99, s17, 0
 v_mfma_f32_16x16x32_bf16 v[104:107], a[212:215], a[76:79], v[104:107]
 ds_read_b64_tr_b16 a[206:207], v29 offset:4256
 s_xor_b32 s3, s81, 0x180100
 v_mfma_f32_16x16x32_bf16 v[108:111], a[216:219], a[72:75], v[108:111]
 ds_read_b64_tr_b16 a[208:209], v30 offset:0
 global_load_lds_dwordx4 v7, s[86:87] offset:3168
 v_mfma_f32_16x16x32_bf16 v[112:115], a[216:219], a[76:79], v[112:115]
 ds_read_b64_tr_b16 a[210:211], v30 offset:4224
 s_add_u32 m0, s63, 50688
 s_xor_b32 s66, s81, 0x80100
 v_mfma_f32_16x16x32_bf16 v[116:119], a[220:223], a[72:75], v[116:119]
 ds_read_b64_tr_b16 a[212:213], v30 offset:32
 s_add_u32 s86, s16, s66
 s_addc_u32 s87, s17, 0
 v_mfma_f32_16x16x32_bf16 v[120:123], a[220:223], a[76:79], v[120:123]
 ds_read_b64_tr_b16 a[214:215], v30 offset:4256
 global_load_lds_dwordx4 v4, s[86:87] offset:0
 s_waitcnt lgkmcnt(4)
 v_mfma_f32_16x16x32_bf16 v[124:127], a[192:195], a[0:3], 0
 ds_read_b64_tr_b16 a[216:217], v31 offset:0
 s_add_u32 s100, s16, s3
 s_addc_u32 s101, s17, 0
 v_mfma_f32_16x16x32_bf16 v[128:131], a[192:195], a[4:7], 0
 ds_read_b64_tr_b16 a[218:219], v31 offset:4224
 s_add_u32 s20, s20, s79
 s_addc_u32 s21, s21, 0
 v_mfma_f32_16x16x32_bf16 v[132:135], a[196:199], a[0:3], 0
 ds_read_b64_tr_b16 a[220:221], v31 offset:32
 global_load_lds_dwordx4 v5, s[86:87] offset:1056
 v_mfma_f32_16x16x32_bf16 v[136:139], a[196:199], a[4:7], 0
 ds_read_b64_tr_b16 a[222:223], v31 offset:4256
 s_waitcnt vmcnt(6)
 ds_read_b128 a[80:83], v16 offset:4352
 v_mfma_f32_16x16x32_bf16 v[140:143], a[200:203], a[0:3], 0
 ds_read_b64_tr_b16 a[192:193], v28 offset:8448
 ds_read_b128 a[84:87], v16 offset:6528
 v_mfma_f32_16x16x32_bf16 v[144:147], a[200:203], a[4:7], 0
 ds_read_b64_tr_b16 a[194:195], v28 offset:12672
 global_load_lds_dwordx4 v6, s[86:87] offset:2112
 v_mfma_f32_16x16x32_bf16 v[148:151], a[204:207], a[0:3], 0
 ds_read_b64_tr_b16 a[196:197], v28 offset:8480
 ds_read_b128 a[88:91], v16 offset:4416
 v_mfma_f32_16x16x32_bf16 v[152:155], a[204:207], a[4:7], 0
 ds_read_b64_tr_b16 a[198:199], v28 offset:12704
 s_waitcnt lgkmcnt(7)
 v_mfma_f32_16x16x32_bf16 v[156:159], a[208:211], a[0:3], 0
 ds_read_b64_tr_b16 a[200:201], v29 offset:8448
 global_load_lds_dwordx4 v7, s[86:87] offset:3168
 v_mfma_f32_16x16x32_bf16 v[160:163], a[208:211], a[4:7], 0
 ds_read_b64_tr_b16 a[202:203], v29 offset:12672
 s_add_u32 m0, s64, 0
 s_xor_b32 s66, s70, 0x300
 v_mfma_f32_16x16x32_bf16 v[164:167], a[212:215], a[0:3], 0
 ds_read_b64_tr_b16 a[204:205], v29 offset:8480
 s_add_u32 s86, s4, s66
 s_addc_u32 s87, s5, 0
 v_mfma_f32_16x16x32_bf16 v[168:171], a[212:215], a[4:7], 0
 ds_read_b64_tr_b16 a[206:207], v29 offset:12704
 global_load_lds_dwordx4 v8, s[86:87] offset:0
 ds_read_b128 a[92:95], v16 offset:6592
 v_mfma_f32_16x16x32_bf16 v[172:175], a[216:219], a[0:3], 0
 ds_read_b64_tr_b16 a[208:209], v30 offset:8448
 s_xor_b32 s3, s69, 0x1000
 v_mfma_f32_16x16x32_bf16 v[176:179], a[216:219], a[4:7], 0
 ds_read_b64_tr_b16 a[210:211], v30 offset:12672
 s_add_u32 s12, s12, s3
 s_addc_u32 s13, s13, 0
 v_mfma_f32_16x16x32_bf16 v[180:183], a[220:223], a[0:3], 0
 ds_read_b64_tr_b16 a[212:213], v30 offset:8480
 global_load_lds_dwordx4 v9, s[86:87] offset:1088
 v_mfma_f32_16x16x32_bf16 v[184:187], a[220:223], a[4:7], 0
 ds_read_b64_tr_b16 a[214:215], v30 offset:12704
 s_waitcnt lgkmcnt(5)
 v_mfma_f32_16x16x32_bf16 v[124:127], a[192:195], a[8:11], v[124:127]
 ds_read_b64_tr_b16 a[216:217], v31 offset:8448
 v_mfma_f32_16x16x32_bf16 v[128:131], a[192:195], a[12:15], v[128:131]
 ds_read_b64_tr_b16 a[218:219], v31 offset:12672
 global_load_lds_dwordx4 v10, s[86:87] offset:2176
 v_mfma_f32_16x16x32_bf16 v[132:135], a[196:199], a[8:11], v[132:135]
 ds_read_b64_tr_b16 a[220:221], v31 offset:8480
 v_mfma_f32_16x16x32_bf16 v[136:139], a[196:199], a[12:15], v[136:139]
 ds_read_b64_tr_b16 a[222:223], v31 offset:12704
 s_barrier
 v_mfma_f32_16x16x32_bf16 v[140:143], a[200:203], a[8:11], v[140:143]
 ds_read_b64_tr_b16 a[192:193], v28 offset:16896
 global_load_lds_dwordx4 v11, s[86:87] offset:3264
 v_mfma_f32_16x16x32_bf16 v[144:147], a[200:203], a[12:15], v[144:147]
 ds_read_b64_tr_b16 a[194:195], v28 offset:21120
 s_add_u32 m0, s64, 12800
 v_mfma_f32_16x16x32_bf16 v[148:151], a[204:207], a[8:11], v[148:151]
 ds_read_b64_tr_b16 a[196:197], v28 offset:16928
 v_mfma_f32_16x16x32_bf16 v[152:155], a[204:207], a[12:15], v[152:155]
 ds_read_b64_tr_b16 a[198:199], v28 offset:21152
 global_load_lds_dwordx4 v17, s[90:91] offset:-4096 nt
 s_waitcnt lgkmcnt(4)
 v_mfma_f32_16x16x32_bf16 v[156:159], a[208:211], a[8:11], v[156:159]
 ds_read_b64_tr_b16 a[200:201], v29 offset:16896
 s_add_u32 m0, s64, 12864
 v_mfma_f32_16x16x32_bf16 v[160:163], a[208:211], a[12:15], v[160:163]
 ds_read_b64_tr_b16 a[202:203], v29 offset:21120
 v_mfma_f32_16x16x32_bf16 v[164:167], a[212:215], a[8:11], v[164:167]
 ds_read_b64_tr_b16 a[204:205], v29 offset:16928
 global_load_lds_dwordx4 v17, s[90:91] offset:-3072 nt
 v_mfma_f32_16x16x32_bf16 v[168:171], a[212:215], a[12:15], v[168:171]
 ds_read_b64_tr_b16 a[206:207], v29 offset:21152
 s_add_u32 m0, s64, 12928
 v_mfma_f32_16x16x32_bf16 v[172:175], a[216:219], a[8:11], v[172:175]
 ds_read_b64_tr_b16 a[208:209], v30 offset:16896
 v_mfma_f32_16x16x32_bf16 v[176:179], a[216:219], a[12:15], v[176:179]
 ds_read_b64_tr_b16 a[210:211], v30 offset:21120
 global_load_lds_dwordx4 v17, s[90:91] offset:-2048 nt
 v_mfma_f32_16x16x32_bf16 v[180:183], a[220:223], a[8:11], v[180:183]
 ds_read_b64_tr_b16 a[212:213], v30 offset:16928
 s_add_u32 m0, s64, 12992
 v_mfma_f32_16x16x32_bf16 v[184:187], a[220:223], a[12:15], v[184:187]
 ds_read_b64_tr_b16 a[214:215], v30 offset:21152
 s_waitcnt lgkmcnt(4)
 v_mfma_f32_16x16x32_bf16 v[60:63], a[192:195], a[80:83], v[60:63]
 ds_read_b64_tr_b16 a[216:217], v31 offset:16896
 global_load_lds_dwordx4 v17, s[90:91] offset:-1024 nt
 v_mfma_f32_16x16x32_bf16 v[64:67], a[192:195], a[84:87], v[64:67]
 ds_read_b64_tr_b16 a[218:219], v31 offset:21120
 s_add_u32 m0, s64, 13056
 v_mfma_f32_16x16x32_bf16 v[68:71], a[196:199], a[80:83], v[68:71]
 ds_read_b64_tr_b16 a[220:221], v31 offset:16928
 v_mfma_f32_16x16x32_bf16 v[72:75], a[196:199], a[84:87], v[72:75]
 ds_read_b64_tr_b16 a[222:223], v31 offset:21152
 global_load_lds_dwordx4 v17, s[90:91] offset:0 nt
 v_mfma_f32_16x16x32_bf16 v[76:79], a[200:203], a[80:83], v[76:79]
 ds_read_b64_tr_b16 a[192:193], v28 offset:25344
 s_add_u32 m0, s64, 13120
 v_mfma_f32_16x16x32_bf16 v[80:83], a[200:203], a[84:87], v[80:83]
 ds_read_b64_tr_b16 a[194:195], v28 offset:29568
 v_mfma_f32_16x16x32_bf16 v[84:87], a[204:207], a[80:83], v[84:87]
 ds_read_b64_tr_b16 a[196:197], v28 offset:25376
 global_load_lds_dwordx4 v17, s[90:91] offset:1024 nt
 v_mfma_f32_16x16x32_bf16 v[88:91], a[204:207], a[84:87], v[88:91]
 ds_read_b64_tr_b16 a[198:199], v28 offset:29600
 s_add_u32 m0, s64, 13184
 s_waitcnt lgkmcnt(4)
 v_mfma_f32_16x16x32_bf16 v[92:95], a[208:211], a[80:83], v[92:95]
 ds_read_b64_tr_b16 a[200:201], v29 offset:25344
 v_mfma_f32_16x16x32_bf16 v[96:99], a[208:211], a[84:87], v[96:99]
 ds_read_b64_tr_b16 a[202:203], v29 offset:29568
 global_load_lds_dwordx4 v17, s[90:91] offset:2048 nt
 v_mfma_f32_16x16x32_bf16 v[100:103], a[212:215], a[80:83], v[100:103]
 ds_read_b64_tr_b16 a[204:205], v29 offset:25376
 s_add_u32 m0, s64, 13248
 v_mfma_f32_16x16x32_bf16 v[104:107], a[212:215], a[84:87], v[104:107]
 ds_read_b64_tr_b16 a[206:207], v29 offset:29600
 v_mfma_f32_16x16x32_bf16 v[108:111], a[216:219], a[80:83], v[108:111]
 ds_read_b64_tr_b16 a[208:209], v30 offset:25344
 global_load_lds_dwordx4 v17, s[90:91] offset:3072 nt
 v_mfma_f32_16x16x32_bf16 v[112:115], a[216:219], a[84:87], v[112:115]
 ds_read_b64_tr_b16 a[210:211], v30 offset:29568
 s_add_u32 m0, s63, 67584
 s_xor_b32 s66, s81, 0x100100
 v_mfma_f32_16x16x32_bf16 v[116:119], a[220:223], a[80:83], v[116:119]
 ds_read_b64_tr_b16 a[212:213], v30 offset:25376
 s_add_u32 s86, s16, s66
 s_addc_u32 s87, s17, 0
 v_mfma_f32_16x16x32_bf16 v[120:123], a[220:223], a[84:87], v[120:123]
 ds_read_b64_tr_b16 a[214:215], v30 offset:29600
 global_load_lds_dwordx4 v4, s[86:87] offset:0
 s_waitcnt lgkmcnt(4)
 v_mfma_f32_16x16x32_bf16 v[60:63], a[192:195], a[88:91], v[60:63]
 ds_read_b64_tr_b16 a[216:217], v31 offset:25344
 s_waitcnt vmcnt(9)
 ds_read_b128 a[96:99], v16 offset:0
 v_mfma_f32_16x16x32_bf16 v[64:67], a[192:195], a[92:95], v[64:67]
 ds_read_b64_tr_b16 a[218:219], v31 offset:29568
 ds_read_b128 a[100:103], v16 offset:2176
 v_mfma_f32_16x16x32_bf16 v[68:71], a[196:199], a[88:91], v[68:71]
 ds_read_b64_tr_b16 a[220:221], v31 offset:25376
 global_load_lds_dwordx4 v5, s[86:87] offset:1056
 v_mfma_f32_16x16x32_bf16 v[72:75], a[196:199], a[92:95], v[72:75]
 ds_read_b64_tr_b16 a[222:223], v31 offset:29600
 s_barrier
 v_mfma_f32_16x16x32_bf16 v[76:79], a[200:203], a[88:91], v[76:79]
 ds_read_b64_tr_b16 a[192:193], v28 offset:33792
 ds_read_b128 a[104:107], v16 offset:64
 v_mfma_f32_16x16x32_bf16 v[80:83], a[200:203], a[92:95], v[80:83]
 ds_read_b64_tr_b16 a[194:195], v28 offset:38016
 global_load_lds_dwordx4 v6, s[86:87] offset:2112
 v_mfma_f32_16x16x32_bf16 v[84:87], a[204:207], a[88:91], v[84:87]
 ds_read_b64_tr_b16 a[196:197], v28 offset:33824
 ds_read_b128 a[108:111], v16 offset:2240
 v_mfma_f32_16x16x32_bf16 v[88:91], a[204:207], a[92:95], v[88:91]
 ds_read_b64_tr_b16 a[198:199], v28 offset:38048
 s_waitcnt lgkmcnt(6)
 v_mfma_f32_16x16x32_bf16 v[92:95], a[208:211], a[88:91], v[92:95]
 ds_read_b64_tr_b16 a[200:201], v29 offset:33792
 v_mfma_f32_16x16x32_bf16 v[96:99], a[208:211], a[92:95], v[96:99]
 ds_read_b64_tr_b16 a[202:203], v29 offset:38016
 v_mfma_f32_16x16x32_bf16 v[100:103], a[212:215], a[88:91], v[100:103]
 ds_read_b64_tr_b16 a[204:205], v29 offset:33824
 v_mfma_f32_16x16x32_bf16 v[104:107], a[212:215], a[92:95], v[104:107]
 ds_read_b64_tr_b16 a[206:207], v29 offset:38048
 v_mfma_f32_16x16x32_bf16 v[108:111], a[216:219], a[88:91], v[108:111]
 ds_read_b64_tr_b16 a[208:209], v30 offset:33792
 global_load_lds_dwordx4 v7, s[86:87] offset:3168
 v_mfma_f32_16x16x32_bf16 v[112:115], a[216:219], a[92:95], v[112:115]
 ds_read_b64_tr_b16 a[210:211], v30 offset:38016
 v_mfma_f32_16x16x32_bf16 v[116:119], a[220:223], a[88:91], v[116:119]
 ds_read_b64_tr_b16 a[212:213], v30 offset:33824
 v_mfma_f32_16x16x32_bf16 v[120:123], a[220:223], a[92:95], v[120:123]
 ds_read_b64_tr_b16 a[214:215], v30 offset:38048
 s_waitcnt lgkmcnt(4)
 v_mfma_f32_16x16x32_bf16 v[60:63], a[192:195], a[96:99], v[60:63]
 ds_read_b64_tr_b16 a[216:217], v31 offset:33792
 v_mfma_f32_16x16x32_bf16 v[64:67], a[192:195], a[100:103], v[64:67]
 ds_read_b64_tr_b16 a[218:219], v31 offset:38016
 v_mfma_f32_16x16x32_bf16 v[68:71], a[196:199], a[96:99], v[68:71]
 ds_read_b64_tr_b16 a[220:221], v31 offset:33824
 s_add_u32 m0, s64, 4352
 s_xor_b32 s66, s70, 0x380
 v_mfma_f32_16x16x32_bf16 v[72:75], a[196:199], a[100:103], v[72:75]
 ds_read_b64_tr_b16 a[222:223], v31 offset:38048
 s_add_u32 s86, s4, s66
 s_addc_u32 s87, s5, 0
 v_mfma_f32_16x16x32_bf16 v[76:79], a[200:203], a[96:99], v[76:79]
 ds_read_b64_tr_b16 a[192:193], v28 offset:42240
 global_load_lds_dwordx4 v8, s[86:87] offset:0
 v_mfma_f32_16x16x32_bf16 v[80:83], a[200:203], a[100:103], v[80:83]
 ds_read_b64_tr_b16 a[194:195], v28 offset:46464
 v_mfma_f32_16x16x32_bf16 v[84:87], a[204:207], a[96:99], v[84:87]
 ds_read_b64_tr_b16 a[196:197], v28 offset:42272
 v_mfma_f32_16x16x32_bf16 v[88:91], a[204:207], a[100:103], v[88:91]
 ds_read_b64_tr_b16 a[198:199], v28 offset:46496
 s_waitcnt lgkmcnt(4)
 v_mfma_f32_16x16x32_bf16 v[92:95], a[208:211], a[96:99], v[92:95]
 ds_read_b64_tr_b16 a[200:201], v29 offset:42240
 global_load_lds_dwordx4 v9, s[86:87] offset:1088
 v_mfma_f32_16x16x32_bf16 v[96:99], a[208:211], a[100:103], v[96:99]
 ds_read_b64_tr_b16 a[202:203], v29 offset:46464
 v_mfma_f32_16x16x32_bf16 v[100:103], a[212:215], a[96:99], v[100:103]
 ds_read_b64_tr_b16 a[204:205], v29 offset:42272
 v_mfma_f32_16x16x32_bf16 v[104:107], a[212:215], a[100:103], v[104:107]
 ds_read_b64_tr_b16 a[206:207], v29 offset:46496
 v_mfma_f32_16x16x32_bf16 v[108:111], a[216:219], a[96:99], v[108:111]
 ds_read_b64_tr_b16 a[208:209], v30 offset:42240
 v_mfma_f32_16x16x32_bf16 v[112:115], a[216:219], a[100:103], v[112:115]
 ds_read_b64_tr_b16 a[210:211], v30 offset:46464
 v_mfma_f32_16x16x32_bf16 v[116:119], a[220:223], a[96:99], v[116:119]
 ds_read_b64_tr_b16 a[212:213], v30 offset:42272
 global_load_lds_dwordx4 v10, s[86:87] offset:2176
 v_mfma_f32_16x16x32_bf16 v[120:123], a[220:223], a[100:103], v[120:123]
 ds_read_b64_tr_b16 a[214:215], v30 offset:46496
 s_waitcnt lgkmcnt(4)
 v_mfma_f32_16x16x32_bf16 v[60:63], a[192:195], a[104:107], v[60:63]
 ds_read_b64_tr_b16 a[216:217], v31 offset:42240
 v_mfma_f32_16x16x32_bf16 v[64:67], a[192:195], a[108:111], v[64:67]
 ds_read_b64_tr_b16 a[218:219], v31 offset:46464
 v_mfma_f32_16x16x32_bf16 v[68:71], a[196:199], a[104:107], v[68:71]
 ds_read_b64_tr_b16 a[220:221], v31 offset:42272
 v_mfma_f32_16x16x32_bf16 v[72:75], a[196:199], a[108:111], v[72:75]
 ds_read_b64_tr_b16 a[222:223], v31 offset:46496
L_hop1_0_2:
L_pad1_854:
 s_cbranch_execz L_ret1_0
 s_barrier
 v_mfma_f32_16x16x32_bf16 v[76:79], a[200:203], a[104:107], v[76:79]
 ds_read_b64_tr_b16 a[192:193], v32 offset:0
 global_load_lds_dwordx4 v11, s[86:87] offset:3264
 v_mfma_f32_16x16x32_bf16 v[80:83], a[200:203], a[108:111], v[80:83]
 ds_read_b64_tr_b16 a[194:195], v32 offset:4224
 v_mfma_f32_16x16x32_bf16 v[84:87], a[204:207], a[104:107], v[84:87]
 ds_read_b64_tr_b16 a[196:197], v32 offset:32
 v_mfma_f32_16x16x32_bf16 v[88:91], a[204:207], a[108:111], v[88:91]
 ds_read_b64_tr_b16 a[198:199], v32 offset:4256
 s_waitcnt lgkmcnt(4)
 v_mfma_f32_16x16x32_bf16 v[92:95], a[208:211], a[104:107], v[92:95]
 ds_read_b64_tr_b16 a[200:201], v33 offset:0
 v_mfma_f32_16x16x32_bf16 v[96:99], a[208:211], a[108:111], v[96:99]
 ds_read_b64_tr_b16 a[202:203], v33 offset:4224
 v_mfma_f32_16x16x32_bf16 v[100:103], a[212:215], a[104:107], v[100:103]
 ds_read_b64_tr_b16 a[204:205], v33 offset:32
 s_add_u32 m0, s63, 0
 s_xor_b32 s66, s71, 0x380000
 v_mfma_f32_16x16x32_bf16 v[104:107], a[212:215], a[108:111], v[104:107]
 ds_read_b64_tr_b16 a[206:207], v33 offset:4256
 s_add_u32 s86, s16, s66
 s_addc_u32 s87, s17, 0
 v_mfma_f32_16x16x32_bf16 v[108:111], a[216:219], a[104:107], v[108:111]
 ds_read_b64_tr_b16 a[208:209], v34 offset:0
 global_load_lds_dwordx4 v4, s[86:87] offset:0
 v_mfma_f32_16x16x32_bf16 v[112:115], a[216:219], a[108:111], v[112:115]
 ds_read_b64_tr_b16 a[210:211], v34 offset:4224
 v_mfma_f32_16x16x32_bf16 v[116:119], a[220:223], a[104:107], v[116:119]
 ds_read_b64_tr_b16 a[212:213], v34 offset:32
 v_mfma_f32_16x16x32_bf16 v[120:123], a[220:223], a[108:111], v[120:123]
 ds_read_b64_tr_b16 a[214:215], v34 offset:4256
 s_waitcnt lgkmcnt(4)
 v_mfma_f32_16x16x32_bf16 v[124:127], a[192:195], a[16:19], v[124:127]
 ds_read_b64_tr_b16 a[216:217], v35 offset:0
 global_load_lds_dwordx4 v5, s[86:87] offset:1056
 v_mfma_f32_16x16x32_bf16 v[128:131], a[192:195], a[20:23], v[128:131]
 ds_read_b64_tr_b16 a[218:219], v35 offset:4224
 v_mfma_f32_16x16x32_bf16 v[132:135], a[196:199], a[16:19], v[132:135]
 ds_read_b64_tr_b16 a[220:221], v35 offset:32
 v_mfma_f32_16x16x32_bf16 v[136:139], a[196:199], a[20:23], v[136:139]
 ds_read_b64_tr_b16 a[222:223], v35 offset:4256
 v_mfma_f32_16x16x32_bf16 v[140:143], a[200:203], a[16:19], v[140:143]
 ds_read_b64_tr_b16 a[192:193], v32 offset:8448
 v_mfma_f32_16x16x32_bf16 v[144:147], a[200:203], a[20:23], v[144:147]
 ds_read_b64_tr_b16 a[194:195], v32 offset:12672
 v_mfma_f32_16x16x32_bf16 v[148:151], a[204:207], a[16:19], v[148:151]
 ds_read_b64_tr_b16 a[196:197], v32 offset:8480
 global_load_lds_dwordx4 v6, s[86:87] offset:2112
 v_mfma_f32_16x16x32_bf16 v[152:155], a[204:207], a[20:23], v[152:155]
 ds_read_b64_tr_b16 a[198:199], v32 offset:12704
 s_waitcnt lgkmcnt(4)
 v_mfma_f32_16x16x32_bf16 v[156:159], a[208:211], a[16:19], v[156:159]
 ds_read_b64_tr_b16 a[200:201], v33 offset:8448
 s_waitcnt vmcnt(11)
 ds_read_b64 a[160:161], v18 offset:8704
 v_mfma_f32_16x16x32_bf16 v[160:163], a[208:211], a[20:23], v[160:163]
 ds_read_b64_tr_b16 a[202:203], v33 offset:12672
 global_load_lds_dwordx4 v7, s[86:87] offset:3168
 v_mfma_f32_16x16x32_bf16 v[164:167], a[212:215], a[16:19], v[164:167]
 ds_read_b64_tr_b16 a[204:205], v33 offset:8480
 ds_read_b64 a[162:163], v19 offset:8704
 v_mfma_f32_16x16x32_bf16 v[168:171], a[212:215], a[20:23], v[168:171]
 ds_read_b64_tr_b16 a[206:207], v33 offset:12704
 ds_read_b64 a[164:165], v18 offset:13056
 v_mfma_f32_16x16x32_bf16 v[172:175], a[216:219], a[16:19], v[172:175]
 ds_read_b64_tr_b16 a[208:209], v34 offset:8448
 ds_read_b64 a[166:167], v19 offset:13056
 v_mfma_f32_16x16x32_bf16 v[176:179], a[216:219], a[20:23], v[176:179]
 ds_read_b64_tr_b16 a[210:211], v34 offset:12672
 s_add_u32 m0, s63, 16896
 v_mfma_f32_16x16x32_bf16 v[180:183], a[220:223], a[16:19], v[180:183]
 ds_read_b64_tr_b16 a[212:213], v34 offset:8480
 global_load_lds_dwordx4 v4, s[100:101] offset:0
 v_mfma_f32_16x16x32_bf16 v[184:187], a[220:223], a[20:23], v[184:187]
 ds_read_b64_tr_b16 a[214:215], v34 offset:12704
 s_waitcnt lgkmcnt(6)
 v_mfma_f32_16x16x32_bf16 v[124:127], a[192:195], a[24:27], v[124:127]
 ds_read_b64_tr_b16 a[216:217], v35 offset:8448
 ds_read_b64 a[168:169], v18 offset:8768
 v_mfma_f32_16x16x32_bf16 v[128:131], a[192:195], a[28:31], v[128:131]
 ds_read_b64_tr_b16 a[218:219], v35 offset:12672
 global_load_lds_dwordx4 v5, s[100:101] offset:1056
 v_mfma_f32_16x16x32_bf16 v[132:135], a[196:199], a[24:27], v[132:135]
 ds_read_b64_tr_b16 a[220:221], v35 offset:8480
 ds_read_b64 a[170:171], v19 offset:8768
 v_mfma_f32_16x16x32_bf16 v[136:139], a[196:199], a[28:31], v[136:139]
 ds_read_b64_tr_b16 a[222:223], v35 offset:12704
 s_waitcnt vmcnt(10)
 s_barrier
 v_mfma_f32_16x16x32_bf16 v[140:143], a[200:203], a[24:27], v[140:143]
 ds_read_b64_tr_b16 a[192:193], v32 offset:16896
 global_load_lds_dwordx4 v6, s[100:101] offset:2112
 ds_read_b64 a[172:173], v18 offset:13120
 v_mfma_f32_16x16x32_bf16 v[144:147], a[200:203], a[28:31], v[144:147]
 ds_read_b64_tr_b16 a[194:195], v32 offset:21120
 ds_read_b64 a[174:175], v19 offset:13120
 v_mfma_f32_16x16x32_bf16 v[148:151], a[204:207], a[24:27], v[148:151]
 ds_read_b64_tr_b16 a[196:197], v32 offset:16928
 ds_read_b64 a[176:177], v18 offset:8832
 v_mfma_f32_16x16x32_bf16 v[152:155], a[204:207], a[28:31], v[152:155]
 ds_read_b64_tr_b16 a[198:199], v32 offset:21152
 s_waitcnt lgkmcnt(7)
 v_mfma_f32_16x16x32_bf16 v[156:159], a[208:211], a[24:27], v[156:159]
 ds_read_b64_tr_b16 a[200:201], v33 offset:16896
 global_load_lds_dwordx4 v7, s[100:101] offset:3168
 v_mfma_f32_16x16x32_bf16 v[160:163], a[208:211], a[28:31], v[160:163]
 ds_read_b64_tr_b16 a[202:203], v33 offset:21120
 ds_read_b64 a[178:179], v19 offset:8832
 v_mfma_f32_16x16x32_bf16 v[164:167], a[212:215], a[24:27], v[164:167]
 ds_read_b64_tr_b16 a[204:205], v33 offset:16928
 ds_read_b64 a[180:181], v18 offset:13184
 v_mfma_f32_16x16x32_bf16 v[168:171], a[212:215], a[28:31], v[168:171]
 ds_read_b64_tr_b16 a[206:207], v33 offset:21152
 ds_read_b64 a[182:183], v19 offset:13184
 v_mfma_f32_16x16x32_bf16 v[172:175], a[216:219], a[24:27], v[172:175]
 ds_read_b64_tr_b16 a[208:209], v34 offset:16896
 s_add_u32 m0, s63, 33792
 v_mfma_f32_16x16x32_bf16 v[176:179], a[216:219], a[28:31], v[176:179]
 ds_read_b64_tr_b16 a[210:211], v34 offset:21120
 global_load_lds_dwordx4 v4, s[98:99] offset:0
 v_mfma_f32_16x16x32_bf16 v[180:183], a[220:223], a[24:27], v[180:183]
 ds_read_b64_tr_b16 a[212:213], v34 offset:16928
 ds_read_b64 a[184:185], v18 offset:8896
 v_mfma_f32_16x16x32_bf16 v[184:187], a[220:223], a[28:31], v[184:187]
 ds_read_b64_tr_b16 a[214:215], v34 offset:21152
 s_waitcnt lgkmcnt(6)
 v_mfma_f32_16x16x32_bf16 v[124:127], a[192:195], a[32:35], v[124:127]
 ds_read_b64_tr_b16 a[216:217], v35 offset:16896
 global_load_lds_dwordx4 v5, s[98:99] offset:1056
 v_mfma_f32_16x16x32_bf16 v[128:131], a[192:195], a[36:39], v[128:131]
 ds_read_b64_tr_b16 a[218:219], v35 offset:21120
 ds_read_b64 a[186:187], v19 offset:8896
 v_mfma_f32_16x16x32_bf16 v[132:135], a[196:199], a[32:35], v[132:135]
 ds_read_b64_tr_b16 a[220:221], v35 offset:16928
 ds_read_b64 a[188:189], v18 offset:13248
 v_mfma_f32_16x16x32_bf16 v[136:139], a[196:199], a[36:39], v[136:139]
 ds_read_b64_tr_b16 a[222:223], v35 offset:21152
 ds_read_b64 a[190:191], v19 offset:13248
 v_mfma_f32_16x16x32_bf16 v[140:143], a[200:203], a[32:35], v[140:143]
 ds_read_b64_tr_b16 a[192:193], v32 offset:25344
 global_load_lds_dwordx4 v6, s[98:99] offset:2112
 v_mfma_f32_16x16x32_bf16 v[144:147], a[200:203], a[36:39], v[144:147]
 ds_read_b64_tr_b16 a[194:195], v32 offset:29568
 s_waitcnt vmcnt(11)
 ds_read_b128 a[112:115], v16 offset:4352
 v_mfma_f32_16x16x32_bf16 v[148:151], a[204:207], a[32:35], v[148:151]
 ds_read_b64_tr_b16 a[196:197], v32 offset:25376
 ds_read_b128 a[116:119], v16 offset:6528
 v_mfma_f32_16x16x32_bf16 v[152:155], a[204:207], a[36:39], v[152:155]
 ds_read_b64_tr_b16 a[198:199], v32 offset:29600
 s_waitcnt lgkmcnt(7)
 v_mfma_f32_16x16x32_bf16 v[156:159], a[208:211], a[32:35], v[156:159]
 ds_read_b64_tr_b16 a[200:201], v33 offset:25344
 global_load_lds_dwordx4 v7, s[98:99] offset:3168
 v_mfma_f32_16x16x32_bf16 v[160:163], a[208:211], a[36:39], v[160:163]
 ds_read_b64_tr_b16 a[202:203], v33 offset:29568
 ds_read_b128 a[120:123], v16 offset:4416
 v_mfma_f32_16x16x32_bf16 v[164:167], a[212:215], a[32:35], v[164:167]
 ds_read_b64_tr_b16 a[204:205], v33 offset:25376
 ds_read_b128 a[124:127], v16 offset:6592
 v_mfma_f32_16x16x32_bf16 v[168:171], a[212:215], a[36:39], v[168:171]
 ds_read_b64_tr_b16 a[206:207], v33 offset:29600
 v_mfma_f32_16x16x32_bf16 v[172:175], a[216:219], a[32:35], v[172:175]
 ds_read_b64_tr_b16 a[208:209], v34 offset:25344
 v_mfma_f32_16x16x32_bf16 v[176:179], a[216:219], a[36:39], v[176:179]
 ds_read_b64_tr_b16 a[210:211], v34 offset:29568
 v_mfma_f32_16x16x32_bf16 v[180:183], a[220:223], a[32:35], v[180:183]
 ds_read_b64_tr_b16 a[212:213], v34 offset:25376
 v_mfma_f32_16x16x32_bf16 v[184:187], a[220:223], a[36:39], v[184:187]
 ds_read_b64_tr_b16 a[214:215], v34 offset:29600
 s_waitcnt lgkmcnt(4)
 v_mfma_f32_16x16x32_bf16 v[124:127], a[192:195], a[40:43], v[124:127]
 ds_read_b64_tr_b16 a[216:217], v35 offset:25344
 v_mfma_f32_16x16x32_bf16 v[128:131], a[192:195], a[44:47], v[128:131]
 ds_read_b64_tr_b16 a[218:219], v35 offset:29568
 v_mfma_f32_16x16x32_bf16 v[132:135], a[196:199], a[40:43], v[132:135]
 ds_read_b64_tr_b16 a[220:221], v35 offset:25376
 v_mfma_f32_16x16x32_bf16 v[136:139], a[196:199], a[44:47], v[136:139]
 ds_read_b64_tr_b16 a[222:223], v35 offset:29600
 s_waitcnt vmcnt(8)
 s_barrier
 v_mfma_f32_16x16x32_bf16 v[140:143], a[200:203], a[40:43], v[140:143]
 ds_read_b64_tr_b16 a[192:193], v28 offset:0
 s_add_u32 m0, s63, 50688
 v_mfma_f32_16x16x32_bf16 v[144:147], a[200:203], a[44:47], v[144:147]
 ds_read_b64_tr_b16 a[194:195], v28 offset:4224
 global_load_lds_dwordx4 v4, s[96:97] offset:0
 v_mfma_f32_16x16x32_bf16 v[148:151], a[204:207], a[40:43], v[148:151]
 ds_read_b64_tr_b16 a[196:197], v28 offset:32
 v_mfma_f32_16x16x32_bf16 v[152:155], a[204:207], a[44:47], v[152:155]
 ds_read_b64_tr_b16 a[198:199], v28 offset:4256
 s_waitcnt lgkmcnt(4)
 v_mfma_f32_16x16x32_bf16 v[156:159], a[208:211], a[40:43], v[156:159]
 ds_read_b64_tr_b16 a[200:201], v29 offset:0
 global_load_lds_dwordx4 v5, s[96:97] offset:1056
 v_mfma_f32_16x16x32_bf16 v[160:163], a[208:211], a[44:47], v[160:163]
 ds_read_b64_tr_b16 a[202:203], v29 offset:4224
 v_mfma_f32_16x16x32_bf16 v[164:167], a[212:215], a[40:43], v[164:167]
 ds_read_b64_tr_b16 a[204:205], v29 offset:32
 v_mfma_f32_16x16x32_bf16 v[168:171], a[212:215], a[44:47], v[168:171]
 ds_read_b64_tr_b16 a[206:207], v29 offset:4256
 global_load_lds_dwordx4 v6, s[96:97] offset:2112
 v_mfma_f32_16x16x32_bf16 v[172:175], a[216:219], a[40:43], v[172:175]
 ds_read_b64_tr_b16 a[208:209], v30 offset:0
 v_mfma_f32_16x16x32_bf16 v[176:179], a[216:219], a[44:47], v[176:179]
 ds_read_b64_tr_b16 a[210:211], v30 offset:4224
 v_mfma_f32_16x16x32_bf16 v[180:183], a[220:223], a[40:43], v[180:183]
 ds_read_b64_tr_b16 a[212:213], v30 offset:32
 global_load_lds_dwordx4 v7, s[96:97] offset:3168
 v_mfma_f32_16x16x32_bf16 v[184:187], a[220:223], a[44:47], v[184:187]
 ds_read_b64_tr_b16 a[214:215], v30 offset:4256
 s_waitcnt lgkmcnt(4)
 v_mfma_f32_16x16x32_bf16 v[60:63], a[192:195], a[112:115], v[60:63]
 ds_read_b64_tr_b16 a[216:217], v31 offset:0
 v_mfma_f32_16x16x32_bf16 v[64:67], a[192:195], a[116:119], v[64:67]
 ds_read_b64_tr_b16 a[218:219], v31 offset:4224
 global_load_dword v43, v45, s[28:29] sc1
 v_mfma_f32_16x16x32_bf16 v[68:71], a[196:199], a[112:115], v[68:71]
 ds_read_b64_tr_b16 a[220:221], v31 offset:32
 v_mfma_f32_16x16x32_bf16 v[72:75], a[196:199], a[116:119], v[72:75]
 ds_read_b64_tr_b16 a[222:223], v31 offset:4256
 v_mfma_f32_16x16x32_bf16 v[76:79], a[200:203], a[112:115], v[76:79]
 ds_read_b64_tr_b16 a[192:193], v28 offset:8448
 v_mfma_f32_16x16x32_bf16 v[80:83], a[200:203], a[116:119], v[80:83]
 ds_read_b64_tr_b16 a[194:195], v28 offset:12672
 v_mfma_f32_16x16x32_bf16 v[84:87], a[204:207], a[112:115], v[84:87]
 ds_read_b64_tr_b16 a[196:197], v28 offset:8480
 v_mfma_f32_16x16x32_bf16 v[88:91], a[204:207], a[116:119], v[88:91]
 ds_read_b64_tr_b16 a[198:199], v28 offset:12704
 s_waitcnt lgkmcnt(4)
 v_mfma_f32_16x16x32_bf16 v[92:95], a[208:211], a[112:115], v[92:95]
 ds_read_b64_tr_b16 a[200:201], v29 offset:8448
 v_mfma_f32_16x16x32_bf16 v[96:99], a[208:211], a[116:119], v[96:99]
 ds_read_b64_tr_b16 a[202:203], v29 offset:12672
 v_mfma_f32_16x16x32_bf16 v[100:103], a[212:215], a[112:115], v[100:103]
 ds_read_b64_tr_b16 a[204:205], v29 offset:8480
 v_mfma_f32_16x16x32_bf16 v[104:107], a[212:215], a[116:119], v[104:107]
 ds_read_b64_tr_b16 a[206:207], v29 offset:12704
 v_mfma_f32_16x16x32_bf16 v[108:111], a[216:219], a[112:115], v[108:111]
 ds_read_b64_tr_b16 a[208:209], v30 offset:8448
 v_mfma_f32_16x16x32_bf16 v[112:115], a[216:219], a[116:119], v[112:115]
 ds_read_b64_tr_b16 a[210:211], v30 offset:12672
 v_mfma_f32_16x16x32_bf16 v[116:119], a[220:223], a[112:115], v[116:119]
 ds_read_b64_tr_b16 a[212:213], v30 offset:8480
 v_mfma_f32_16x16x32_bf16 v[120:123], a[220:223], a[116:119], v[120:123]
 ds_read_b64_tr_b16 a[214:215], v30 offset:12704
 s_waitcnt lgkmcnt(4)
 v_mfma_f32_16x16x32_bf16 v[60:63], a[192:195], a[120:123], v[60:63]
 ds_read_b64_tr_b16 a[216:217], v31 offset:8448
 v_mfma_f32_16x16x32_bf16 v[64:67], a[192:195], a[124:127], v[64:67]
 ds_read_b64_tr_b16 a[218:219], v31 offset:12672
 v_mfma_f32_16x16x32_bf16 v[68:71], a[196:199], a[120:123], v[68:71]
 ds_read_b64_tr_b16 a[220:221], v31 offset:8480
 v_mfma_f32_16x16x32_bf16 v[72:75], a[196:199], a[124:127], v[72:75]
 ds_read_b64_tr_b16 a[222:223], v31 offset:12704
 s_waitcnt vmcnt(5)
 s_barrier
 v_mfma_f32_16x16x32_bf16 v[76:79], a[200:203], a[120:123], v[76:79]
 ds_read_b64_tr_b16 a[192:193], v28 offset:16896
 s_add_u32 m0, s63, 67584
 v_mfma_f32_16x16x32_bf16 v[80:83], a[200:203], a[124:127], v[80:83]
 ds_read_b64_tr_b16 a[194:195], v28 offset:21120
 global_load_lds_dwordx4 v4, s[94:95] offset:0
 v_mfma_f32_16x16x32_bf16 v[84:87], a[204:207], a[120:123], v[84:87]
 ds_read_b64_tr_b16 a[196:197], v28 offset:16928
 v_mfma_f32_16x16x32_bf16 v[88:91], a[204:207], a[124:127], v[88:91]
L_hop1_0_3:
L_pad1_1121:
 s_cbranch_execz L_ret1_0
 ds_read_b64_tr_b16 a[198:199], v28 offset:21152
 s_waitcnt lgkmcnt(4)
 v_mfma_f32_16x16x32_bf16 v[92:95], a[208:211], a[120:123], v[92:95]
 ds_read_b64_tr_b16 a[200:201], v29 offset:16896
 global_load_lds_dwordx4 v5, s[94:95] offset:1056
 v_mfma_f32_16x16x32_bf16 v[96:99], a[208:211], a[124:127], v[96:99]
 ds_read_b64_tr_b16 a[202:203], v29 offset:21120
 v_mfma_f32_16x16x32_bf16 v[100:103], a[212:215], a[120:123], v[100:103]
 ds_read_b64_tr_b16 a[204:205], v29 offset:16928
 v_mfma_f32_16x16x32_bf16 v[104:107], a[212:215], a[124:127], v[104:107]
 ds_read_b64_tr_b16 a[206:207], v29 offset:21152
 global_load_lds_dwordx4 v6, s[94:95] offset:2112
 v_mfma_f32_16x16x32_bf16 v[108:111], a[216:219], a[120:123], v[108:111]
 ds_read_b64_tr_b16 a[208:209], v30 offset:16896
 v_mfma_f32_16x16x32_bf16 v[112:115], a[216:219], a[124:127], v[112:115]
 ds_read_b64_tr_b16 a[210:211], v30 offset:21120
 v_mfma_f32_16x16x32_bf16 v[116:119], a[220:223], a[120:123], v[116:119]
 ds_read_b64_tr_b16 a[212:213], v30 offset:16928
 global_load_lds_dwordx4 v7, s[94:95] offset:3168
 v_mfma_f32_16x16x32_bf16 v[120:123], a[220:223], a[124:127], v[120:123]
 ds_read_b64_tr_b16 a[214:215], v30 offset:21152
 s_waitcnt lgkmcnt(4)
 v_mfma_f32_16x16x32_bf16 v[124:127], a[192:195], a[48:51], v[124:127]
 ds_read_b64_tr_b16 a[216:217], v31 offset:16896
 s_add_u32 m0, s64, 12800
 v_mfma_f32_16x16x32_bf16 v[128:131], a[192:195], a[52:55], v[128:131]
 ds_read_b64_tr_b16 a[218:219], v31 offset:21120
 global_load_lds_dwordx4 v24, s[12:13] offset:-4096
 v_mfma_f32_16x16x32_bf16 v[132:135], a[196:199], a[48:51], v[132:135]
 ds_read_b64_tr_b16 a[220:221], v31 offset:16928
 v_cvt_pk_bf16_f32 v188, v60, v61
 v_cvt_pk_bf16_f32 v189, v62, v63
 v_cvt_pk_bf16_f32 v192, v64, v65
 v_cvt_pk_bf16_f32 v193, v66, v67
 v_cvt_pk_bf16_f32 v190, v68, v69
 v_cvt_pk_bf16_f32 v191, v70, v71
 v_cvt_pk_bf16_f32 v194, v72, v73
 v_cvt_pk_bf16_f32 v195, v74, v75
 v_cvt_pk_bf16_f32 v196, v76, v77
 v_cvt_pk_bf16_f32 v197, v78, v79
 v_cvt_pk_bf16_f32 v200, v80, v81
 v_cvt_pk_bf16_f32 v201, v82, v83
 v_cvt_pk_bf16_f32 v198, v84, v85
 v_cvt_pk_bf16_f32 v199, v86, v87
 v_cvt_pk_bf16_f32 v202, v88, v89
 v_cvt_pk_bf16_f32 v203, v90, v91
 v_cvt_pk_bf16_f32 v204, v92, v93
 v_cvt_pk_bf16_f32 v205, v94, v95
 v_cvt_pk_bf16_f32 v208, v96, v97
 v_cvt_pk_bf16_f32 v209, v98, v99
 v_mfma_f32_16x16x32_bf16 v[136:139], a[196:199], a[52:55], v[136:139]
 ds_read_b64_tr_b16 a[222:223], v31 offset:21152
 v_cvt_pk_bf16_f32 v206, v100, v101
 v_mfma_f32_16x16x32_bf16 v[140:143], a[200:203], a[48:51], v[140:143]
 ds_read_b64_tr_b16 a[192:193], v28 offset:25344
 global_load_lds_dwordx4 v25, s[12:13] offset:-3040
 v_cvt_pk_bf16_f32 v207, v102, v103
 v_mfma_f32_16x16x32_bf16 v[144:147], a[200:203], a[52:55], v[144:147]
 ds_read_b64_tr_b16 a[194:195], v28 offset:29568
 v_cvt_pk_bf16_f32 v210, v104, v105
 v_mfma_f32_16x16x32_bf16 v[148:151], a[204:207], a[48:51], v[148:151]
 ds_read_b64_tr_b16 a[196:197], v28 offset:25376
 v_cvt_pk_bf16_f32 v211, v106, v107
 v_mfma_f32_16x16x32_bf16 v[152:155], a[204:207], a[52:55], v[152:155]
 ds_read_b64_tr_b16 a[198:199], v28 offset:29600
 global_load_lds_dwordx4 v26, s[12:13] offset:-1984
 v_cvt_pk_bf16_f32 v212, v108, v109
 s_waitcnt lgkmcnt(4)
 v_mfma_f32_16x16x32_bf16 v[156:159], a[208:211], a[48:51], v[156:159]
 ds_read_b64_tr_b16 a[200:201], v29 offset:25344
 v_cvt_pk_bf16_f32 v213, v110, v111
 v_mfma_f32_16x16x32_bf16 v[160:163], a[208:211], a[52:55], v[160:163]
 ds_read_b64_tr_b16 a[202:203], v29 offset:29568
 s_waitcnt vmcnt(7)
 v_cmp_ne_u32 vcc, 1, v43
 s_cbranch_vccnz L_slow1i
L_back1i:
 v_cvt_pk_bf16_f32 v216, v112, v113
 v_mfma_f32_16x16x32_bf16 v[164:167], a[212:215], a[48:51], v[164:167]
 ds_read_b64_tr_b16 a[204:205], v29 offset:25376
 global_load_lds_dwordx4 v27, s[12:13] offset:-928
 v_cvt_pk_bf16_f32 v217, v114, v115
 v_mfma_f32_16x16x32_bf16 v[168:171], a[212:215], a[52:55], v[168:171]
 ds_read_b64_tr_b16 a[206:207], v29 offset:29600
 s_add_u32 m0, s64, 12928
 v_cvt_pk_bf16_f32 v214, v116, v117
 v_mfma_f32_16x16x32_bf16 v[172:175], a[216:219], a[48:51], v[172:175]
 ds_read_b64_tr_b16 a[208:209], v30 offset:25344
 v_cvt_pk_bf16_f32 v215, v118, v119
 v_mfma_f32_16x16x32_bf16 v[176:179], a[216:219], a[52:55], v[176:179]
 ds_read_b64_tr_b16 a[210:211], v30 offset:29568
 global_load_lds_dwordx4 v24, s[12:13] offset:0
 v_cvt_pk_bf16_f32 v218, v120, v121
 v_mfma_f32_16x16x32_bf16 v[180:183], a[220:223], a[48:51], v[180:183]
 ds_read_b64_tr_b16 a[212:213], v30 offset:25376
 v_cvt_pk_bf16_f32 v219, v122, v123
 v_mfma_f32_16x16x32_bf16 v[184:187], a[220:223], a[52:55], v[184:187]
 ds_read_b64_tr_b16 a[214:215], v30 offset:29600
 v_mfma_f32_16x16x32_bf16 v[60:63], a[128:131], v[188:191], 0
 global_load_lds_dwordx4 v25, s[12:13] offset:1056
 v_mfma_f32_16x16x32_bf16 v[68:71], a[128:131], v[192:195], 0
 v_mfma_f32_16x16x32_bf16 v[64:67], a[132:135], v[188:191], 0
 v_mfma_f32_16x16x32_bf16 v[72:75], a[132:135], v[192:195], 0
 global_load_lds_dwordx4 v26, s[12:13] offset:2112
 v_mfma_f32_16x16x32_bf16 v[60:63], a[136:139], v[196:199], v[60:63]
 v_mfma_f32_16x16x32_bf16 v[68:71], a[136:139], v[200:203], v[68:71]
 v_mfma_f32_16x16x32_bf16 v[64:67], a[140:143], v[196:199], v[64:67]
 global_load_lds_dwordx4 v27, s[12:13] offset:3168
 v_mfma_f32_16x16x32_bf16 v[72:75], a[140:143], v[200:203], v[72:75]
 s_add_u32 m0, s64, 4096
 v_mfma_f32_16x16x32_bf16 v[60:63], a[144:147], v[204:207], v[60:63]
 v_mfma_f32_16x16x32_bf16 v[68:71], a[144:147], v[208:211], v[68:71]
 global_load_lds_dwordx4 v24, s[88:89] offset:-4096
 v_mfma_f32_16x16x32_bf16 v[64:67], a[148:151], v[204:207], v[64:67]
 v_mfma_f32_16x16x32_bf16 v[72:75], a[148:151], v[208:211], v[72:75]
 v_mfma_f32_16x16x32_bf16 v[60:63], a[152:155], v[212:215], v[60:63]
 global_load_lds_dwordx4 v25, s[88:89] offset:-3040
 v_mfma_f32_16x16x32_bf16 v[68:71], a[152:155], v[216:219], v[68:71]
 v_mfma_f32_16x16x32_bf16 v[64:67], a[156:159], v[212:215], v[64:67]
 v_mfma_f32_16x16x32_bf16 v[72:75], a[156:159], v[216:219], v[72:75]
 global_load_lds_dwordx4 v26, s[88:89] offset:-1984
 s_waitcnt lgkmcnt(4)
 v_mfma_f32_16x16x32_bf16 v[124:127], a[192:195], a[56:59], v[124:127]
 ds_read_b64_tr_b16 a[216:217], v31 offset:25344
 v_mfma_f32_16x16x32_bf16 v[128:131], a[192:195], a[60:63], v[128:131]
 ds_read_b64_tr_b16 a[218:219], v31 offset:29568
 v_mfma_f32_16x16x32_bf16 v[132:135], a[196:199], a[56:59], v[132:135]
 ds_read_b64_tr_b16 a[220:221], v31 offset:25376
 v_max3_f32 v2, v60, v61, v62
 v_max3_f32 v3, v68, v69, v70
 v_max3_f32 v2, v2, v63, v64
 v_max3_f32 v3, v3, v71, v72
 v_max3_f32 v2, v2, v65, v66
 v_max3_f32 v3, v3, v73, v74
 v_max_f32 v2, v2, v67
 v_max_f32 v3, v3, v75
 s_nop 1
 v_permlane32_swap_b32 v2, v3
 v_max_f32 v2, v2, v3
 v_mov_b32 v48, v2
 s_nop 1
 v_permlane16_swap_b32 v2, v48
 v_max_f32 v2, v2, v48
 v_mov_b32 v3, v2
 s_nop 1
 v_permlane32_swap_b32 v2, v3
 v_mul_f32 v2, s76, v2
 v_mul_f32 v3, s76, v3
 v_fma_f32 v60, v60, s76, -v2
 v_fma_f32 v61, v61, s76, -v2
 v_fma_f32 v62, v62, s76, -v2
 v_fma_f32 v63, v63, s76, -v2
 v_fma_f32 v64, v64, s76, -v2
 v_fma_f32 v65, v65, s76, -v2
 v_fma_f32 v66, v66, s76, -v2
 v_fma_f32 v67, v67, s76, -v2
 v_fma_f32 v68, v68, s76, -v3
 v_fma_f32 v69, v69, s76, -v3
 v_fma_f32 v70, v70, s76, -v3
 v_fma_f32 v71, v71, s76, -v3
 v_fma_f32 v72, v72, s76, -v3
 v_fma_f32 v73, v73, s76, -v3
 v_fma_f32 v74, v74, s76, -v3
 v_fma_f32 v75, v75, s76, -v3
 v_exp_f32 v60, v60
 v_exp_f32 v61, v61
 v_exp_f32 v62, v62
 v_exp_f32 v63, v63
 v_exp_f32 v64, v64
 v_exp_f32 v65, v65
 v_exp_f32 v66, v66
 v_exp_f32 v67, v67
 v_exp_f32 v68, v68
 v_exp_f32 v69, v69
 v_exp_f32 v70, v70
 v_exp_f32 v71, v71
 v_exp_f32 v72, v72
 v_exp_f32 v73, v73
 v_exp_f32 v74, v74
 v_exp_f32 v75, v75
 v_add_f32 v2, v60, v61
 v_add_f32 v3, v68, v69
 v_add_f32 v2, v2, v62
 v_add_f32 v3, v3, v70
 v_add_f32 v2, v2, v63
 v_add_f32 v3, v3, v71
 v_add_f32 v2, v2, v64
 v_add_f32 v3, v3, v72
 v_add_f32 v2, v2, v65
 v_add_f32 v3, v3, v73
 v_add_f32 v2, v2, v66
 v_add_f32 v3, v3, v74
 v_add_f32 v2, v2, v67
 v_add_f32 v3, v3, v75
 s_nop 1
 v_permlane32_swap_b32 v2, v3
 v_add_f32 v2, v2, v3
 v_mov_b32 v48, v2
 s_nop 1
 v_permlane16_swap_b32 v2, v48
 v_add_f32 v2, v2, v48
 v_mov_b32 v3, v2
 s_nop 1
 v_permlane32_swap_b32 v2, v3
 v_rcp_f32 v2, v2
 v_rcp_f32 v3, v3
 v_mul_f32 v60, v2, v60
 v_mul_f32 v61, v2, v61
 v_mul_f32 v62, v2, v62
 v_mul_f32 v63, v2, v63
 v_mul_f32 v64, v2, v64
 v_mul_f32 v65, v2, v65
 v_mul_f32 v66, v2, v66
 v_mul_f32 v67, v2, v67
 v_mul_f32 v68, v3, v68
 v_mul_f32 v69, v3, v69
 v_mul_f32 v70, v3, v70
 v_mul_f32 v71, v3, v71
 v_mul_f32 v72, v3, v72
 v_mul_f32 v73, v3, v73
 v_mul_f32 v74, v3, v74
 v_mul_f32 v75, v3, v75
 v_cvt_pk_bf16_f32 v52, v60, v61
 v_cvt_pk_bf16_f32 v53, v62, v63
 v_cvt_pk_bf16_f32 v54, v64, v65
 v_cvt_pk_bf16_f32 v55, v66, v67
 v_cvt_pk_bf16_f32 v56, v68, v69
 v_mfma_f32_16x16x32_bf16 v[136:139], a[196:199], a[60:63], v[136:139]
 ds_read_b64_tr_b16 a[222:223], v31 offset:29600
 global_load_lds_dwordx4 v27, s[88:89] offset:-928
 v_cvt_pk_bf16_f32 v57, v70, v71
 v_mfma_f32_16x16x32_bf16 v[140:143], a[200:203], a[56:59], v[140:143]
 ds_read_b64_tr_b16 a[192:193], v28 offset:33792
 s_add_u32 m0, s64, 4224
 v_cvt_pk_bf16_f32 v58, v72, v73
 v_mfma_f32_16x16x32_bf16 v[144:147], a[200:203], a[60:63], v[144:147]
 ds_read_b64_tr_b16 a[194:195], v28 offset:38016
 v_cvt_pk_bf16_f32 v59, v74, v75
 v_mfma_f32_16x16x32_bf16 v[148:151], a[204:207], a[56:59], v[148:151]
 ds_read_b64_tr_b16 a[196:197], v28 offset:33824
 buffer_store_dwordx4 v[52:55], v40, s[32:35], s72 offen sc1
 v_mfma_f32_16x16x32_bf16 v[152:155], a[204:207], a[60:63], v[152:155]
 ds_read_b64_tr_b16 a[198:199], v28 offset:38048
 s_waitcnt lgkmcnt(4)
 v_mfma_f32_16x16x32_bf16 v[156:159], a[208:211], a[56:59], v[156:159]
 ds_read_b64_tr_b16 a[200:201], v29 offset:33792
 v_mfma_f32_16x16x32_bf16 v[160:163], a[208:211], a[60:63], v[160:163]
 ds_read_b64_tr_b16 a[202:203], v29 offset:38016
 buffer_store_dwordx4 v[56:59], v40, s[32:35], s72 offen offset:1024 sc1
 v_mfma_f32_16x16x32_bf16 v[164:167], a[212:215], a[56:59], v[164:167]
 ds_read_b64_tr_b16 a[204:205], v29 offset:33824
 v_mfma_f32_16x16x32_bf16 v[168:171], a[212:215], a[60:63], v[168:171]
 ds_read_b64_tr_b16 a[206:207], v29 offset:38048
 v_mfma_f32_16x16x32_bf16 v[172:175], a[216:219], a[56:59], v[172:175]
 ds_read_b64_tr_b16 a[208:209], v30 offset:33792
 global_load_lds_dwordx4 v24, s[88:89] offset:0
 v_mfma_f32_16x16x32_bf16 v[176:179], a[216:219], a[60:63], v[176:179]
 ds_read_b64_tr_b16 a[210:211], v30 offset:38016
 v_mfma_f32_16x16x32_bf16 v[180:183], a[220:223], a[56:59], v[180:183]
 ds_read_b64_tr_b16 a[212:213], v30 offset:33824
 v_mfma_f32_16x16x32_bf16 v[184:187], a[220:223], a[60:63], v[184:187]
 ds_read_b64_tr_b16 a[214:215], v30 offset:38048
 global_load_lds_dwordx4 v25, s[88:89] offset:1056
 s_waitcnt lgkmcnt(4)
 v_mfma_f32_16x16x32_bf16 v[124:127], a[192:195], a[64:67], v[124:127]
 ds_read_b64_tr_b16 a[216:217], v31 offset:33792
 v_mfma_f32_16x16x32_bf16 v[128:131], a[192:195], a[68:71], v[128:131]
 ds_read_b64_tr_b16 a[218:219], v31 offset:38016
 v_mfma_f32_16x16x32_bf16 v[132:135], a[196:199], a[64:67], v[132:135]
 ds_read_b64_tr_b16 a[220:221], v31 offset:33824
 global_load_lds_dwordx4 v26, s[88:89] offset:2112
 v_mfma_f32_16x16x32_bf16 v[136:139], a[196:199], a[68:71], v[136:139]
 ds_read_b64_tr_b16 a[222:223], v31 offset:38048
 v_mfma_f32_16x16x32_bf16 v[140:143], a[200:203], a[64:67], v[140:143]
 ds_read_b64_tr_b16 a[192:193], v28 offset:42240
 v_mfma_f32_16x16x32_bf16 v[144:147], a[200:203], a[68:71], v[144:147]
 ds_read_b64_tr_b16 a[194:195], v28 offset:46464
 global_load_lds_dwordx4 v27, s[88:89] offset:3168
 v_mfma_f32_16x16x32_bf16 v[148:151], a[204:207], a[64:67], v[148:151]
 ds_read_b64_tr_b16 a[196:197], v28 offset:42272
 v_mfma_f32_16x16x32_bf16 v[152:155], a[204:207], a[68:71], v[152:155]
 ds_read_b64_tr_b16 a[198:199], v28 offset:46496
 s_waitcnt lgkmcnt(4)
 v_mfma_f32_16x16x32_bf16 v[156:159], a[208:211], a[64:67], v[156:159]
 ds_read_b64_tr_b16 a[200:201], v29 offset:42240
 v_mfma_f32_16x16x32_bf16 v[160:163], a[208:211], a[68:71], v[160:163]
 ds_read_b64_tr_b16 a[202:203], v29 offset:46464
 v_mfma_f32_16x16x32_bf16 v[164:167], a[212:215], a[64:67], v[164:167]
 ds_read_b64_tr_b16 a[204:205], v29 offset:42272
 v_mfma_f32_16x16x32_bf16 v[168:171], a[212:215], a[68:71], v[168:171]
 ds_read_b64_tr_b16 a[206:207], v29 offset:46496
 v_mfma_f32_16x16x32_bf16 v[172:175], a[216:219], a[64:67], v[172:175]
 ds_read_b64_tr_b16 a[208:209], v30 offset:42240
 v_mfma_f32_16x16x32_bf16 v[176:179], a[216:219], a[68:71], v[176:179]
 ds_read_b64_tr_b16 a[210:211], v30 offset:46464
 v_mfma_f32_16x16x32_bf16 v[180:183], a[220:223], a[64:67], v[180:183]
 ds_read_b64_tr_b16 a[212:213], v30 offset:42272
 v_mfma_f32_16x16x32_bf16 v[184:187], a[220:223], a[68:71], v[184:187]
L_hop1_1_0:
L_pad1_1419:
 s_cbranch_execz L_pad1_2515
 ds_read_b64_tr_b16 a[214:215], v30 offset:46496
 s_waitcnt lgkmcnt(4)
 v_mfma_f32_16x16x32_bf16 v[124:127], a[192:195], a[72:75], v[124:127]
 ds_read_b64_tr_b16 a[216:217], v31 offset:42240
 v_mfma_f32_16x16x32_bf16 v[128:131], a[192:195], a[76:79], v[128:131]
 ds_read_b64_tr_b16 a[218:219], v31 offset:46464
 v_mfma_f32_16x16x32_bf16 v[132:135], a[196:199], a[72:75], v[132:135]
 ds_read_b64_tr_b16 a[220:221], v31 offset:42272
 v_mfma_f32_16x16x32_bf16 v[136:139], a[196:199], a[76:79], v[136:139]
 ds_read_b64_tr_b16 a[222:223], v31 offset:46496
 s_barrier
 v_mfma_f32_16x16x32_bf16 v[140:143], a[200:203], a[72:75], v[140:143]
 ds_read_b64_tr_b16 a[192:193], v32 offset:0
 s_add_u32 m0, s63, 0
 v_mfma_f32_16x16x32_bf16 v[144:147], a[200:203], a[76:79], v[144:147]
 ds_read_b64_tr_b16 a[194:195], v32 offset:4224
 global_load_lds_dwordx4 v4, s[92:93] offset:0
 v_mfma_f32_16x16x32_bf16 v[148:151], a[204:207], a[72:75], v[148:151]
 ds_read_b64_tr_b16 a[196:197], v32 offset:32
 v_mfma_f32_16x16x32_bf16 v[152:155], a[204:207], a[76:79], v[152:155]
 ds_read_b64_tr_b16 a[198:199], v32 offset:4256
 s_waitcnt lgkmcnt(4)
 v_mfma_f32_16x16x32_bf16 v[156:159], a[208:211], a[72:75], v[156:159]
 ds_read_b64_tr_b16 a[200:201], v33 offset:0
 global_load_lds_dwordx4 v5, s[92:93] offset:1056
 v_mfma_f32_16x16x32_bf16 v[160:163], a[208:211], a[76:79], v[160:163]
 ds_read_b64_tr_b16 a[202:203], v33 offset:4224
 v_mfma_f32_16x16x32_bf16 v[164:167], a[212:215], a[72:75], v[164:167]
 ds_read_b64_tr_b16 a[204:205], v33 offset:32
 v_mfma_f32_16x16x32_bf16 v[168:171], a[212:215], a[76:79], v[168:171]
 ds_read_b64_tr_b16 a[206:207], v33 offset:4256
 global_load_lds_dwordx4 v6, s[92:93] offset:2112
 v_mfma_f32_16x16x32_bf16 v[172:175], a[216:219], a[72:75], v[172:175]
 ds_read_b64_tr_b16 a[208:209], v34 offset:0
 v_mfma_f32_16x16x32_bf16 v[176:179], a[216:219], a[76:79], v[176:179]
 ds_read_b64_tr_b16 a[210:211], v34 offset:4224
 v_mfma_f32_16x16x32_bf16 v[180:183], a[220:223], a[72:75], v[180:183]
 ds_read_b64_tr_b16 a[212:213], v34 offset:32
 global_load_lds_dwordx4 v7, s[92:93] offset:3168
 v_mfma_f32_16x16x32_bf16 v[184:187], a[220:223], a[76:79], v[184:187]
 ds_read_b64_tr_b16 a[214:215], v34 offset:4256
 s_add_u32 m0, s63, 16896
 s_waitcnt lgkmcnt(4)
 v_mfma_f32_16x16x32_bf16 v[124:127], a[192:195], a[80:83], v[124:127]
 ds_read_b64_tr_b16 a[216:217], v35 offset:0
 v_mfma_f32_16x16x32_bf16 v[128:131], a[192:195], a[84:87], v[128:131]
 ds_read_b64_tr_b16 a[218:219], v35 offset:4224
 global_load_lds_dwordx4 v20, s[20:21] offset:0
 v_mfma_f32_16x16x32_bf16 v[132:135], a[196:199], a[80:83], v[132:135]
 ds_read_b64_tr_b16 a[220:221], v35 offset:32
 v_mfma_f32_16x16x32_bf16 v[136:139], a[196:199], a[84:87], v[136:139]
 ds_read_b64_tr_b16 a[222:223], v35 offset:4256
 v_mfma_f32_16x16x32_bf16 v[140:143], a[200:203], a[80:83], v[140:143]
 ds_read_b64_tr_b16 a[192:193], v32 offset:8448
 global_load_lds_dwordx4 v21, s[20:21] offset:1056
 v_mfma_f32_16x16x32_bf16 v[144:147], a[200:203], a[84:87], v[144:147]
 ds_read_b64_tr_b16 a[194:195], v32 offset:12672
 v_mfma_f32_16x16x32_bf16 v[148:151], a[204:207], a[80:83], v[148:151]
 ds_read_b64_tr_b16 a[196:197], v32 offset:8480
 v_mfma_f32_16x16x32_bf16 v[152:155], a[204:207], a[84:87], v[152:155]
 ds_read_b64_tr_b16 a[198:199], v32 offset:12704
 global_load_lds_dwordx4 v22, s[20:21] offset:2112
 s_waitcnt lgkmcnt(4)
 v_mfma_f32_16x16x32_bf16 v[156:159], a[208:211], a[80:83], v[156:159]
 ds_read_b64_tr_b16 a[200:201], v33 offset:8448
 v_mfma_f32_16x16x32_bf16 v[160:163], a[208:211], a[84:87], v[160:163]
 ds_read_b64_tr_b16 a[202:203], v33 offset:12672
 v_mfma_f32_16x16x32_bf16 v[164:167], a[212:215], a[80:83], v[164:167]
 ds_read_b64_tr_b16 a[204:205], v33 offset:8480
 global_load_lds_dwordx4 v23, s[20:21] offset:3168
 v_mfma_f32_16x16x32_bf16 v[168:171], a[212:215], a[84:87], v[168:171]
 ds_read_b64_tr_b16 a[206:207], v33 offset:12704
 v_mfma_f32_16x16x32_bf16 v[172:175], a[216:219], a[80:83], v[172:175]
 ds_read_b64_tr_b16 a[208:209], v34 offset:8448
 v_mfma_f32_16x16x32_bf16 v[176:179], a[216:219], a[84:87], v[176:179]
 ds_read_b64_tr_b16 a[210:211], v34 offset:12672
 s_waitcnt vmcnt(12)
 s_mov_b64 exec, 1
 buffer_store_dword v44, v45, s[32:35], s74 offen offset:0 sc1
 s_mov_b64 exec, -1
 v_mfma_f32_16x16x32_bf16 v[180:183], a[220:223], a[80:83], v[180:183]
 ds_read_b64_tr_b16 a[212:213], v34 offset:8480
 v_mfma_f32_16x16x32_bf16 v[184:187], a[220:223], a[84:87], v[184:187]
 ds_read_b64_tr_b16 a[214:215], v34 offset:12704
 s_waitcnt lgkmcnt(4)
 v_mfma_f32_16x16x32_bf16 v[124:127], a[192:195], a[88:91], v[124:127]
 ds_read_b64_tr_b16 a[216:217], v35 offset:8448
 v_mfma_f32_16x16x32_bf16 v[128:131], a[192:195], a[92:95], v[128:131]
 ds_read_b64_tr_b16 a[218:219], v35 offset:12672
 v_mfma_f32_16x16x32_bf16 v[132:135], a[196:199], a[88:91], v[132:135]
 ds_read_b64_tr_b16 a[220:221], v35 offset:8480
 v_mfma_f32_16x16x32_bf16 v[136:139], a[196:199], a[92:95], v[136:139]
 ds_read_b64_tr_b16 a[222:223], v35 offset:12704
 s_barrier
 v_mfma_f32_16x16x32_bf16 v[140:143], a[200:203], a[88:91], v[140:143]
 ds_read_b64_tr_b16 a[192:193], v32 offset:16896
 s_add_u32 m0, s63, 33792
 v_mfma_f32_16x16x32_bf16 v[144:147], a[200:203], a[92:95], v[144:147]
 ds_read_b64_tr_b16 a[194:195], v32 offset:21120
 global_load_lds_dwordx4 v20, s[48:49] offset:0
 v_mfma_f32_16x16x32_bf16 v[148:151], a[204:207], a[88:91], v[148:151]
 ds_read_b64_tr_b16 a[196:197], v32 offset:16928
 v_mfma_f32_16x16x32_bf16 v[152:155], a[204:207], a[92:95], v[152:155]
 ds_read_b64_tr_b16 a[198:199], v32 offset:21152
 s_waitcnt lgkmcnt(4)
 v_mfma_f32_16x16x32_bf16 v[156:159], a[208:211], a[88:91], v[156:159]
 ds_read_b64_tr_b16 a[200:201], v33 offset:16896
 global_load_lds_dwordx4 v21, s[48:49] offset:1056
 v_mfma_f32_16x16x32_bf16 v[160:163], a[208:211], a[92:95], v[160:163]
 ds_read_b64_tr_b16 a[202:203], v33 offset:21120
 v_mfma_f32_16x16x32_bf16 v[164:167], a[212:215], a[88:91], v[164:167]
 ds_read_b64_tr_b16 a[204:205], v33 offset:16928
 v_mfma_f32_16x16x32_bf16 v[168:171], a[212:215], a[92:95], v[168:171]
 ds_read_b64_tr_b16 a[206:207], v33 offset:21152
 global_load_lds_dwordx4 v22, s[48:49] offset:2112
 v_mfma_f32_16x16x32_bf16 v[172:175], a[216:219], a[88:91], v[172:175]
 ds_read_b64_tr_b16 a[208:209], v34 offset:16896
 v_mfma_f32_16x16x32_bf16 v[176:179], a[216:219], a[92:95], v[176:179]
 ds_read_b64_tr_b16 a[210:211], v34 offset:21120
 v_mfma_f32_16x16x32_bf16 v[180:183], a[220:223], a[88:91], v[180:183]
 ds_read_b64_tr_b16 a[212:213], v34 offset:16928
 global_load_lds_dwordx4 v23, s[48:49] offset:3168
 v_mfma_f32_16x16x32_bf16 v[184:187], a[220:223], a[92:95], v[184:187]
 ds_read_b64_tr_b16 a[214:215], v34 offset:21152
 s_waitcnt lgkmcnt(4)
 v_mfma_f32_16x16x32_bf16 v[124:127], a[192:195], a[96:99], v[124:127]
 ds_read_b64_tr_b16 a[216:217], v35 offset:16896
 v_mfma_f32_16x16x32_bf16 v[128:131], a[192:195], a[100:103], v[128:131]
 ds_read_b64_tr_b16 a[218:219], v35 offset:21120
 v_mfma_f32_16x16x32_bf16 v[132:135], a[196:199], a[96:99], v[132:135]
 ds_read_b64_tr_b16 a[220:221], v35 offset:16928
 v_mfma_f32_16x16x32_bf16 v[136:139], a[196:199], a[100:103], v[136:139]
 ds_read_b64_tr_b16 a[222:223], v35 offset:21152
 v_mfma_f32_16x16x32_bf16 v[140:143], a[200:203], a[96:99], v[140:143]
 ds_read_b64_tr_b16 a[192:193], v32 offset:25344
 v_mfma_f32_16x16x32_bf16 v[144:147], a[200:203], a[100:103], v[144:147]
 ds_read_b64_tr_b16 a[194:195], v32 offset:29568
 v_mfma_f32_16x16x32_bf16 v[148:151], a[204:207], a[96:99], v[148:151]
 ds_read_b64_tr_b16 a[196:197], v32 offset:25376
 v_mfma_f32_16x16x32_bf16 v[152:155], a[204:207], a[100:103], v[152:155]
 ds_read_b64_tr_b16 a[198:199], v32 offset:29600
 s_waitcnt lgkmcnt(4)
 v_mfma_f32_16x16x32_bf16 v[156:159], a[208:211], a[96:99], v[156:159]
 ds_read_b64_tr_b16 a[200:201], v33 offset:25344
 v_mfma_f32_16x16x32_bf16 v[160:163], a[208:211], a[100:103], v[160:163]
 ds_read_b64_tr_b16 a[202:203], v33 offset:29568
 v_mfma_f32_16x16x32_bf16 v[164:167], a[212:215], a[96:99], v[164:167]
 ds_read_b64_tr_b16 a[204:205], v33 offset:25376
 v_mfma_f32_16x16x32_bf16 v[168:171], a[212:215], a[100:103], v[168:171]
 ds_read_b64_tr_b16 a[206:207], v33 offset:29600
 v_mfma_f32_16x16x32_bf16 v[172:175], a[216:219], a[96:99], v[172:175]
 ds_read_b64_tr_b16 a[208:209], v34 offset:25344
 v_mfma_f32_16x16x32_bf16 v[176:179], a[216:219], a[100:103], v[176:179]
 ds_read_b64_tr_b16 a[210:211], v34 offset:29568
 v_mfma_f32_16x16x32_bf16 v[180:183], a[220:223], a[96:99], v[180:183]
 ds_read_b64_tr_b16 a[212:213], v34 offset:25376
 v_mfma_f32_16x16x32_bf16 v[184:187], a[220:223], a[100:103], v[184:187]
 ds_read_b64_tr_b16 a[214:215], v34 offset:29600
 s_waitcnt lgkmcnt(4)
 v_mfma_f32_16x16x32_bf16 v[124:127], a[192:195], a[104:107], v[124:127]
 ds_read_b64_tr_b16 a[216:217], v35 offset:25344
 v_mfma_f32_16x16x32_bf16 v[128:131], a[192:195], a[108:111], v[128:131]
 ds_read_b64_tr_b16 a[218:219], v35 offset:29568
 v_mfma_f32_16x16x32_bf16 v[132:135], a[196:199], a[104:107], v[132:135]
 ds_read_b64_tr_b16 a[220:221], v35 offset:25376
 v_mfma_f32_16x16x32_bf16 v[136:139], a[196:199], a[108:111], v[136:139]
 ds_read_b64_tr_b16 a[222:223], v35 offset:29600
 s_waitcnt vmcnt(9)
 s_barrier
 v_mfma_f32_16x16x32_bf16 v[140:143], a[200:203], a[104:107], v[140:143]
 ds_read_b64_tr_b16 a[192:193], v28 offset:0
 s_add_u32 m0, s63, 50688
 v_mfma_f32_16x16x32_bf16 v[144:147], a[200:203], a[108:111], v[144:147]
 ds_read_b64_tr_b16 a[194:195], v28 offset:4224
 global_load_lds_dwordx4 v20, s[46:47] offset:0
 v_mfma_f32_16x16x32_bf16 v[148:151], a[204:207], a[104:107], v[148:151]
 ds_read_b64_tr_b16 a[196:197], v28 offset:32
 v_mfma_f32_16x16x32_bf16 v[152:155], a[204:207], a[108:111], v[152:155]
 ds_read_b64_tr_b16 a[198:199], v28 offset:4256
 s_waitcnt lgkmcnt(4)
 v_mfma_f32_16x16x32_bf16 v[156:159], a[208:211], a[104:107], v[156:159]
 ds_read_b64_tr_b16 a[200:201], v29 offset:0
 global_load_lds_dwordx4 v21, s[46:47] offset:1056
 v_mfma_f32_16x16x32_bf16 v[160:163], a[208:211], a[108:111], v[160:163]
 ds_read_b64_tr_b16 a[202:203], v29 offset:4224
 v_mfma_f32_16x16x32_bf16 v[164:167], a[212:215], a[104:107], v[164:167]
 ds_read_b64_tr_b16 a[204:205], v29 offset:32
 v_mfma_f32_16x16x32_bf16 v[168:171], a[212:215], a[108:111], v[168:171]
 ds_read_b64_tr_b16 a[206:207], v29 offset:4256
 global_load_lds_dwordx4 v22, s[46:47] offset:2112
 v_mfma_f32_16x16x32_bf16 v[172:175], a[216:219], a[104:107], v[172:175]
 ds_read_b64_tr_b16 a[208:209], v30 offset:0
 v_mfma_f32_16x16x32_bf16 v[176:179], a[216:219], a[108:111], v[176:179]
 ds_read_b64_tr_b16 a[210:211], v30 offset:4224
 v_mfma_f32_16x16x32_bf16 v[180:183], a[220:223], a[104:107], v[180:183]
 ds_read_b64_tr_b16 a[212:213], v30 offset:32
 global_load_lds_dwordx4 v23, s[46:47] offset:3168
 v_mfma_f32_16x16x32_bf16 v[184:187], a[220:223], a[108:111], v[184:187]
 ds_read_b64_tr_b16 a[214:215], v30 offset:4256
 s_waitcnt lgkmcnt(4)
 v_mfma_f32_16x16x32_bf16 v[124:127], a[192:195], a[112:115], v[124:127]
 ds_read_b64_tr_b16 a[216:217], v31 offset:0
 v_mfma_f32_16x16x32_bf16 v[128:131], a[192:195], a[116:119], v[128:131]
 ds_read_b64_tr_b16 a[218:219], v31 offset:4224
 v_mfma_f32_16x16x32_bf16 v[132:135], a[196:199], a[112:115], v[132:135]
 ds_read_b64_tr_b16 a[220:221], v31 offset:32
 v_mfma_f32_16x16x32_bf16 v[136:139], a[196:199], a[116:119], v[136:139]
 ds_read_b64_tr_b16 a[222:223], v31 offset:4256
 v_mfma_f32_16x16x32_bf16 v[140:143], a[200:203], a[112:115], v[140:143]
 ds_read_b64_tr_b16 a[192:193], v36 offset:8704
 v_mfma_f32_16x16x32_bf16 v[144:147], a[200:203], a[116:119], v[144:147]
 ds_read_b64_tr_b16 a[194:195], v36 offset:12928
 v_mfma_f32_16x16x32_bf16 v[148:151], a[204:207], a[112:115], v[148:151]
 ds_read_b64_tr_b16 a[196:197], v36 offset:8736
 v_mfma_f32_16x16x32_bf16 v[152:155], a[204:207], a[116:119], v[152:155]
 ds_read_b64_tr_b16 a[198:199], v36 offset:12960
 s_waitcnt lgkmcnt(4)
 v_mfma_f32_16x16x32_bf16 v[156:159], a[208:211], a[112:115], v[156:159]
 ds_read_b64_tr_b16 a[200:201], v37 offset:8704
 v_mfma_f32_16x16x32_bf16 v[160:163], a[208:211], a[116:119], v[160:163]
 ds_read_b64_tr_b16 a[202:203], v37 offset:12928
 v_mfma_f32_16x16x32_bf16 v[164:167], a[212:215], a[112:115], v[164:167]
 ds_read_b64_tr_b16 a[204:205], v37 offset:8736
 v_mfma_f32_16x16x32_bf16 v[168:171], a[212:215], a[116:119], v[168:171]
 ds_read_b64_tr_b16 a[206:207], v37 offset:12960
 v_mfma_f32_16x16x32_bf16 v[172:175], a[216:219], a[112:115], v[172:175]
 ds_read_b64_tr_b16 a[208:209], v38 offset:8704
 v_mfma_f32_16x16x32_bf16 v[176:179], a[216:219], a[116:119], v[176:179]
 ds_read_b64_tr_b16 a[210:211], v38 offset:12928
 v_mfma_f32_16x16x32_bf16 v[180:183], a[220:223], a[112:115], v[180:183]
 ds_read_b64_tr_b16 a[212:213], v38 offset:8736
 v_mfma_f32_16x16x32_bf16 v[184:187], a[220:223], a[116:119], v[184:187]
 ds_read_b64_tr_b16 a[214:215], v38 offset:12960
 s_waitcnt lgkmcnt(4)
 v_mfma_f32_16x16x32_bf16 v[60:63], a[192:195], v[52:55], 0
 ds_read_b64_tr_b16 a[216:217], v39 offset:8704
 v_mfma_f32_16x16x32_bf16 v[64:67], a[192:195], v[56:59], 0
 ds_read_b64_tr_b16 a[218:219], v39 offset:12928
 v_mfma_f32_16x16x32_bf16 v[68:71], a[196:199], v[52:55], 0
 ds_read_b64_tr_b16 a[220:221], v39 offset:8736
 v_mfma_f32_16x16x32_bf16 v[72:75], a[196:199], v[56:59], 0
 ds_read_b64_tr_b16 a[222:223], v39 offset:12960
 v_mfma_f32_16x16x32_bf16 v[76:79], a[200:203], v[52:55], 0
 ds_read_b64_tr_b16 a[192:193], v28 offset:8448
 v_mfma_f32_16x16x32_bf16 v[80:83], a[200:203], v[56:59], 0
 ds_read_b64_tr_b16 a[194:195], v28 offset:12672
 v_mfma_f32_16x16x32_bf16 v[84:87], a[204:207], v[52:55], 0
 ds_read_b64_tr_b16 a[196:197], v28 offset:8480
 v_mfma_f32_16x16x32_bf16 v[88:91], a[204:207], v[56:59], 0
 ds_read_b64_tr_b16 a[198:199], v28 offset:12704
 s_waitcnt lgkmcnt(4)
 v_mfma_f32_16x16x32_bf16 v[92:95], a[208:211], v[52:55], 0
 ds_read_b64_tr_b16 a[200:201], v29 offset:8448
 v_mfma_f32_16x16x32_bf16 v[96:99], a[208:211], v[56:59], 0
 ds_read_b64_tr_b16 a[202:203], v29 offset:12672
 v_mfma_f32_16x16x32_bf16 v[100:103], a[212:215], v[52:55], 0
 ds_read_b64_tr_b16 a[204:205], v29 offset:8480
 v_mfma_f32_16x16x32_bf16 v[104:107], a[212:215], v[56:59], 0
 ds_read_b64_tr_b16 a[206:207], v29 offset:12704
 v_mfma_f32_16x16x32_bf16 v[108:111], a[216:219], v[52:55], 0
 ds_read_b64_tr_b16 a[208:209], v30 offset:8448
 v_mfma_f32_16x16x32_bf16 v[112:115], a[216:219], v[56:59], 0
 ds_read_b64_tr_b16 a[210:211], v30 offset:12672
 v_mfma_f32_16x16x32_bf16 v[116:119], a[220:223], v[52:55], 0
 ds_read_b64_tr_b16 a[212:213], v30 offset:8480
 v_mfma_f32_16x16x32_bf16 v[120:123], a[220:223], v[56:59], 0
L_hop1_1_1:
L_pad1_1685:
 s_cbranch_execz L_pad1_2781
 ds_read_b64_tr_b16 a[214:215], v30 offset:12704
 s_waitcnt lgkmcnt(4)
 v_mfma_f32_16x16x32_bf16 v[124:127], a[192:195], a[120:123], v[124:127]
 ds_read_b64_tr_b16 a[216:217], v31 offset:8448
 s_add_u32 m0, s64, 12800
 v_mfma_f32_16x16x32_bf16 v[128:131], a[192:195], a[124:127], v[128:131]
 ds_read_b64_tr_b16 a[218:219], v31 offset:12672
 global_load_lds_dwordx4 v24, s[60:61] offset:-4096
 v_cvt_pk_bf16_f32 v188, v60, v61
 v_cvt_pk_bf16_f32 v189, v62, v63
 v_cvt_pk_bf16_f32 v192, v64, v65
 v_cvt_pk_bf16_f32 v193, v66, v67
 v_cvt_pk_bf16_f32 v190, v68, v69
 v_cvt_pk_bf16_f32 v191, v70, v71
 v_cvt_pk_bf16_f32 v194, v72, v73
 v_cvt_pk_bf16_f32 v195, v74, v75
 v_cvt_pk_bf16_f32 v196, v76, v77
 v_cvt_pk_bf16_f32 v197, v78, v79
 v_cvt_pk_bf16_f32 v200, v80, v81
 v_cvt_pk_bf16_f32 v201, v82, v83
 v_cvt_pk_bf16_f32 v198, v84, v85
 v_cvt_pk_bf16_f32 v199, v86, v87
 v_cvt_pk_bf16_f32 v202, v88, v89
 v_cvt_pk_bf16_f32 v203, v90, v91
 v_cvt_pk_bf16_f32 v204, v92, v93
 v_cvt_pk_bf16_f32 v205, v94, v95
 v_cvt_pk_bf16_f32 v208, v96, v97
 v_mfma_f32_16x16x32_bf16 v[132:135], a[196:199], a[120:123], v[132:135]
 ds_read_b64_tr_b16 a[220:221], v31 offset:8480
 v_cvt_pk_bf16_f32 v209, v98, v99
 v_mfma_f32_16x16x32_bf16 v[136:139], a[196:199], a[124:127], v[136:139]
 ds_read_b64_tr_b16 a[222:223], v31 offset:12704
 v_cvt_pk_bf16_f32 v206, v100, v101
 s_waitcnt vmcnt(10)
 s_barrier
 v_mfma_f32_16x16x32_bf16 v[140:143], a[200:203], a[120:123], v[140:143]
 ds_read_b64_tr_b16 a[192:193], v28 offset:16896
 global_load_lds_dwordx4 v25, s[60:61] offset:-3040
 v_cvt_pk_bf16_f32 v207, v102, v103
 v_mfma_f32_16x16x32_bf16 v[144:147], a[200:203], a[124:127], v[144:147]
 ds_read_b64_tr_b16 a[194:195], v28 offset:21120
 v_cvt_pk_bf16_f32 v210, v104, v105
 v_mfma_f32_16x16x32_bf16 v[148:151], a[204:207], a[120:123], v[148:151]
 ds_read_b64_tr_b16 a[196:197], v28 offset:16928
 v_cvt_pk_bf16_f32 v211, v106, v107
 v_mfma_f32_16x16x32_bf16 v[152:155], a[204:207], a[124:127], v[152:155]
 ds_read_b64_tr_b16 a[198:199], v28 offset:21152
 global_load_lds_dwordx4 v26, s[60:61] offset:-1984
 v_cvt_pk_bf16_f32 v212, v108, v109
 s_waitcnt lgkmcnt(4)
 v_mfma_f32_16x16x32_bf16 v[156:159], a[208:211], a[120:123], v[156:159]
 ds_read_b64_tr_b16 a[200:201], v29 offset:16896
 v_cvt_pk_bf16_f32 v213, v110, v111
 v_mfma_f32_16x16x32_bf16 v[160:163], a[208:211], a[124:127], v[160:163]
 ds_read_b64_tr_b16 a[202:203], v29 offset:21120
 v_cvt_pk_bf16_f32 v216, v112, v113
 v_mfma_f32_16x16x32_bf16 v[164:167], a[212:215], a[120:123], v[164:167]
 ds_read_b64_tr_b16 a[204:205], v29 offset:16928
 global_load_lds_dwordx4 v27, s[60:61] offset:-928
 v_cvt_pk_bf16_f32 v217, v114, v115
 v_mfma_f32_16x16x32_bf16 v[168:171], a[212:215], a[124:127], v[168:171]
 ds_read_b64_tr_b16 a[206:207], v29 offset:21152
 s_add_u32 m0, s64, 12928
 v_cvt_pk_bf16_f32 v214, v116, v117
 v_mfma_f32_16x16x32_bf16 v[172:175], a[216:219], a[120:123], v[172:175]
 ds_read_b64_tr_b16 a[208:209], v30 offset:16896
 v_cvt_pk_bf16_f32 v215, v118, v119
 v_mfma_f32_16x16x32_bf16 v[176:179], a[216:219], a[124:127], v[176:179]
 ds_read_b64_tr_b16 a[210:211], v30 offset:21120
 global_load_lds_dwordx4 v24, s[60:61] offset:0
 v_cvt_pk_bf16_f32 v218, v120, v121
 v_mfma_f32_16x16x32_bf16 v[180:183], a[220:223], a[120:123], v[180:183]
 ds_read_b64_tr_b16 a[212:213], v30 offset:16928
 v_cvt_pk_bf16_f32 v219, v122, v123
 v_mfma_f32_16x16x32_bf16 v[184:187], a[220:223], a[124:127], v[184:187]
 ds_read_b64_tr_b16 a[214:215], v30 offset:21152
 s_waitcnt lgkmcnt(4)
 v_mfma_f32_16x16x32_bf16 v[60:63], a[192:195], v[188:191], 0
 ds_read_b64_tr_b16 a[216:217], v31 offset:16896
 global_load_lds_dwordx4 v25, s[60:61] offset:1056
 v_mfma_f32_16x16x32_bf16 v[64:67], a[192:195], v[192:195], 0
 ds_read_b64_tr_b16 a[218:219], v31 offset:21120
 v_mfma_f32_16x16x32_bf16 v[68:71], a[196:199], v[188:191], 0
 ds_read_b64_tr_b16 a[220:221], v31 offset:16928
 v_cvt_pk_bf16_f32 v220, v124, v125
 v_mfma_f32_16x16x32_bf16 v[72:75], a[196:199], v[192:195], 0
 ds_read_b64_tr_b16 a[222:223], v31 offset:21152
 global_load_lds_dwordx4 v26, s[60:61] offset:2112
 v_mfma_f32_16x16x32_bf16 v[76:79], a[200:203], v[188:191], 0
 ds_read_b64_tr_b16 a[192:193], v28 offset:25344
 v_cvt_pk_bf16_f32 v228, v140, v141
 v_mfma_f32_16x16x32_bf16 v[80:83], a[200:203], v[192:195], 0
 ds_read_b64_tr_b16 a[194:195], v28 offset:29568
 v_cvt_pk_bf16_f32 v236, v156, v157
 v_mfma_f32_16x16x32_bf16 v[84:87], a[204:207], v[188:191], 0
 ds_read_b64_tr_b16 a[196:197], v28 offset:25376
 buffer_load_dword v43, v41, s[32:35], s73 offen offset:0 sc1
 v_mfma_f32_16x16x32_bf16 v[88:91], a[204:207], v[192:195], 0
 ds_read_b64_tr_b16 a[198:199], v28 offset:29600
 v_cvt_pk_bf16_f32 v244, v172, v173
 s_waitcnt lgkmcnt(4)
 v_mfma_f32_16x16x32_bf16 v[92:95], a[208:211], v[188:191], 0
 ds_read_b64_tr_b16 a[200:201], v29 offset:25344
 v_cvt_pk_bf16_f32 v221, v126, v127
 v_mfma_f32_16x16x32_bf16 v[96:99], a[208:211], v[192:195], 0
 ds_read_b64_tr_b16 a[202:203], v29 offset:29568
 global_load_lds_dwordx4 v27, s[60:61] offset:3168
 v_mfma_f32_16x16x32_bf16 v[100:103], a[212:215], v[188:191], 0
 ds_read_b64_tr_b16 a[204:205], v29 offset:25376
 s_add_u32 m0, s63, 67584
 v_cvt_pk_bf16_f32 v229, v142, v143
 v_mfma_f32_16x16x32_bf16 v[104:107], a[212:215], v[192:195], 0
 ds_read_b64_tr_b16 a[206:207], v29 offset:29600
 v_cvt_pk_bf16_f32 v237, v158, v159
 v_mfma_f32_16x16x32_bf16 v[108:111], a[216:219], v[188:191], 0
 ds_read_b64_tr_b16 a[208:209], v30 offset:25344
 global_load_lds_dwordx4 v20, s[44:45] offset:0
 v_cvt_pk_bf16_f32 v245, v174, v175
 v_mfma_f32_16x16x32_bf16 v[112:115], a[216:219], v[192:195], 0
 ds_read_b64_tr_b16 a[210:211], v30 offset:29568
 v_cvt_pk_bf16_f32 v224, v128, v129
 v_mfma_f32_16x16x32_bf16 v[116:119], a[220:223], v[188:191], 0
 ds_read_b64_tr_b16 a[212:213], v30 offset:25376
 v_cvt_pk_bf16_f32 v232, v144, v145
 v_mfma_f32_16x16x32_bf16 v[120:123], a[220:223], v[192:195], 0
 ds_read_b64_tr_b16 a[214:215], v30 offset:29600
 global_load_lds_dwordx4 v21, s[44:45] offset:1056
 s_waitcnt lgkmcnt(4)
 v_mfma_f32_16x16x32_bf16 v[60:63], a[192:195], v[196:199], v[60:63]
 ds_read_b64_tr_b16 a[216:217], v31 offset:25344
 v_cvt_pk_bf16_f32 v240, v160, v161
 v_cvt_pk_bf16_f32 v225, v130, v131
 v_mfma_f32_16x16x32_bf16 v[64:67], a[192:195], v[200:203], v[64:67]
 ds_read_b64_tr_b16 a[218:219], v31 offset:29568
 v_cvt_pk_bf16_f32 v248, v176, v177
 v_mfma_f32_16x16x32_bf16 v[68:71], a[196:199], v[196:199], v[68:71]
 ds_read_b64_tr_b16 a[220:221], v31 offset:25376
 global_load_lds_dwordx4 v22, s[44:45] offset:2112
 v_cvt_pk_bf16_f32 v233, v146, v147
 v_mfma_f32_16x16x32_bf16 v[72:75], a[196:199], v[200:203], v[72:75]
 ds_read_b64_tr_b16 a[222:223], v31 offset:29600
 s_waitcnt vmcnt(16)
 s_barrier
 v_mfma_f32_16x16x32_bf16 v[76:79], a[200:203], v[196:199], v[76:79]
 ds_read_b64_tr_b16 a[192:193], v28 offset:33792
 v_cvt_pk_bf16_f32 v222, v132, v133
 v_cvt_pk_bf16_f32 v241, v162, v163
 v_mfma_f32_16x16x32_bf16 v[80:83], a[200:203], v[200:203], v[80:83]
 ds_read_b64_tr_b16 a[194:195], v28 offset:38016
 global_load_lds_dwordx4 v23, s[44:45] offset:3168
 v_mfma_f32_16x16x32_bf16 v[84:87], a[204:207], v[196:199], v[84:87]
 ds_read_b64_tr_b16 a[196:197], v28 offset:33824
 s_add_u32 m0, s63, 0
 v_cvt_pk_bf16_f32 v230, v148, v149
 v_cvt_pk_bf16_f32 v249, v178, v179
 v_mfma_f32_16x16x32_bf16 v[88:91], a[204:207], v[200:203], v[88:91]
 ds_read_b64_tr_b16 a[198:199], v28 offset:38048
 v_cvt_pk_bf16_f32 v223, v134, v135
 s_waitcnt lgkmcnt(4)
 v_mfma_f32_16x16x32_bf16 v[92:95], a[208:211], v[196:199], v[92:95]
 ds_read_b64_tr_b16 a[200:201], v29 offset:33792
 global_load_lds_dwordx4 v20, s[42:43] offset:0
 v_mfma_f32_16x16x32_bf16 v[96:99], a[208:211], v[200:203], v[96:99]
 ds_read_b64_tr_b16 a[202:203], v29 offset:38016
 v_cvt_pk_bf16_f32 v238, v164, v165
 v_mfma_f32_16x16x32_bf16 v[100:103], a[212:215], v[196:199], v[100:103]
 ds_read_b64_tr_b16 a[204:205], v29 offset:33824
 v_cvt_pk_bf16_f32 v231, v150, v151
 v_mfma_f32_16x16x32_bf16 v[104:107], a[212:215], v[200:203], v[104:107]
 ds_read_b64_tr_b16 a[206:207], v29 offset:38048
 global_load_lds_dwordx4 v21, s[42:43] offset:1056
 v_cvt_pk_bf16_f32 v226, v136, v137
 v_cvt_pk_bf16_f32 v246, v180, v181
 v_mfma_f32_16x16x32_bf16 v[108:111], a[216:219], v[196:199], v[108:111]
 ds_read_b64_tr_b16 a[208:209], v30 offset:33792
 v_cvt_pk_bf16_f32 v239, v166, v167
 v_mfma_f32_16x16x32_bf16 v[112:115], a[216:219], v[200:203], v[112:115]
 ds_read_b64_tr_b16 a[210:211], v30 offset:38016
 v_cvt_pk_bf16_f32 v227, v138, v139
 v_mfma_f32_16x16x32_bf16 v[116:119], a[220:223], v[196:199], v[116:119]
 ds_read_b64_tr_b16 a[212:213], v30 offset:33824
 global_load_lds_dwordx4 v22, s[42:43] offset:2112
 v_cvt_pk_bf16_f32 v234, v152, v153
 v_mfma_f32_16x16x32_bf16 v[120:123], a[220:223], v[200:203], v[120:123]
 ds_read_b64_tr_b16 a[214:215], v30 offset:38048
 v_cvt_pk_bf16_f32 v247, v182, v183
 v_mfma_f32_16x16x32_bf16 v[4:7], a[160:163], v[220:223], 0
 v_cvt_pk_bf16_f32 v242, v168, v169
 v_cvt_pk_bf16_f32 v235, v154, v155
 v_mfma_f32_16x16x32_bf16 v[12:15], a[160:163], v[224:227], 0
 global_load_lds_dwordx4 v23, s[42:43] offset:3168
 v_cvt_pk_bf16_f32 v250, v184, v185
 v_mfma_f32_16x16x32_bf16 v[8:11], a[164:167], v[220:223], 0
 s_waitcnt vmcnt(9)
 v_cmp_ne_u32 vcc, 1, v43
 s_cbranch_vccnz L_slow1a
L_back1a:
 v_mfma_f32_16x16x32_bf16 v[16:19], a[164:167], v[224:227], 0
 s_xor_b32 s66, s72, 0x4000
 v_cvt_pk_bf16_f32 v243, v170, v171
 v_mfma_f32_16x16x32_bf16 v[4:7], a[168:171], v[228:231], v[4:7]
 s_add_u32 s86, s32, s66
 s_addc_u32 s87, s33, 0
 v_mfma_f32_16x16x32_bf16 v[12:15], a[168:171], v[232:235], v[12:15]
 global_load_dwordx4 a[224:227], v40, s[86:87] offset:0 sc1
 v_cvt_pk_bf16_f32 v251, v186, v187
 v_mfma_f32_16x16x32_bf16 v[8:11], a[172:175], v[228:231], v[8:11]
 v_mfma_f32_16x16x32_bf16 v[16:19], a[172:175], v[232:235], v[16:19]
 v_mfma_f32_16x16x32_bf16 v[4:7], a[176:179], v[236:239], v[4:7]
 global_load_dwordx4 a[228:231], v40, s[86:87] offset:1024 sc1
 v_mfma_f32_16x16x32_bf16 v[12:15], a[176:179], v[240:243], v[12:15]
 s_xor_b32 s66, s72, 0x8000
 v_mfma_f32_16x16x32_bf16 v[8:11], a[180:183], v[236:239], v[8:11]
 s_add_u32 s86, s32, s66
 s_addc_u32 s87, s33, 0
 v_mfma_f32_16x16x32_bf16 v[16:19], a[180:183], v[240:243], v[16:19]
 global_load_dwordx4 a[232:235], v40, s[86:87] offset:0 sc1
 v_mfma_f32_16x16x32_bf16 v[4:7], a[184:187], v[244:247], v[4:7]
 v_mfma_f32_16x16x32_bf16 v[12:15], a[184:187], v[248:251], v[12:15]
 v_mfma_f32_16x16x32_bf16 v[8:11], a[188:191], v[244:247], v[8:11]
 global_load_dwordx4 a[236:239], v40, s[86:87] offset:1024 sc1
 v_mfma_f32_16x16x32_bf16 v[16:19], a[188:191], v[248:251], v[16:19]
 s_xor_b32 s66, s72, 0xc000
 s_waitcnt lgkmcnt(4)
 v_mfma_f32_16x16x32_bf16 v[60:63], a[192:195], v[204:207], v[60:63]
 ds_read_b64_tr_b16 a[216:217], v31 offset:33792
 s_add_u32 s86, s32, s66
 s_addc_u32 s87, s33, 0
 v_mfma_f32_16x16x32_bf16 v[64:67], a[192:195], v[208:211], v[64:67]
 ds_read_b64_tr_b16 a[218:219], v31 offset:38016
 global_load_dwordx4 a[240:243], v40, s[86:87] offset:0 sc1
 v_mfma_f32_16x16x32_bf16 v[68:71], a[196:199], v[204:207], v[68:71]
 ds_read_b64_tr_b16 a[220:221], v31 offset:33824
 v_max3_f32 v2, v4, v5, v6
 v_max3_f32 v3, v12, v13, v14
 v_max3_f32 v2, v2, v7, v8
 v_max3_f32 v3, v3, v15, v16
 v_max3_f32 v2, v2, v9, v10
 v_max3_f32 v3, v3, v17, v18
 v_max_f32 v2, v2, v11
 v_max_f32 v3, v3, v19
 s_nop 1
 v_permlane32_swap_b32 v2, v3
 v_max_f32 v2, v2, v3
 v_mov_b32 v48, v2
 s_nop 1
 v_permlane16_swap_b32 v2, v48
 v_max_f32 v2, v2, v48
 v_mov_b32 v3, v2
 s_nop 1
 v_permlane32_swap_b32 v2, v3
 v_mul_f32 v2, s76, v2
 v_mul_f32 v3, s76, v3
 v_fma_f32 v4, v4, s76, -v2
 v_fma_f32 v5, v5, s76, -v2
 v_fma_f32 v6, v6, s76, -v2
 v_fma_f32 v7, v7, s76, -v2
 v_fma_f32 v8, v8, s76, -v2
 v_fma_f32 v9, v9, s76, -v2
 v_fma_f32 v10, v10, s76, -v2
 v_fma_f32 v11, v11, s76, -v2
 v_fma_f32 v12, v12, s76, -v3
 v_fma_f32 v13, v13, s76, -v3
 v_fma_f32 v14, v14, s76, -v3
 v_fma_f32 v15, v15, s76, -v3
 v_fma_f32 v16, v16, s76, -v3
 v_fma_f32 v17, v17, s76, -v3
 v_fma_f32 v18, v18, s76, -v3
 v_fma_f32 v19, v19, s76, -v3
 v_exp_f32 v4, v4
 v_exp_f32 v5, v5
 v_exp_f32 v6, v6
 v_exp_f32 v7, v7
 v_exp_f32 v8, v8
 v_mfma_f32_16x16x32_bf16 v[72:75], a[196:199], v[208:211], v[72:75]
 ds_read_b64_tr_b16 a[222:223], v31 offset:38048
 v_exp_f32 v9, v9
L_hop1_1_2:
L_pad1_1962:
 s_cbranch_execz L_pad1_3048
 v_mfma_f32_16x16x32_bf16 v[76:79], a[200:203], v[204:207], v[76:79]
 ds_read_b64_tr_b16 a[192:193], v36 offset:0
 global_load_dwordx4 a[244:247], v40, s[86:87] offset:1024 sc1
 v_exp_f32 v10, v10
 v_mfma_f32_16x16x32_bf16 v[80:83], a[200:203], v[208:211], v[80:83]
 ds_read_b64_tr_b16 a[194:195], v36 offset:4224
 v_exp_f32 v11, v11
 v_mfma_f32_16x16x32_bf16 v[84:87], a[204:207], v[204:207], v[84:87]
 ds_read_b64_tr_b16 a[196:197], v36 offset:32
 v_exp_f32 v12, v12
 v_mfma_f32_16x16x32_bf16 v[88:91], a[204:207], v[208:211], v[88:91]
 ds_read_b64_tr_b16 a[198:199], v36 offset:4256
 v_exp_f32 v13, v13
 s_waitcnt lgkmcnt(4)
 v_mfma_f32_16x16x32_bf16 v[92:95], a[208:211], v[204:207], v[92:95]
 ds_read_b64_tr_b16 a[200:201], v37 offset:0
 v_exp_f32 v14, v14
 v_mfma_f32_16x16x32_bf16 v[96:99], a[208:211], v[208:211], v[96:99]
 ds_read_b64_tr_b16 a[202:203], v37 offset:4224
 v_exp_f32 v15, v15
 v_mfma_f32_16x16x32_bf16 v[100:103], a[212:215], v[204:207], v[100:103]
 ds_read_b64_tr_b16 a[204:205], v37 offset:32
 v_exp_f32 v16, v16
 v_mfma_f32_16x16x32_bf16 v[104:107], a[212:215], v[208:211], v[104:107]
 ds_read_b64_tr_b16 a[206:207], v37 offset:4256
 v_exp_f32 v17, v17
 v_mfma_f32_16x16x32_bf16 v[108:111], a[216:219], v[204:207], v[108:111]
 ds_read_b64_tr_b16 a[208:209], v38 offset:0
 v_exp_f32 v18, v18
 v_mfma_f32_16x16x32_bf16 v[112:115], a[216:219], v[208:211], v[112:115]
 ds_read_b64_tr_b16 a[210:211], v38 offset:4224
 v_exp_f32 v19, v19
 v_mfma_f32_16x16x32_bf16 v[116:119], a[220:223], v[204:207], v[116:119]
 ds_read_b64_tr_b16 a[212:213], v38 offset:32
 v_add_f32 v2, v4, v5
 v_mfma_f32_16x16x32_bf16 v[120:123], a[220:223], v[208:211], v[120:123]
 ds_read_b64_tr_b16 a[214:215], v38 offset:4256
 v_add_f32 v3, v12, v13
 s_waitcnt lgkmcnt(4)
 s_waitcnt vmcnt(5)
 v_mfma_f32_16x16x32_bf16 v[124:127], a[192:195], a[224:227], 0
 ds_read_b64_tr_b16 a[216:217], v39 offset:0
 v_add_f32 v2, v2, v6
 s_waitcnt vmcnt(4)
 v_mfma_f32_16x16x32_bf16 v[128:131], a[192:195], a[228:231], 0
 ds_read_b64_tr_b16 a[218:219], v39 offset:4224
 v_add_f32 v3, v3, v14
 v_mfma_f32_16x16x32_bf16 v[132:135], a[196:199], a[224:227], 0
 ds_read_b64_tr_b16 a[220:221], v39 offset:32
 v_add_f32 v2, v2, v7
 v_mfma_f32_16x16x32_bf16 v[136:139], a[196:199], a[228:231], 0
 ds_read_b64_tr_b16 a[222:223], v39 offset:4256
 v_add_f32 v3, v3, v15
 v_mfma_f32_16x16x32_bf16 v[140:143], a[200:203], a[224:227], 0
 ds_read_b64_tr_b16 a[192:193], v28 offset:42240
 v_add_f32 v2, v2, v8
 v_mfma_f32_16x16x32_bf16 v[144:147], a[200:203], a[228:231], 0
 ds_read_b64_tr_b16 a[194:195], v28 offset:46464
 v_add_f32 v3, v3, v16
 v_mfma_f32_16x16x32_bf16 v[148:151], a[204:207], a[224:227], 0
 ds_read_b64_tr_b16 a[196:197], v28 offset:42272
 v_add_f32 v2, v2, v9
 v_mfma_f32_16x16x32_bf16 v[152:155], a[204:207], a[228:231], 0
 ds_read_b64_tr_b16 a[198:199], v28 offset:46496
 v_add_f32 v3, v3, v17
 s_waitcnt lgkmcnt(4)
 v_mfma_f32_16x16x32_bf16 v[156:159], a[208:211], a[224:227], 0
 ds_read_b64_tr_b16 a[200:201], v29 offset:42240
 v_add_f32 v2, v2, v10
 v_mfma_f32_16x16x32_bf16 v[160:163], a[208:211], a[228:231], 0
 ds_read_b64_tr_b16 a[202:203], v29 offset:46464
 v_add_f32 v3, v3, v18
 v_mfma_f32_16x16x32_bf16 v[164:167], a[212:215], a[224:227], 0
 ds_read_b64_tr_b16 a[204:205], v29 offset:42272
 v_add_f32 v2, v2, v11
 v_mfma_f32_16x16x32_bf16 v[168:171], a[212:215], a[228:231], 0
 ds_read_b64_tr_b16 a[206:207], v29 offset:46496
 v_cvt_pk_bf16_f32 v188, v124, v125
 v_add_f32 v3, v3, v19
 v_mfma_f32_16x16x32_bf16 v[172:175], a[216:219], a[224:227], 0
 ds_read_b64_tr_b16 a[208:209], v30 offset:42240
 v_permlane32_swap_b32 v2, v3
 v_mfma_f32_16x16x32_bf16 v[176:179], a[216:219], a[228:231], 0
 ds_read_b64_tr_b16 a[210:211], v30 offset:46464
 v_add_f32 v2, v2, v3
 v_mfma_f32_16x16x32_bf16 v[180:183], a[220:223], a[224:227], 0
 ds_read_b64_tr_b16 a[212:213], v30 offset:42272
 v_cvt_pk_bf16_f32 v189, v126, v127
 v_mov_b32 v48, v2
 v_mfma_f32_16x16x32_bf16 v[184:187], a[220:223], a[228:231], 0
 ds_read_b64_tr_b16 a[214:215], v30 offset:46496
 v_permlane16_swap_b32 v2, v48
 s_waitcnt lgkmcnt(4)
 v_mfma_f32_16x16x32_bf16 v[60:63], a[192:195], v[212:215], v[60:63]
 ds_read_b64_tr_b16 a[216:217], v31 offset:42240
 s_add_u32 m0, s64, 4096
 v_add_f32 v2, v2, v48
 v_mfma_f32_16x16x32_bf16 v[64:67], a[192:195], v[216:219], v[64:67]
 ds_read_b64_tr_b16 a[218:219], v31 offset:46464
 global_load_lds_dwordx4 v24, s[58:59] offset:-4096
 v_cvt_pk_bf16_f32 v192, v128, v129
 v_cvt_pk_bf16_f32 v196, v140, v141
 v_mov_b32 v3, v2
 v_mfma_f32_16x16x32_bf16 v[68:71], a[196:199], v[212:215], v[68:71]
 ds_read_b64_tr_b16 a[220:221], v31 offset:42272
 v_permlane32_swap_b32 v2, v3
 v_mfma_f32_16x16x32_bf16 v[72:75], a[196:199], v[216:219], v[72:75]
 ds_read_b64_tr_b16 a[222:223], v31 offset:46496
 v_cvt_pk_bf16_f32 v193, v130, v131
 v_rcp_f32 v2, v2
 s_barrier
 v_mfma_f32_16x16x32_bf16 v[76:79], a[200:203], v[212:215], v[76:79]
 ds_read_b64_tr_b16 a[192:193], v32 offset:0
 global_load_lds_dwordx4 v25, s[58:59] offset:-3040
 v_rcp_f32 v3, v3
 v_mfma_f32_16x16x32_bf16 v[80:83], a[200:203], v[216:219], v[80:83]
 ds_read_b64_tr_b16 a[194:195], v32 offset:4224
 v_cvt_pk_bf16_f32 v197, v142, v143
 v_mul_f32 v4, v2, v4
 v_mfma_f32_16x16x32_bf16 v[84:87], a[204:207], v[212:215], v[84:87]
 ds_read_b64_tr_b16 a[196:197], v32 offset:32
 v_cvt_pk_bf16_f32 v190, v132, v133
 v_mul_f32 v5, v2, v5
 v_mfma_f32_16x16x32_bf16 v[88:91], a[204:207], v[216:219], v[88:91]
 ds_read_b64_tr_b16 a[198:199], v32 offset:4256
 global_load_lds_dwordx4 v26, s[58:59] offset:-1984
 v_cvt_pk_bf16_f32 v204, v156, v157
 v_mul_f32 v6, v2, v6
 s_waitcnt lgkmcnt(4)
 v_mfma_f32_16x16x32_bf16 v[92:95], a[208:211], v[212:215], v[92:95]
 ds_read_b64_tr_b16 a[200:201], v33 offset:0
 v_mul_f32 v7, v2, v7
 v_mfma_f32_16x16x32_bf16 v[96:99], a[208:211], v[216:219], v[96:99]
 ds_read_b64_tr_b16 a[202:203], v33 offset:4224
 v_cvt_pk_bf16_f32 v191, v134, v135
 v_cvt_pk_bf16_f32 v200, v144, v145
 v_mul_f32 v8, v2, v8
 v_mfma_f32_16x16x32_bf16 v[100:103], a[212:215], v[212:215], v[100:103]
 ds_read_b64_tr_b16 a[204:205], v33 offset:32
 global_load_lds_dwordx4 v27, s[58:59] offset:-928
 v_mul_f32 v9, v2, v9
 v_mfma_f32_16x16x32_bf16 v[104:107], a[212:215], v[216:219], v[104:107]
 ds_read_b64_tr_b16 a[206:207], v33 offset:4256
 s_add_u32 m0, s64, 4224
 v_mul_f32 v10, v2, v10
 v_mfma_f32_16x16x32_bf16 v[108:111], a[216:219], v[212:215], v[108:111]
 ds_read_b64_tr_b16 a[208:209], v34 offset:0
 v_cvt_pk_bf16_f32 v194, v136, v137
 v_mul_f32 v11, v2, v11
 v_mfma_f32_16x16x32_bf16 v[112:115], a[216:219], v[216:219], v[112:115]
 ds_read_b64_tr_b16 a[210:211], v34 offset:4224
 global_load_lds_dwordx4 v24, s[58:59] offset:0
 v_cvt_pk_bf16_f32 v201, v146, v147
 v_mul_f32 v12, v3, v12
 v_mfma_f32_16x16x32_bf16 v[116:119], a[220:223], v[212:215], v[116:119]
 ds_read_b64_tr_b16 a[212:213], v34 offset:32
 v_cvt_pk_bf16_f32 v205, v158, v159
 v_cvt_pk_bf16_f32 v195, v138, v139
 v_mul_f32 v13, v3, v13
 v_mfma_f32_16x16x32_bf16 v[120:123], a[220:223], v[216:219], v[120:123]
 ds_read_b64_tr_b16 a[214:215], v34 offset:4256
 v_mul_f32 v14, v3, v14
 s_waitcnt lgkmcnt(4)
 v_mfma_f32_16x16x32_bf16 v[60:63], a[192:195], v[188:191], v[60:63]
 ds_read_b64_tr_b16 a[216:217], v35 offset:0
 global_load_lds_dwordx4 v25, s[58:59] offset:1056
 v_mul_f32 v15, v3, v15
 v_mfma_f32_16x16x32_bf16 v[64:67], a[192:195], v[192:195], v[64:67]
 ds_read_b64_tr_b16 a[218:219], v35 offset:4224
 v_mul_f32 v16, v3, v16
 v_mfma_f32_16x16x32_bf16 v[68:71], a[196:199], v[188:191], v[68:71]
 ds_read_b64_tr_b16 a[220:221], v35 offset:32
 v_cvt_pk_bf16_f32 v198, v148, v149
 v_mul_f32 v17, v3, v17
 v_mfma_f32_16x16x32_bf16 v[72:75], a[196:199], v[192:195], v[72:75]
 ds_read_b64_tr_b16 a[222:223], v35 offset:4256
 global_load_lds_dwordx4 v26, s[58:59] offset:2112
 v_mul_f32 v18, v3, v18
 v_mfma_f32_16x16x32_bf16 v[76:79], a[200:203], v[188:191], v[76:79]
 ds_read_b64_tr_b16 a[192:193], v32 offset:8448
 v_mul_f32 v19, v3, v19
 v_mfma_f32_16x16x32_bf16 v[80:83], a[200:203], v[192:195], v[80:83]
 ds_read_b64_tr_b16 a[194:195], v32 offset:12672
 v_cvt_pk_bf16_f32 v208, v160, v161
 v_cvt_pk_bf16_f32 v52, v4, v5
 v_mfma_f32_16x16x32_bf16 v[84:87], a[204:207], v[188:191], v[84:87]
 ds_read_b64_tr_b16 a[196:197], v32 offset:8480
 global_load_lds_dwordx4 v27, s[58:59] offset:3168
 v_cvt_pk_bf16_f32 v212, v172, v173
 v_cvt_pk_bf16_f32 v199, v150, v151
 v_cvt_pk_bf16_f32 v53, v6, v7
 v_mfma_f32_16x16x32_bf16 v[88:91], a[204:207], v[192:195], v[88:91]
 ds_read_b64_tr_b16 a[198:199], v32 offset:12704
 s_add_u32 m0, s63, 16896
 v_cvt_pk_bf16_f32 v54, v8, v9
 s_waitcnt lgkmcnt(4)
 v_mfma_f32_16x16x32_bf16 v[92:95], a[208:211], v[188:191], v[92:95]
 ds_read_b64_tr_b16 a[200:201], v33 offset:8448
 v_cvt_pk_bf16_f32 v55, v10, v11
 v_mfma_f32_16x16x32_bf16 v[96:99], a[208:211], v[192:195], v[96:99]
 ds_read_b64_tr_b16 a[202:203], v33 offset:12672
 global_load_lds_dwordx4 v20, s[40:41] offset:0
 v_cvt_pk_bf16_f32 v56, v12, v13
 v_mfma_f32_16x16x32_bf16 v[100:103], a[212:215], v[188:191], v[100:103]
 ds_read_b64_tr_b16 a[204:205], v33 offset:8480
 v_cvt_pk_bf16_f32 v202, v152, v153
 v_cvt_pk_bf16_f32 v57, v14, v15
 v_mfma_f32_16x16x32_bf16 v[104:107], a[212:215], v[192:195], v[104:107]
 ds_read_b64_tr_b16 a[206:207], v33 offset:12704
 v_cvt_pk_bf16_f32 v213, v174, v175
 v_cvt_pk_bf16_f32 v58, v16, v17
 v_mfma_f32_16x16x32_bf16 v[108:111], a[216:219], v[188:191], v[108:111]
 ds_read_b64_tr_b16 a[208:209], v34 offset:8448
 global_load_lds_dwordx4 v21, s[40:41] offset:1056
 v_cvt_pk_bf16_f32 v209, v162, v163
 v_cvt_pk_bf16_f32 v59, v18, v19
 v_mfma_f32_16x16x32_bf16 v[112:115], a[216:219], v[192:195], v[112:115]
 ds_read_b64_tr_b16 a[210:211], v34 offset:12672
 v_cvt_pk_bf16_f32 v203, v154, v155
 v_mfma_f32_16x16x32_bf16 v[116:119], a[220:223], v[188:191], v[116:119]
 ds_read_b64_tr_b16 a[212:213], v34 offset:8480
 v_cvt_pk_bf16_f32 v216, v176, v177
 v_mfma_f32_16x16x32_bf16 v[120:123], a[220:223], v[192:195], v[120:123]
 ds_read_b64_tr_b16 a[214:215], v34 offset:12704
 s_xor_b32 s65, s72, 0x2000
 buffer_store_dwordx4 v[52:55], v40, s[32:35], s65 offen sc1
 s_waitcnt lgkmcnt(4)
 v_mfma_f32_16x16x32_bf16 v[60:63], a[192:195], v[196:199], v[60:63]
 ds_read_b64_tr_b16 a[216:217], v35 offset:8448
 v_cvt_pk_bf16_f32 v206, v164, v165
 v_mfma_f32_16x16x32_bf16 v[64:67], a[192:195], v[200:203], v[64:67]
 ds_read_b64_tr_b16 a[218:219], v35 offset:12672
 v_cvt_pk_bf16_f32 v217, v178, v179
 v_mfma_f32_16x16x32_bf16 v[68:71], a[196:199], v[196:199], v[68:71]
 ds_read_b64_tr_b16 a[220:221], v35 offset:8480
 buffer_store_dwordx4 v[56:59], v40, s[32:35], s65 offen offset:1024 sc1
 v_mfma_f32_16x16x32_bf16 v[72:75], a[196:199], v[200:203], v[72:75]
 ds_read_b64_tr_b16 a[222:223], v35 offset:12704
 v_mfma_f32_16x16x32_bf16 v[76:79], a[200:203], v[196:199], v[76:79]
 ds_read_b64_tr_b16 a[192:193], v36 offset:8704
 v_cvt_pk_bf16_f32 v207, v166, v167
 v_mfma_f32_16x16x32_bf16 v[80:83], a[200:203], v[200:203], v[80:83]
 ds_read_b64_tr_b16 a[194:195], v36 offset:12928
 global_load_lds_dwordx4 v22, s[40:41] offset:2112
 v_mfma_f32_16x16x32_bf16 v[84:87], a[204:207], v[196:199], v[84:87]
 ds_read_b64_tr_b16 a[196:197], v36 offset:8736
 v_cvt_pk_bf16_f32 v214, v180, v181
 v_mfma_f32_16x16x32_bf16 v[88:91], a[204:207], v[200:203], v[88:91]
 ds_read_b64_tr_b16 a[198:199], v36 offset:12960
 s_waitcnt lgkmcnt(4)
 v_mfma_f32_16x16x32_bf16 v[92:95], a[208:211], v[196:199], v[92:95]
 ds_read_b64_tr_b16 a[200:201], v37 offset:8704
 global_load_lds_dwordx4 v23, s[40:41] offset:3168
 v_mfma_f32_16x16x32_bf16 v[96:99], a[208:211], v[200:203], v[96:99]
 ds_read_b64_tr_b16 a[202:203], v37 offset:12928
 v_cvt_pk_bf16_f32 v210, v168, v169
 v_mfma_f32_16x16x32_bf16 v[100:103], a[212:215], v[196:199], v[100:103]
 ds_read_b64_tr_b16 a[204:205], v37 offset:8736
 v_cvt_pk_bf16_f32 v215, v182, v183
 v_mfma_f32_16x16x32_bf16 v[104:107], a[212:215], v[200:203], v[104:107]
 ds_read_b64_tr_b16 a[206:207], v37 offset:12960
 v_cvt_pk_bf16_f32 v218, v184, v185
 v_mfma_f32_16x16x32_bf16 v[108:111], a[216:219], v[196:199], v[108:111]
 ds_read_b64_tr_b16 a[208:209], v38 offset:8704
 v_cvt_pk_bf16_f32 v211, v170, v171
 v_mfma_f32_16x16x32_bf16 v[112:115], a[216:219], v[200:203], v[112:115]
 ds_read_b64_tr_b16 a[210:211], v38 offset:12928
 v_cvt_pk_bf16_f32 v219, v186, v187
 v_mfma_f32_16x16x32_bf16 v[116:119], a[220:223], v[196:199], v[116:119]
 ds_read_b64_tr_b16 a[212:213], v38 offset:8736
 v_mfma_f32_16x16x32_bf16 v[120:123], a[220:223], v[200:203], v[120:123]
 ds_read_b64_tr_b16 a[214:215], v38 offset:12960
 s_waitcnt lgkmcnt(4)
 s_waitcnt vmcnt(17)
 v_mfma_f32_16x16x32_bf16 v[124:127], a[192:195], a[232:235], 0
 ds_read_b64_tr_b16 a[216:217], v39 offset:8704
 s_waitcnt vmcnt(16)
 v_mfma_f32_16x16x32_bf16 v[128:131], a[192:195], a[236:239], 0
 ds_read_b64_tr_b16 a[218:219], v39 offset:12928
 v_mfma_f32_16x16x32_bf16 v[132:135], a[196:199], a[232:235], 0
 ds_read_b64_tr_b16 a[220:221], v39 offset:8736
 v_mfma_f32_16x16x32_bf16 v[136:139], a[196:199], a[236:239], 0
 ds_read_b64_tr_b16 a[222:223], v39 offset:12960
 s_barrier
 v_mfma_f32_16x16x32_bf16 v[140:143], a[200:203], a[232:235], 0
 ds_read_b64_tr_b16 a[192:193], v32 offset:16896
 s_add_u32 m0, s63, 33792
 v_mfma_f32_16x16x32_bf16 v[144:147], a[200:203], a[236:239], 0
L_hop1_1_3:
L_pad1_2250:
 s_cbranch_execz L_pad1_3313
 ds_read_b64_tr_b16 a[194:195], v32 offset:21120
 global_load_lds_dwordx4 v20, s[38:39] offset:0
 v_mfma_f32_16x16x32_bf16 v[148:151], a[204:207], a[232:235], 0
 ds_read_b64_tr_b16 a[196:197], v32 offset:16928
 v_mfma_f32_16x16x32_bf16 v[152:155], a[204:207], a[236:239], 0
 ds_read_b64_tr_b16 a[198:199], v32 offset:21152
 s_waitcnt lgkmcnt(4)
 v_mfma_f32_16x16x32_bf16 v[156:159], a[208:211], a[232:235], 0
 ds_read_b64_tr_b16 a[200:201], v33 offset:16896
 global_load_lds_dwordx4 v21, s[38:39] offset:1056
 v_mfma_f32_16x16x32_bf16 v[160:163], a[208:211], a[236:239], 0
 ds_read_b64_tr_b16 a[202:203], v33 offset:21120
 v_cvt_pk_bf16_f32 v188, v124, v125
 v_mfma_f32_16x16x32_bf16 v[164:167], a[212:215], a[232:235], 0
 ds_read_b64_tr_b16 a[204:205], v33 offset:16928
 v_cvt_pk_bf16_f32 v189, v126, v127
 v_mfma_f32_16x16x32_bf16 v[168:171], a[212:215], a[236:239], 0
 ds_read_b64_tr_b16 a[206:207], v33 offset:21152
 global_load_lds_dwordx4 v22, s[38:39] offset:2112
 v_mfma_f32_16x16x32_bf16 v[172:175], a[216:219], a[232:235], 0
 ds_read_b64_tr_b16 a[208:209], v34 offset:16896
 v_cvt_pk_bf16_f32 v196, v140, v141
 v_mfma_f32_16x16x32_bf16 v[176:179], a[216:219], a[236:239], 0
 ds_read_b64_tr_b16 a[210:211], v34 offset:21120
 v_cvt_pk_bf16_f32 v192, v128, v129
 v_mfma_f32_16x16x32_bf16 v[180:183], a[220:223], a[232:235], 0
 ds_read_b64_tr_b16 a[212:213], v34 offset:16928
 global_load_lds_dwordx4 v23, s[38:39] offset:3168
 v_mfma_f32_16x16x32_bf16 v[184:187], a[220:223], a[236:239], 0
 ds_read_b64_tr_b16 a[214:215], v34 offset:21152
 s_add_u32 m0, s63, 50688
 s_waitcnt lgkmcnt(4)
 v_mfma_f32_16x16x32_bf16 v[60:63], a[192:195], v[204:207], v[60:63]
 ds_read_b64_tr_b16 a[216:217], v35 offset:16896
 v_cvt_pk_bf16_f32 v197, v142, v143
 v_mfma_f32_16x16x32_bf16 v[64:67], a[192:195], v[208:211], v[64:67]
 ds_read_b64_tr_b16 a[218:219], v35 offset:21120
 global_load_lds_dwordx4 v20, s[36:37] offset:0
 v_mfma_f32_16x16x32_bf16 v[68:71], a[196:199], v[204:207], v[68:71]
 ds_read_b64_tr_b16 a[220:221], v35 offset:16928
 v_cvt_pk_bf16_f32 v193, v130, v131
 v_mfma_f32_16x16x32_bf16 v[72:75], a[196:199], v[208:211], v[72:75]
 ds_read_b64_tr_b16 a[222:223], v35 offset:21152
 v_cvt_pk_bf16_f32 v200, v144, v145
 v_mfma_f32_16x16x32_bf16 v[76:79], a[200:203], v[204:207], v[76:79]
 ds_read_b64_tr_b16 a[192:193], v32 offset:25344
 global_load_lds_dwordx4 v21, s[36:37] offset:1056
 v_mfma_f32_16x16x32_bf16 v[80:83], a[200:203], v[208:211], v[80:83]
 ds_read_b64_tr_b16 a[194:195], v32 offset:29568
 v_cvt_pk_bf16_f32 v190, v132, v133
 v_mfma_f32_16x16x32_bf16 v[84:87], a[204:207], v[204:207], v[84:87]
 ds_read_b64_tr_b16 a[196:197], v32 offset:25376
 v_cvt_pk_bf16_f32 v191, v134, v135
 v_mfma_f32_16x16x32_bf16 v[88:91], a[204:207], v[208:211], v[88:91]
 ds_read_b64_tr_b16 a[198:199], v32 offset:29600
 global_load_lds_dwordx4 v22, s[36:37] offset:2112
 s_waitcnt lgkmcnt(4)
 v_mfma_f32_16x16x32_bf16 v[92:95], a[208:211], v[204:207], v[92:95]
 ds_read_b64_tr_b16 a[200:201], v33 offset:25344
 v_cvt_pk_bf16_f32 v201, v146, v147
 v_mfma_f32_16x16x32_bf16 v[96:99], a[208:211], v[208:211], v[96:99]
 ds_read_b64_tr_b16 a[202:203], v33 offset:29568
 v_cvt_pk_bf16_f32 v194, v136, v137
 v_mfma_f32_16x16x32_bf16 v[100:103], a[212:215], v[204:207], v[100:103]
 ds_read_b64_tr_b16 a[204:205], v33 offset:25376
 global_load_lds_dwordx4 v23, s[36:37] offset:3168
 v_mfma_f32_16x16x32_bf16 v[104:107], a[212:215], v[208:211], v[104:107]
 ds_read_b64_tr_b16 a[206:207], v33 offset:29600
 s_add_u32 m0, s64, 12800
 v_mfma_f32_16x16x32_bf16 v[108:111], a[216:219], v[204:207], v[108:111]
 ds_read_b64_tr_b16 a[208:209], v34 offset:25344
 v_cvt_pk_bf16_f32 v198, v148, v149
 v_mfma_f32_16x16x32_bf16 v[112:115], a[216:219], v[208:211], v[112:115]
 ds_read_b64_tr_b16 a[210:211], v34 offset:29568
 global_load_lds_dwordx4 v24, s[56:57] offset:-4096
 v_mfma_f32_16x16x32_bf16 v[116:119], a[220:223], v[204:207], v[116:119]
 ds_read_b64_tr_b16 a[212:213], v34 offset:25376
 v_cvt_pk_bf16_f32 v195, v138, v139
 v_mfma_f32_16x16x32_bf16 v[120:123], a[220:223], v[208:211], v[120:123]
 ds_read_b64_tr_b16 a[214:215], v34 offset:29600
 s_waitcnt lgkmcnt(4)
 v_mfma_f32_16x16x32_bf16 v[60:63], a[192:195], v[212:215], v[60:63]
 ds_read_b64_tr_b16 a[216:217], v35 offset:25344
 global_load_lds_dwordx4 v25, s[56:57] offset:-3040
 v_mfma_f32_16x16x32_bf16 v[64:67], a[192:195], v[216:219], v[64:67]
 ds_read_b64_tr_b16 a[218:219], v35 offset:29568
 v_cvt_pk_bf16_f32 v204, v156, v157
 v_mfma_f32_16x16x32_bf16 v[68:71], a[196:199], v[212:215], v[68:71]
 ds_read_b64_tr_b16 a[220:221], v35 offset:25376
 v_cvt_pk_bf16_f32 v205, v158, v159
 v_mfma_f32_16x16x32_bf16 v[72:75], a[196:199], v[216:219], v[72:75]
 ds_read_b64_tr_b16 a[222:223], v35 offset:29600
 global_load_lds_dwordx4 v26, s[56:57] offset:-1984
 s_barrier
 v_mfma_f32_16x16x32_bf16 v[76:79], a[200:203], v[212:215], v[76:79]
 ds_read_b64_tr_b16 a[192:193], v28 offset:0
 v_cvt_pk_bf16_f32 v208, v160, v161
 v_mfma_f32_16x16x32_bf16 v[80:83], a[200:203], v[216:219], v[80:83]
 ds_read_b64_tr_b16 a[194:195], v28 offset:4224
 v_cvt_pk_bf16_f32 v199, v150, v151
 v_mfma_f32_16x16x32_bf16 v[84:87], a[204:207], v[212:215], v[84:87]
 ds_read_b64_tr_b16 a[196:197], v28 offset:32
 s_waitcnt vmcnt(13)
 s_mov_b64 exec, 1
 buffer_store_dword v44, v45, s[32:35], s74 offen offset:4 sc1
 s_mov_b64 exec, -1
 v_mfma_f32_16x16x32_bf16 v[88:91], a[204:207], v[216:219], v[88:91]
 ds_read_b64_tr_b16 a[198:199], v28 offset:4256
 s_waitcnt lgkmcnt(4)
 v_mfma_f32_16x16x32_bf16 v[92:95], a[208:211], v[212:215], v[92:95]
 ds_read_b64_tr_b16 a[200:201], v29 offset:0
 v_cvt_pk_bf16_f32 v209, v162, v163
 v_mfma_f32_16x16x32_bf16 v[96:99], a[208:211], v[216:219], v[96:99]
 ds_read_b64_tr_b16 a[202:203], v29 offset:4224
 global_load_lds_dwordx4 v27, s[56:57] offset:-928
 v_mfma_f32_16x16x32_bf16 v[100:103], a[212:215], v[212:215], v[100:103]
 ds_read_b64_tr_b16 a[204:205], v29 offset:32
 s_add_u32 m0, s64, 12928
 v_mfma_f32_16x16x32_bf16 v[104:107], a[212:215], v[216:219], v[104:107]
 ds_read_b64_tr_b16 a[206:207], v29 offset:4256
 v_cvt_pk_bf16_f32 v202, v152, v153
 v_mfma_f32_16x16x32_bf16 v[108:111], a[216:219], v[212:215], v[108:111]
 ds_read_b64_tr_b16 a[208:209], v30 offset:0
 global_load_lds_dwordx4 v24, s[56:57] offset:0
 v_mfma_f32_16x16x32_bf16 v[112:115], a[216:219], v[216:219], v[112:115]
 ds_read_b64_tr_b16 a[210:211], v30 offset:4224
 v_cvt_pk_bf16_f32 v206, v164, v165
 v_mfma_f32_16x16x32_bf16 v[116:119], a[220:223], v[212:215], v[116:119]
 ds_read_b64_tr_b16 a[212:213], v30 offset:32
 v_cvt_pk_bf16_f32 v203, v154, v155
 v_mfma_f32_16x16x32_bf16 v[120:123], a[220:223], v[216:219], v[120:123]
 ds_read_b64_tr_b16 a[214:215], v30 offset:4256
 global_load_lds_dwordx4 v25, s[56:57] offset:1056
 s_waitcnt lgkmcnt(4)
 v_mfma_f32_16x16x32_bf16 v[60:63], a[192:195], v[188:191], v[60:63]
 ds_read_b64_tr_b16 a[216:217], v31 offset:0
 v_cvt_pk_bf16_f32 v212, v172, v173
 v_mfma_f32_16x16x32_bf16 v[64:67], a[192:195], v[192:195], v[64:67]
 ds_read_b64_tr_b16 a[218:219], v31 offset:4224
 v_cvt_pk_bf16_f32 v213, v174, v175
 v_mfma_f32_16x16x32_bf16 v[68:71], a[196:199], v[188:191], v[68:71]
 ds_read_b64_tr_b16 a[220:221], v31 offset:32
 global_load_lds_dwordx4 v26, s[56:57] offset:2112
 v_mfma_f32_16x16x32_bf16 v[72:75], a[196:199], v[192:195], v[72:75]
 ds_read_b64_tr_b16 a[222:223], v31 offset:4256
 v_cvt_pk_bf16_f32 v207, v166, v167
 v_mfma_f32_16x16x32_bf16 v[76:79], a[200:203], v[188:191], v[76:79]
 ds_read_b64_tr_b16 a[192:193], v28 offset:8448
 v_cvt_pk_bf16_f32 v216, v176, v177
 v_mfma_f32_16x16x32_bf16 v[80:83], a[200:203], v[192:195], v[80:83]
 ds_read_b64_tr_b16 a[194:195], v28 offset:12672
 global_load_lds_dwordx4 v27, s[56:57] offset:3168
 v_mfma_f32_16x16x32_bf16 v[84:87], a[204:207], v[188:191], v[84:87]
 ds_read_b64_tr_b16 a[196:197], v28 offset:8480
 v_cvt_pk_bf16_f32 v210, v168, v169
 v_mfma_f32_16x16x32_bf16 v[88:91], a[204:207], v[192:195], v[88:91]
 ds_read_b64_tr_b16 a[198:199], v28 offset:12704
 s_waitcnt lgkmcnt(4)
 v_mfma_f32_16x16x32_bf16 v[92:95], a[208:211], v[188:191], v[92:95]
 ds_read_b64_tr_b16 a[200:201], v29 offset:8448
 v_cvt_pk_bf16_f32 v217, v178, v179
 v_mfma_f32_16x16x32_bf16 v[96:99], a[208:211], v[192:195], v[96:99]
 ds_read_b64_tr_b16 a[202:203], v29 offset:12672
 v_cvt_pk_bf16_f32 v211, v170, v171
 v_mfma_f32_16x16x32_bf16 v[100:103], a[212:215], v[188:191], v[100:103]
 ds_read_b64_tr_b16 a[204:205], v29 offset:8480
 v_cvt_pk_bf16_f32 v214, v180, v181
 v_mfma_f32_16x16x32_bf16 v[104:107], a[212:215], v[192:195], v[104:107]
 ds_read_b64_tr_b16 a[206:207], v29 offset:12704
 v_cvt_pk_bf16_f32 v215, v182, v183
 v_mfma_f32_16x16x32_bf16 v[108:111], a[216:219], v[188:191], v[108:111]
 ds_read_b64_tr_b16 a[208:209], v30 offset:8448
 v_cvt_pk_bf16_f32 v218, v184, v185
 v_mfma_f32_16x16x32_bf16 v[112:115], a[216:219], v[192:195], v[112:115]
 ds_read_b64_tr_b16 a[210:211], v30 offset:12672
 v_cvt_pk_bf16_f32 v219, v186, v187
 v_mfma_f32_16x16x32_bf16 v[116:119], a[220:223], v[188:191], v[116:119]
 ds_read_b64_tr_b16 a[212:213], v30 offset:8480
 v_mfma_f32_16x16x32_bf16 v[120:123], a[220:223], v[192:195], v[120:123]
 ds_read_b64_tr_b16 a[214:215], v30 offset:12704
 s_waitcnt lgkmcnt(4)
 v_mfma_f32_16x16x32_bf16 v[60:63], a[192:195], v[196:199], v[60:63]
 ds_read_b64_tr_b16 a[216:217], v31 offset:8448
 v_mfma_f32_16x16x32_bf16 v[64:67], a[192:195], v[200:203], v[64:67]
 ds_read_b64_tr_b16 a[218:219], v31 offset:12672
 v_mfma_f32_16x16x32_bf16 v[68:71], a[196:199], v[196:199], v[68:71]
 ds_read_b64_tr_b16 a[220:221], v31 offset:8480
 v_mfma_f32_16x16x32_bf16 v[72:75], a[196:199], v[200:203], v[72:75]
 ds_read_b64_tr_b16 a[222:223], v31 offset:12704
 s_waitcnt vmcnt(17)
 s_barrier
 v_mfma_f32_16x16x32_bf16 v[76:79], a[200:203], v[196:199], v[76:79]
 ds_read_b64_tr_b16 a[192:193], v28 offset:16896
 s_add_u32 m0, s63, 67584
 v_mfma_f32_16x16x32_bf16 v[80:83], a[200:203], v[200:203], v[80:83]
 ds_read_b64_tr_b16 a[194:195], v28 offset:21120
 global_load_lds_dwordx4 v20, s[30:31] offset:0
 v_mfma_f32_16x16x32_bf16 v[84:87], a[204:207], v[196:199], v[84:87]
 ds_read_b64_tr_b16 a[196:197], v28 offset:16928
 v_mfma_f32_16x16x32_bf16 v[88:91], a[204:207], v[200:203], v[88:91]
 ds_read_b64_tr_b16 a[198:199], v28 offset:21152
 s_waitcnt lgkmcnt(4)
 v_mfma_f32_16x16x32_bf16 v[92:95], a[208:211], v[196:199], v[92:95]
 ds_read_b64_tr_b16 a[200:201], v29 offset:16896
 global_load_lds_dwordx4 v21, s[30:31] offset:1056
 v_mfma_f32_16x16x32_bf16 v[96:99], a[208:211], v[200:203], v[96:99]
 ds_read_b64_tr_b16 a[202:203], v29 offset:21120
 v_mfma_f32_16x16x32_bf16 v[100:103], a[212:215], v[196:199], v[100:103]
 ds_read_b64_tr_b16 a[204:205], v29 offset:16928
 v_mfma_f32_16x16x32_bf16 v[104:107], a[212:215], v[200:203], v[104:107]
 ds_read_b64_tr_b16 a[206:207], v29 offset:21152
 global_load_lds_dwordx4 v22, s[30:31] offset:2112
 v_mfma_f32_16x16x32_bf16 v[108:111], a[216:219], v[196:199], v[108:111]
 ds_read_b64_tr_b16 a[208:209], v30 offset:16896
 v_mfma_f32_16x16x32_bf16 v[112:115], a[216:219], v[200:203], v[112:115]
 ds_read_b64_tr_b16 a[210:211], v30 offset:21120
 v_mfma_f32_16x16x32_bf16 v[116:119], a[220:223], v[196:199], v[116:119]
 ds_read_b64_tr_b16 a[212:213], v30 offset:16928
 global_load_lds_dwordx4 v23, s[30:31] offset:3168
 v_mfma_f32_16x16x32_bf16 v[120:123], a[220:223], v[200:203], v[120:123]
 ds_read_b64_tr_b16 a[214:215], v30 offset:21152
 s_waitcnt lgkmcnt(4)
 v_mfma_f32_16x16x32_bf16 v[60:63], a[192:195], v[204:207], v[60:63]
 ds_read_b64_tr_b16 a[216:217], v31 offset:16896
 v_mfma_f32_16x16x32_bf16 v[64:67], a[192:195], v[208:211], v[64:67]
 ds_read_b64_tr_b16 a[218:219], v31 offset:21120
 v_mfma_f32_16x16x32_bf16 v[68:71], a[196:199], v[204:207], v[68:71]
 ds_read_b64_tr_b16 a[220:221], v31 offset:16928
 v_mfma_f32_16x16x32_bf16 v[72:75], a[196:199], v[208:211], v[72:75]
 ds_read_b64_tr_b16 a[222:223], v31 offset:21152
 v_mfma_f32_16x16x32_bf16 v[76:79], a[200:203], v[204:207], v[76:79]
 ds_read_b64_tr_b16 a[192:193], v36 offset:0
 v_mfma_f32_16x16x32_bf16 v[80:83], a[200:203], v[208:211], v[80:83]
 ds_read_b64_tr_b16 a[194:195], v36 offset:4224
 v_mfma_f32_16x16x32_bf16 v[84:87], a[204:207], v[204:207], v[84:87]
 ds_read_b64_tr_b16 a[196:197], v36 offset:32
 v_mfma_f32_16x16x32_bf16 v[88:91], a[204:207], v[208:211], v[88:91]
 ds_read_b64_tr_b16 a[198:199], v36 offset:4256
 s_waitcnt lgkmcnt(4)
 v_mfma_f32_16x16x32_bf16 v[92:95], a[208:211], v[204:207], v[92:95]
 ds_read_b64_tr_b16 a[200:201], v37 offset:0
 v_mfma_f32_16x16x32_bf16 v[96:99], a[208:211], v[208:211], v[96:99]
 ds_read_b64_tr_b16 a[202:203], v37 offset:4224
 v_mfma_f32_16x16x32_bf16 v[100:103], a[212:215], v[204:207], v[100:103]
 ds_read_b64_tr_b16 a[204:205], v37 offset:32
 v_mfma_f32_16x16x32_bf16 v[104:107], a[212:215], v[208:211], v[104:107]
 ds_read_b64_tr_b16 a[206:207], v37 offset:4256
 v_mfma_f32_16x16x32_bf16 v[108:111], a[216:219], v[204:207], v[108:111]
 ds_read_b64_tr_b16 a[208:209], v38 offset:0
 v_mfma_f32_16x16x32_bf16 v[112:115], a[216:219], v[208:211], v[112:115]
 ds_read_b64_tr_b16 a[210:211], v38 offset:4224
 v_mfma_f32_16x16x32_bf16 v[116:119], a[220:223], v[204:207], v[116:119]
 ds_read_b64_tr_b16 a[212:213], v38 offset:32
 v_mfma_f32_16x16x32_bf16 v[120:123], a[220:223], v[208:211], v[120:123]
 ds_read_b64_tr_b16 a[214:215], v38 offset:4256
 s_waitcnt lgkmcnt(4)
 v_mfma_f32_16x16x32_bf16 v[124:127], a[192:195], a[240:243], 0
 ds_read_b64_tr_b16 a[216:217], v39 offset:0
 v_mfma_f32_16x16x32_bf16 v[128:131], a[192:195], a[244:247], 0
 ds_read_b64_tr_b16 a[218:219], v39 offset:4224
 v_mfma_f32_16x16x32_bf16 v[132:135], a[196:199], a[240:243], 0
 ds_read_b64_tr_b16 a[220:221], v39 offset:32
 v_mfma_f32_16x16x32_bf16 v[136:139], a[196:199], a[244:247], 0
 ds_read_b64_tr_b16 a[222:223], v39 offset:4256
 v_mfma_f32_16x16x32_bf16 v[140:143], a[200:203], a[240:243], 0
L_pad1_2515:
 s_cbranch_execz L_pad1_3582
 ds_read_b64_tr_b16 a[192:193], v28 offset:25344
 v_mfma_f32_16x16x32_bf16 v[144:147], a[200:203], a[244:247], 0
 ds_read_b64_tr_b16 a[194:195], v28 offset:29568
 v_mfma_f32_16x16x32_bf16 v[148:151], a[204:207], a[240:243], 0
 ds_read_b64_tr_b16 a[196:197], v28 offset:25376
 v_mfma_f32_16x16x32_bf16 v[152:155], a[204:207], a[244:247], 0
 ds_read_b64_tr_b16 a[198:199], v28 offset:29600
 s_waitcnt lgkmcnt(4)
 v_mfma_f32_16x16x32_bf16 v[156:159], a[208:211], a[240:243], 0
 ds_read_b64_tr_b16 a[200:201], v29 offset:25344
 v_cvt_pk_bf16_f32 v188, v124, v125
 v_mfma_f32_16x16x32_bf16 v[160:163], a[208:211], a[244:247], 0
 ds_read_b64_tr_b16 a[202:203], v29 offset:29568
 v_cvt_pk_bf16_f32 v189, v126, v127
 v_mfma_f32_16x16x32_bf16 v[164:167], a[212:215], a[240:243], 0
 ds_read_b64_tr_b16 a[204:205], v29 offset:25376
 v_cvt_pk_bf16_f32 v192, v128, v129
 v_mfma_f32_16x16x32_bf16 v[168:171], a[212:215], a[244:247], 0
 ds_read_b64_tr_b16 a[206:207], v29 offset:29600
 v_cvt_pk_bf16_f32 v193, v130, v131
 v_mfma_f32_16x16x32_bf16 v[172:175], a[216:219], a[240:243], 0
 ds_read_b64_tr_b16 a[208:209], v30 offset:25344
 v_cvt_pk_bf16_f32 v196, v140, v141
 v_mfma_f32_16x16x32_bf16 v[176:179], a[216:219], a[244:247], 0
 ds_read_b64_tr_b16 a[210:211], v30 offset:29568
 v_cvt_pk_bf16_f32 v190, v132, v133
 v_mfma_f32_16x16x32_bf16 v[180:183], a[220:223], a[240:243], 0
 ds_read_b64_tr_b16 a[212:213], v30 offset:25376
 v_cvt_pk_bf16_f32 v197, v142, v143
 v_mfma_f32_16x16x32_bf16 v[184:187], a[220:223], a[244:247], 0
 ds_read_b64_tr_b16 a[214:215], v30 offset:29600
 s_waitcnt lgkmcnt(4)
 v_mfma_f32_16x16x32_bf16 v[60:63], a[192:195], v[212:215], v[60:63]
 ds_read_b64_tr_b16 a[216:217], v31 offset:25344
 s_add_u32 m0, s64, 4096
 v_mfma_f32_16x16x32_bf16 v[64:67], a[192:195], v[216:219], v[64:67]
 ds_read_b64_tr_b16 a[218:219], v31 offset:29568
 global_load_lds_dwordx4 v24, s[54:55] offset:-4096
 v_mfma_f32_16x16x32_bf16 v[68:71], a[196:199], v[212:215], v[68:71]
 ds_read_b64_tr_b16 a[220:221], v31 offset:25376
 v_cvt_pk_bf16_f32 v204, v156, v157
 v_mfma_f32_16x16x32_bf16 v[72:75], a[196:199], v[216:219], v[72:75]
 ds_read_b64_tr_b16 a[222:223], v31 offset:29600
 s_waitcnt vmcnt(18)
 s_barrier
 v_mfma_f32_16x16x32_bf16 v[76:79], a[200:203], v[212:215], v[76:79]
 ds_read_b64_tr_b16 a[192:193], v28 offset:33792
 global_load_lds_dwordx4 v25, s[54:55] offset:-3040
 v_mfma_f32_16x16x32_bf16 v[80:83], a[200:203], v[216:219], v[80:83]
 ds_read_b64_tr_b16 a[194:195], v28 offset:38016
 v_cvt_pk_bf16_f32 v191, v134, v135
 v_mfma_f32_16x16x32_bf16 v[84:87], a[204:207], v[212:215], v[84:87]
 ds_read_b64_tr_b16 a[196:197], v28 offset:33824
 v_cvt_pk_bf16_f32 v205, v158, v159
 v_mfma_f32_16x16x32_bf16 v[88:91], a[204:207], v[216:219], v[88:91]
 ds_read_b64_tr_b16 a[198:199], v28 offset:38048
 global_load_lds_dwordx4 v26, s[54:55] offset:-1984
 s_waitcnt lgkmcnt(4)
 v_mfma_f32_16x16x32_bf16 v[92:95], a[208:211], v[212:215], v[92:95]
 ds_read_b64_tr_b16 a[200:201], v29 offset:33792
 v_cvt_pk_bf16_f32 v200, v144, v145
 v_mfma_f32_16x16x32_bf16 v[96:99], a[208:211], v[216:219], v[96:99]
 ds_read_b64_tr_b16 a[202:203], v29 offset:38016
 v_cvt_pk_bf16_f32 v194, v136, v137
 v_mfma_f32_16x16x32_bf16 v[100:103], a[212:215], v[212:215], v[100:103]
 ds_read_b64_tr_b16 a[204:205], v29 offset:33824
 global_load_lds_dwordx4 v27, s[54:55] offset:-928
 v_mfma_f32_16x16x32_bf16 v[104:107], a[212:215], v[216:219], v[104:107]
 ds_read_b64_tr_b16 a[206:207], v29 offset:38048
 s_add_u32 m0, s64, 4224
 v_mfma_f32_16x16x32_bf16 v[108:111], a[216:219], v[212:215], v[108:111]
 ds_read_b64_tr_b16 a[208:209], v30 offset:33792
 v_cvt_pk_bf16_f32 v195, v138, v139
 v_mfma_f32_16x16x32_bf16 v[112:115], a[216:219], v[216:219], v[112:115]
 ds_read_b64_tr_b16 a[210:211], v30 offset:38016
 global_load_lds_dwordx4 v24, s[54:55] offset:0
 v_mfma_f32_16x16x32_bf16 v[116:119], a[220:223], v[212:215], v[116:119]
 ds_read_b64_tr_b16 a[212:213], v30 offset:33824
 v_cvt_pk_bf16_f32 v208, v160, v161
 v_mfma_f32_16x16x32_bf16 v[120:123], a[220:223], v[216:219], v[120:123]
 ds_read_b64_tr_b16 a[214:215], v30 offset:38048
 s_waitcnt lgkmcnt(4)
 v_mfma_f32_16x16x32_bf16 v[60:63], a[192:195], v[188:191], v[60:63]
 ds_read_b64_tr_b16 a[216:217], v31 offset:33792
 global_load_lds_dwordx4 v25, s[54:55] offset:1056
 v_cvt_pk_bf16_f32 v201, v146, v147
 v_mfma_f32_16x16x32_bf16 v[64:67], a[192:195], v[192:195], v[64:67]
 ds_read_b64_tr_b16 a[218:219], v31 offset:38016
 v_cvt_pk_bf16_f32 v212, v172, v173
 v_mfma_f32_16x16x32_bf16 v[68:71], a[196:199], v[188:191], v[68:71]
 ds_read_b64_tr_b16 a[220:221], v31 offset:33824
 v_cvt_pk_bf16_f32 v209, v162, v163
 v_mfma_f32_16x16x32_bf16 v[72:75], a[196:199], v[192:195], v[72:75]
 ds_read_b64_tr_b16 a[222:223], v31 offset:38048
 global_load_lds_dwordx4 v26, s[54:55] offset:2112
 s_waitcnt vmcnt(11)
 v_mfma_f32_16x16x32_bf16 v[76:79], a[200:203], v[188:191], v[76:79]
 ds_read_b64_tr_b16 a[192:193], v36 offset:8704
 v_cvt_pk_bf16_f32 v198, v148, v149
 v_mfma_f32_16x16x32_bf16 v[80:83], a[200:203], v[192:195], v[80:83]
 ds_read_b64_tr_b16 a[194:195], v36 offset:12928
 v_cvt_pk_bf16_f32 v213, v174, v175
 v_mfma_f32_16x16x32_bf16 v[84:87], a[204:207], v[188:191], v[84:87]
 ds_read_b64_tr_b16 a[196:197], v36 offset:8736
 global_load_lds_dwordx4 v27, s[54:55] offset:3168
 v_mfma_f32_16x16x32_bf16 v[88:91], a[204:207], v[192:195], v[88:91]
 ds_read_b64_tr_b16 a[198:199], v36 offset:12960
 s_add_u32 m0, s63, 0
 s_waitcnt lgkmcnt(4)
 v_mfma_f32_16x16x32_bf16 v[92:95], a[208:211], v[188:191], v[92:95]
 ds_read_b64_tr_b16 a[200:201], v37 offset:8704
 v_cvt_pk_bf16_f32 v206, v164, v165
 v_mfma_f32_16x16x32_bf16 v[96:99], a[208:211], v[192:195], v[96:99]
 ds_read_b64_tr_b16 a[202:203], v37 offset:12928
 global_load_lds_dwordx4 v20, s[26:27] offset:0
 v_mfma_f32_16x16x32_bf16 v[100:103], a[212:215], v[188:191], v[100:103]
 ds_read_b64_tr_b16 a[204:205], v37 offset:8736
 v_cvt_pk_bf16_f32 v199, v150, v151
 v_mfma_f32_16x16x32_bf16 v[104:107], a[212:215], v[192:195], v[104:107]
 ds_read_b64_tr_b16 a[206:207], v37 offset:12960
 v_cvt_pk_bf16_f32 v216, v176, v177
 v_mfma_f32_16x16x32_bf16 v[108:111], a[216:219], v[188:191], v[108:111]
 ds_read_b64_tr_b16 a[208:209], v38 offset:8704
 global_load_lds_dwordx4 v21, s[26:27] offset:1056
 v_mfma_f32_16x16x32_bf16 v[112:115], a[216:219], v[192:195], v[112:115]
 ds_read_b64_tr_b16 a[210:211], v38 offset:12928
 v_cvt_pk_bf16_f32 v207, v166, v167
 v_mfma_f32_16x16x32_bf16 v[116:119], a[220:223], v[188:191], v[116:119]
 ds_read_b64_tr_b16 a[212:213], v38 offset:8736
 v_cvt_pk_bf16_f32 v217, v178, v179
 v_mfma_f32_16x16x32_bf16 v[120:123], a[220:223], v[192:195], v[120:123]
 ds_read_b64_tr_b16 a[214:215], v38 offset:12960
 buffer_load_dword v43, v41, s[32:35], s73 offen offset:4 sc1
 v_cvt_pk_bf16_f32 v202, v152, v153
 s_waitcnt lgkmcnt(4)
 v_mfma_f32_16x16x32_bf16 v[124:127], a[192:195], v[52:55], 0
 ds_read_b64_tr_b16 a[216:217], v39 offset:8704
 v_cvt_pk_bf16_f32 v214, v180, v181
 v_mfma_f32_16x16x32_bf16 v[128:131], a[192:195], v[56:59], 0
 ds_read_b64_tr_b16 a[218:219], v39 offset:12928
 v_cvt_pk_bf16_f32 v210, v168, v169
 v_mfma_f32_16x16x32_bf16 v[132:135], a[196:199], v[52:55], 0
 ds_read_b64_tr_b16 a[220:221], v39 offset:8736
 global_load_lds_dwordx4 v22, s[26:27] offset:2112
 v_mfma_f32_16x16x32_bf16 v[136:139], a[196:199], v[56:59], 0
 ds_read_b64_tr_b16 a[222:223], v39 offset:12960
 v_cvt_pk_bf16_f32 v203, v154, v155
 v_mfma_f32_16x16x32_bf16 v[140:143], a[200:203], v[52:55], 0
 ds_read_b64_tr_b16 a[192:193], v28 offset:42240
 v_cvt_pk_bf16_f32 v215, v182, v183
 v_mfma_f32_16x16x32_bf16 v[144:147], a[200:203], v[56:59], 0
 ds_read_b64_tr_b16 a[194:195], v28 offset:46464
 global_load_lds_dwordx4 v23, s[26:27] offset:3168
 v_mfma_f32_16x16x32_bf16 v[148:151], a[204:207], v[52:55], 0
 ds_read_b64_tr_b16 a[196:197], v28 offset:42272
 v_cvt_pk_bf16_f32 v211, v170, v171
 v_mfma_f32_16x16x32_bf16 v[152:155], a[204:207], v[56:59], 0
 ds_read_b64_tr_b16 a[198:199], v28 offset:46496
 s_waitcnt lgkmcnt(4)
 v_mfma_f32_16x16x32_bf16 v[156:159], a[208:211], v[52:55], 0
 ds_read_b64_tr_b16 a[200:201], v29 offset:42240
 v_cvt_pk_bf16_f32 v218, v184, v185
 v_mfma_f32_16x16x32_bf16 v[160:163], a[208:211], v[56:59], 0
 ds_read_b64_tr_b16 a[202:203], v29 offset:46464
 v_cvt_pk_bf16_f32 v219, v186, v187
 v_mfma_f32_16x16x32_bf16 v[164:167], a[212:215], v[52:55], 0
 ds_read_b64_tr_b16 a[204:205], v29 offset:42272
 v_cvt_pk_bf16_f32 v4, v124, v125
 v_mfma_f32_16x16x32_bf16 v[168:171], a[212:215], v[56:59], 0
 ds_read_b64_tr_b16 a[206:207], v29 offset:46496
 v_cvt_pk_bf16_f32 v5, v126, v127
 v_mfma_f32_16x16x32_bf16 v[172:175], a[216:219], v[52:55], 0
 ds_read_b64_tr_b16 a[208:209], v30 offset:42240
 v_cvt_pk_bf16_f32 v12, v140, v141
 v_mfma_f32_16x16x32_bf16 v[176:179], a[216:219], v[56:59], 0
 ds_read_b64_tr_b16 a[210:211], v30 offset:46464
 v_cvt_pk_bf16_f32 v13, v142, v143
 v_mfma_f32_16x16x32_bf16 v[180:183], a[220:223], v[52:55], 0
 ds_read_b64_tr_b16 a[212:213], v30 offset:42272
 v_cvt_pk_bf16_f32 v8, v128, v129
 v_mfma_f32_16x16x32_bf16 v[184:187], a[220:223], v[56:59], 0
 ds_read_b64_tr_b16 a[214:215], v30 offset:46496
 s_waitcnt lgkmcnt(4)
 v_mfma_f32_16x16x32_bf16 v[60:63], a[192:195], v[196:199], v[60:63]
 ds_read_b64_tr_b16 a[216:217], v31 offset:42240
 s_add_u32 m0, s64, 12800
 v_mfma_f32_16x16x32_bf16 v[64:67], a[192:195], v[200:203], v[64:67]
 ds_read_b64_tr_b16 a[218:219], v31 offset:46464
 global_load_lds_dwordx4 v24, s[52:53] offset:-4096
 v_mfma_f32_16x16x32_bf16 v[68:71], a[196:199], v[196:199], v[68:71]
 ds_read_b64_tr_b16 a[220:221], v31 offset:42272
 v_cvt_pk_bf16_f32 v0, v156, v157
 v_mfma_f32_16x16x32_bf16 v[72:75], a[196:199], v[200:203], v[72:75]
 ds_read_b64_tr_b16 a[222:223], v31 offset:46496
 s_barrier
 v_mfma_f32_16x16x32_bf16 v[76:79], a[200:203], v[196:199], v[76:79]
 ds_read_b64_tr_b16 a[192:193], v32 offset:0
 global_load_lds_dwordx4 v25, s[52:53] offset:-3040
 v_mfma_f32_16x16x32_bf16 v[80:83], a[200:203], v[200:203], v[80:83]
 ds_read_b64_tr_b16 a[194:195], v32 offset:4224
 v_cvt_pk_bf16_f32 v52, v172, v173
 v_mfma_f32_16x16x32_bf16 v[84:87], a[204:207], v[196:199], v[84:87]
 ds_read_b64_tr_b16 a[196:197], v32 offset:32
 v_cvt_pk_bf16_f32 v1, v158, v159
 v_mfma_f32_16x16x32_bf16 v[88:91], a[204:207], v[200:203], v[88:91]
 ds_read_b64_tr_b16 a[198:199], v32 offset:4256
 global_load_lds_dwordx4 v26, s[52:53] offset:-1984
 s_waitcnt lgkmcnt(4)
 v_mfma_f32_16x16x32_bf16 v[92:95], a[208:211], v[196:199], v[92:95]
 ds_read_b64_tr_b16 a[200:201], v33 offset:0
 v_cvt_pk_bf16_f32 v9, v130, v131
 v_mfma_f32_16x16x32_bf16 v[96:99], a[208:211], v[200:203], v[96:99]
 ds_read_b64_tr_b16 a[202:203], v33 offset:4224
 v_cvt_pk_bf16_f32 v16, v144, v145
 v_mfma_f32_16x16x32_bf16 v[100:103], a[212:215], v[196:199], v[100:103]
 ds_read_b64_tr_b16 a[204:205], v33 offset:32
 global_load_lds_dwordx4 v27, s[52:53] offset:-928
 v_mfma_f32_16x16x32_bf16 v[104:107], a[212:215], v[200:203], v[104:107]
 ds_read_b64_tr_b16 a[206:207], v33 offset:4256
 s_add_u32 m0, s64, 12928
 v_mfma_f32_16x16x32_bf16 v[108:111], a[216:219], v[196:199], v[108:111]
 ds_read_b64_tr_b16 a[208:209], v34 offset:0
 v_cvt_pk_bf16_f32 v6, v132, v133
 v_mfma_f32_16x16x32_bf16 v[112:115], a[216:219], v[200:203], v[112:115]
 ds_read_b64_tr_b16 a[210:211], v34 offset:4224
 global_load_lds_dwordx4 v24, s[52:53] offset:0
 v_mfma_f32_16x16x32_bf16 v[116:119], a[220:223], v[196:199], v[116:119]
 ds_read_b64_tr_b16 a[212:213], v34 offset:32
 v_cvt_pk_bf16_f32 v252, v160, v161
 v_mfma_f32_16x16x32_bf16 v[120:123], a[220:223], v[200:203], v[120:123]
 ds_read_b64_tr_b16 a[214:215], v34 offset:4256
 s_waitcnt lgkmcnt(4)
 v_mfma_f32_16x16x32_bf16 v[60:63], a[192:195], v[204:207], v[60:63]
 ds_read_b64_tr_b16 a[216:217], v35 offset:0
 global_load_lds_dwordx4 v25, s[52:53] offset:1056
 v_mfma_f32_16x16x32_bf16 v[64:67], a[192:195], v[208:211], v[64:67]
 ds_read_b64_tr_b16 a[218:219], v35 offset:4224
 v_cvt_pk_bf16_f32 v53, v174, v175
 v_mfma_f32_16x16x32_bf16 v[68:71], a[196:199], v[204:207], v[68:71]
 ds_read_b64_tr_b16 a[220:221], v35 offset:32
 v_cvt_pk_bf16_f32 v17, v146, v147
 v_mfma_f32_16x16x32_bf16 v[72:75], a[196:199], v[208:211], v[72:75]
 ds_read_b64_tr_b16 a[222:223], v35 offset:4256
 global_load_lds_dwordx4 v26, s[52:53] offset:2112
 v_mfma_f32_16x16x32_bf16 v[76:79], a[200:203], v[204:207], v[76:79]
 ds_read_b64_tr_b16 a[192:193], v32 offset:8448
 v_cvt_pk_bf16_f32 v7, v134, v135
 v_mfma_f32_16x16x32_bf16 v[80:83], a[200:203], v[208:211], v[80:83]
 ds_read_b64_tr_b16 a[194:195], v32 offset:12672
 v_cvt_pk_bf16_f32 v14, v148, v149
 v_mfma_f32_16x16x32_bf16 v[84:87], a[204:207], v[204:207], v[84:87]
 ds_read_b64_tr_b16 a[196:197], v32 offset:8480
 global_load_lds_dwordx4 v27, s[52:53] offset:3168
 v_mfma_f32_16x16x32_bf16 v[88:91], a[204:207], v[208:211], v[88:91]
 ds_read_b64_tr_b16 a[198:199], v32 offset:12704
 s_waitcnt vmcnt(10)
 v_cmp_ne_u32 vcc, 1, v43
 s_cbranch_vccnz L_slow1b
L_back1b:
 s_waitcnt lgkmcnt(4)
 v_mfma_f32_16x16x32_bf16 v[92:95], a[208:211], v[204:207], v[92:95]
 ds_read_b64_tr_b16 a[200:201], v33 offset:8448
 s_xor_b32 s66, s72, 0x6000
 v_mfma_f32_16x16x32_bf16 v[96:99], a[208:211], v[208:211], v[96:99]
 ds_read_b64_tr_b16 a[202:203], v33 offset:12672
 s_add_u32 s86, s32, s66
L_pad1_2781:
 s_cbranch_execz L_pad1_3770
 s_addc_u32 s87, s33, 0
 v_mfma_f32_16x16x32_bf16 v[100:103], a[212:215], v[204:207], v[100:103]
 ds_read_b64_tr_b16 a[204:205], v33 offset:8480
 global_load_dwordx4 a[128:131], v40, s[86:87] offset:0 sc1
 v_mfma_f32_16x16x32_bf16 v[104:107], a[212:215], v[208:211], v[104:107]
 ds_read_b64_tr_b16 a[206:207], v33 offset:12704
 v_cvt_pk_bf16_f32 v253, v162, v163
 v_mfma_f32_16x16x32_bf16 v[108:111], a[216:219], v[204:207], v[108:111]
 ds_read_b64_tr_b16 a[208:209], v34 offset:8448
 v_accvgpr_write_b32 a224, -1
 v_mfma_f32_16x16x32_bf16 v[112:115], a[216:219], v[208:211], v[112:115]
 ds_read_b64_tr_b16 a[210:211], v34 offset:12672
 global_load_dwordx4 a[132:135], v40, s[86:87] offset:1024 sc1
 v_mfma_f32_16x16x32_bf16 v[116:119], a[220:223], v[204:207], v[116:119]
 ds_read_b64_tr_b16 a[212:213], v34 offset:8480
 s_add_u32 m0, s63, 16896
 v_mfma_f32_16x16x32_bf16 v[120:123], a[220:223], v[208:211], v[120:123]
 ds_read_b64_tr_b16 a[214:215], v34 offset:12704
 s_waitcnt lgkmcnt(4)
 v_mfma_f32_16x16x32_bf16 v[60:63], a[192:195], v[212:215], v[60:63]
 ds_read_b64_tr_b16 a[216:217], v35 offset:8448
 global_load_lds_dwordx4 v20, s[22:23] offset:0
 v_mfma_f32_16x16x32_bf16 v[64:67], a[192:195], v[216:219], v[64:67]
 ds_read_b64_tr_b16 a[218:219], v35 offset:12672
 v_cvt_pk_bf16_f32 v56, v176, v177
 v_mfma_f32_16x16x32_bf16 v[68:71], a[196:199], v[212:215], v[68:71]
 ds_read_b64_tr_b16 a[220:221], v35 offset:8480
 v_cvt_pk_bf16_f32 v10, v136, v137
 v_mfma_f32_16x16x32_bf16 v[72:75], a[196:199], v[216:219], v[72:75]
 ds_read_b64_tr_b16 a[222:223], v35 offset:12704
 global_load_lds_dwordx4 v21, s[22:23] offset:1056
 s_barrier
 v_mfma_f32_16x16x32_bf16 v[76:79], a[200:203], v[212:215], v[76:79]
 ds_read_b64_tr_b16 a[192:193], v33 offset:16896
 ds_read_b64_tr_b16 a[0:1], v32 offset:16896
 v_mfma_f32_16x16x32_bf16 v[80:83], a[200:203], v[216:219], v[80:83]
 ds_read_b64_tr_b16 a[194:195], v33 offset:21120
 ds_read_b64_tr_b16 a[2:3], v32 offset:21120
 v_mfma_f32_16x16x32_bf16 v[84:87], a[204:207], v[212:215], v[84:87]
 ds_read_b64_tr_b16 a[196:197], v33 offset:16928
 global_load_lds_dwordx4 v22, s[22:23] offset:2112
 v_mfma_f32_16x16x32_bf16 v[88:91], a[204:207], v[216:219], v[88:91]
 ds_read_b64_tr_b16 a[198:199], v33 offset:21152
 s_waitcnt lgkmcnt(6)
 v_mfma_f32_16x16x32_bf16 v[92:95], a[208:211], v[212:215], v[92:95]
 ds_read_b64_tr_b16 a[200:201], v34 offset:16896
 v_cvt_pk_bf16_f32 v15, v150, v151
 v_mfma_f32_16x16x32_bf16 v[96:99], a[208:211], v[216:219], v[96:99]
 ds_read_b64_tr_b16 a[202:203], v34 offset:21120
 global_load_lds_dwordx4 v23, s[22:23] offset:3168
 v_mfma_f32_16x16x32_bf16 v[100:103], a[212:215], v[212:215], v[100:103]
 ds_read_b64_tr_b16 a[204:205], v34 offset:16928
 v_cvt_pk_bf16_f32 v2, v164, v165
 v_mfma_f32_16x16x32_bf16 v[104:107], a[212:215], v[216:219], v[104:107]
 ds_read_b64_tr_b16 a[206:207], v34 offset:21152
 ds_read_b64_tr_b16 a[4:5], v32 offset:16928
 v_mfma_f32_16x16x32_bf16 v[108:111], a[216:219], v[212:215], v[108:111]
 ds_read_b64_tr_b16 a[208:209], v35 offset:16896
 s_add_u32 m0, s63, 33792
 v_mfma_f32_16x16x32_bf16 v[112:115], a[216:219], v[216:219], v[112:115]
 ds_read_b64_tr_b16 a[210:211], v35 offset:21120
 global_load_lds_dwordx4 v20, s[18:19] offset:0
 v_mfma_f32_16x16x32_bf16 v[116:119], a[220:223], v[212:215], v[116:119]
 ds_read_b64_tr_b16 a[212:213], v35 offset:16928
 v_cvt_pk_bf16_f32 v11, v138, v139
 v_mfma_f32_16x16x32_bf16 v[120:123], a[220:223], v[216:219], v[120:123]
 ds_read_b64_tr_b16 a[214:215], v35 offset:21152
 ds_read_b64_tr_b16 a[6:7], v32 offset:21152
 s_waitcnt lgkmcnt(6)
 v_mfma_f32_16x16x32_bf16 v[76:79], a[192:195], v[4:7], v[76:79]
 ds_read_b64_tr_b16 a[216:217], v33 offset:25344
 global_load_lds_dwordx4 v21, s[18:19] offset:1056
 v_mfma_f32_16x16x32_bf16 v[80:83], a[192:195], v[8:11], v[80:83]
 ds_read_b64_tr_b16 a[218:219], v33 offset:29568
 ds_read_b64_tr_b16 a[8:9], v32 offset:25344
 v_mfma_f32_16x16x32_bf16 v[84:87], a[196:199], v[4:7], v[84:87]
 ds_read_b64_tr_b16 a[220:221], v33 offset:25376
 v_cvt_pk_bf16_f32 v57, v178, v179
 v_mfma_f32_16x16x32_bf16 v[88:91], a[196:199], v[8:11], v[88:91]
 ds_read_b64_tr_b16 a[222:223], v33 offset:29600
 global_load_lds_dwordx4 v22, s[18:19] offset:2112
 v_cvt_pk_bf16_f32 v18, v152, v153
 v_mfma_f32_16x16x32_bf16 v[92:95], a[200:203], v[4:7], v[92:95]
 ds_read_b64_tr_b16 a[192:193], v34 offset:25344
 ds_read_b64_tr_b16 a[10:11], v32 offset:29568
 v_mfma_f32_16x16x32_bf16 v[96:99], a[200:203], v[8:11], v[96:99]
 ds_read_b64_tr_b16 a[194:195], v34 offset:29568
 v_cvt_pk_bf16_f32 v3, v166, v167
 v_mfma_f32_16x16x32_bf16 v[100:103], a[204:207], v[4:7], v[100:103]
 ds_read_b64_tr_b16 a[196:197], v34 offset:25376
 ds_read_b64_tr_b16 a[12:13], v32 offset:25376
 v_mfma_f32_16x16x32_bf16 v[104:107], a[204:207], v[8:11], v[104:107]
 ds_read_b64_tr_b16 a[198:199], v34 offset:29600
 global_load_lds_dwordx4 v23, s[18:19] offset:3168
 s_waitcnt lgkmcnt(6)
 v_mfma_f32_16x16x32_bf16 v[108:111], a[208:211], v[4:7], v[108:111]
 ds_read_b64_tr_b16 a[200:201], v35 offset:25344
 ds_read_b64_tr_b16 a[14:15], v32 offset:29600
 v_mfma_f32_16x16x32_bf16 v[112:115], a[208:211], v[8:11], v[112:115]
 ds_read_b64_tr_b16 a[202:203], v35 offset:29568
 v_cvt_pk_bf16_f32 v19, v154, v155
 v_mfma_f32_16x16x32_bf16 v[116:119], a[212:215], v[4:7], v[116:119]
 ds_read_b64_tr_b16 a[204:205], v35 offset:25376
 v_cvt_pk_bf16_f32 v54, v180, v181
 v_mfma_f32_16x16x32_bf16 v[120:123], a[212:215], v[8:11], v[120:123]
 ds_read_b64_tr_b16 a[206:207], v35 offset:29600
 s_xor_b32 s66, s72, 0xa000
 s_waitcnt vmcnt(18)
 s_barrier
 v_mfma_f32_16x16x32_bf16 v[76:79], a[216:219], v[12:15], v[76:79]
 ds_read_b64_tr_b16 a[208:209], v29 offset:0
 s_add_u32 s86, s32, s66
 s_addc_u32 s87, s33, 0
 v_mfma_f32_16x16x32_bf16 v[80:83], a[216:219], v[16:19], v[80:83]
 ds_read_b64_tr_b16 a[210:211], v29 offset:4224
 global_load_dwordx4 a[136:139], v40, s[86:87] offset:0 sc1
 v_mfma_f32_16x16x32_bf16 v[84:87], a[220:223], v[12:15], v[84:87]
 ds_read_b64_tr_b16 a[212:213], v29 offset:32
 v_cvt_pk_bf16_f32 v254, v168, v169
 v_mfma_f32_16x16x32_bf16 v[88:91], a[220:223], v[16:19], v[88:91]
 ds_read_b64_tr_b16 a[214:215], v29 offset:4256
 s_waitcnt lgkmcnt(4)
 v_mfma_f32_16x16x32_bf16 v[92:95], a[192:195], v[12:15], v[92:95]
 ds_read_b64_tr_b16 a[216:217], v30 offset:0
 ds_read_b64_tr_b16 a[16:17], v28 offset:0
 v_mfma_f32_16x16x32_bf16 v[96:99], a[192:195], v[16:19], v[96:99]
 ds_read_b64_tr_b16 a[218:219], v30 offset:4224
 ds_read_b64_tr_b16 a[18:19], v28 offset:4224
 v_mfma_f32_16x16x32_bf16 v[100:103], a[196:199], v[12:15], v[100:103]
 ds_read_b64_tr_b16 a[220:221], v30 offset:32
 v_cvt_pk_bf16_f32 v255, v170, v171
 v_mfma_f32_16x16x32_bf16 v[104:107], a[196:199], v[16:19], v[104:107]
 ds_read_b64_tr_b16 a[222:223], v30 offset:4256
 v_cvt_pk_bf16_f32 v55, v182, v183
 v_mfma_f32_16x16x32_bf16 v[108:111], a[200:203], v[12:15], v[108:111]
 ds_read_b64_tr_b16 a[192:193], v31 offset:0
 ds_read_b64_tr_b16 a[20:21], v28 offset:32
 v_mfma_f32_16x16x32_bf16 v[112:115], a[200:203], v[16:19], v[112:115]
 ds_read_b64_tr_b16 a[194:195], v31 offset:4224
 global_load_dwordx4 a[140:143], v40, s[86:87] offset:1024 sc1
 v_mfma_f32_16x16x32_bf16 v[116:119], a[204:207], v[12:15], v[116:119]
 ds_read_b64_tr_b16 a[196:197], v31 offset:32
 s_xor_b32 s66, s72, 0xe000
 v_mfma_f32_16x16x32_bf16 v[120:123], a[204:207], v[16:19], v[120:123]
 ds_read_b64_tr_b16 a[198:199], v31 offset:4256
 s_add_u32 s86, s32, s66
 s_addc_u32 s87, s33, 0
 s_waitcnt lgkmcnt(5)
 v_mfma_f32_16x16x32_bf16 v[76:79], a[208:211], v[0:3], v[76:79]
 ds_read_b64_tr_b16 a[200:201], v36 offset:0
 v_accvgpr_write_b32 a225, -1
 v_mfma_f32_16x16x32_bf16 v[80:83], a[208:211], v[252:255], v[80:83]
 ds_read_b64_tr_b16 a[202:203], v36 offset:4224
 ds_read_b64_tr_b16 a[22:23], v28 offset:4256
 v_mfma_f32_16x16x32_bf16 v[84:87], a[212:215], v[0:3], v[84:87]
 ds_read_b64_tr_b16 a[204:205], v36 offset:32
 global_load_dwordx4 a[144:147], v40, s[86:87] offset:0 sc1
 v_mfma_f32_16x16x32_bf16 v[88:91], a[212:215], v[252:255], v[88:91]
 ds_read_b64_tr_b16 a[206:207], v36 offset:4256
 ds_read_b64_tr_b16 a[24:25], v28 offset:8448
 v_mfma_f32_16x16x32_bf16 v[92:95], a[216:219], v[0:3], v[92:95]
 ds_read_b64_tr_b16 a[208:209], v37 offset:0
 v_cvt_pk_bf16_f32 v58, v184, v185
 v_mfma_f32_16x16x32_bf16 v[96:99], a[216:219], v[252:255], v[96:99]
 ds_read_b64_tr_b16 a[210:211], v37 offset:4224
 ds_read_b64_tr_b16 a[26:27], v28 offset:12672
 v_mfma_f32_16x16x32_bf16 v[100:103], a[220:223], v[0:3], v[100:103]
 ds_read_b64_tr_b16 a[212:213], v37 offset:32
 global_load_dwordx4 a[148:151], v40, s[86:87] offset:1024 sc1
 v_mfma_f32_16x16x32_bf16 v[104:107], a[220:223], v[252:255], v[104:107]
 ds_read_b64_tr_b16 a[214:215], v37 offset:4256
 s_waitcnt lgkmcnt(6)
 v_mfma_f32_16x16x32_bf16 v[108:111], a[192:195], v[0:3], v[108:111]
 ds_read_b64_tr_b16 a[216:217], v38 offset:0
 ds_read_b64_tr_b16 a[28:29], v28 offset:8480
 v_mfma_f32_16x16x32_bf16 v[112:115], a[192:195], v[252:255], v[112:115]
 ds_read_b64_tr_b16 a[218:219], v38 offset:4224
 v_cvt_pk_bf16_f32 v59, v186, v187
 v_mfma_f32_16x16x32_bf16 v[116:119], a[196:199], v[0:3], v[116:119]
 ds_read_b64_tr_b16 a[220:221], v38 offset:32
 s_add_u32 m0, s63, 50688
 v_mfma_f32_16x16x32_bf16 v[120:123], a[196:199], v[252:255], v[120:123]
 ds_read_b64_tr_b16 a[222:223], v38 offset:4256
 global_load_lds_dwordx4 v20, s[14:15] offset:0
 s_waitcnt vmcnt(14)
 v_mfma_f32_16x16x32_bf16 v[124:127], a[200:203], a[128:131], 0
 ds_read_b64_tr_b16 a[192:193], v39 offset:0
 ds_read_b64_tr_b16 a[30:31], v28 offset:12704
 s_waitcnt vmcnt(13)
 v_mfma_f32_16x16x32_bf16 v[128:131], a[200:203], a[132:135], 0
 ds_read_b64_tr_b16 a[194:195], v39 offset:4224
 v_accvgpr_write_b32 a226, -1
 v_mfma_f32_16x16x32_bf16 v[132:135], a[204:207], a[128:131], 0
 ds_read_b64_tr_b16 a[196:197], v39 offset:32
 global_load_lds_dwordx4 v21, s[14:15] offset:1056
 v_mfma_f32_16x16x32_bf16 v[136:139], a[204:207], a[132:135], 0
 ds_read_b64_tr_b16 a[198:199], v39 offset:4256
 s_waitcnt lgkmcnt(5)
 v_mfma_f32_16x16x32_bf16 v[140:143], a[208:211], a[128:131], 0
 ds_read_b64_tr_b16 a[200:201], v29 offset:8448
 v_accvgpr_write_b32 a227, -1
 v_mfma_f32_16x16x32_bf16 v[144:147], a[208:211], a[132:135], 0
 ds_read_b64_tr_b16 a[202:203], v29 offset:12672
 v_mfma_f32_16x16x32_bf16 v[148:151], a[212:215], a[128:131], 0
 ds_read_b64_tr_b16 a[204:205], v29 offset:8480
 global_load_lds_dwordx4 v22, s[14:15] offset:2112
 v_mfma_f32_16x16x32_bf16 v[152:155], a[212:215], a[132:135], 0
 ds_read_b64_tr_b16 a[206:207], v29 offset:12704
 v_mfma_f32_16x16x32_bf16 v[156:159], a[216:219], a[128:131], 0
 ds_read_b64_tr_b16 a[208:209], v30 offset:8448
 v_cvt_pk_bf16_f32 v220, v124, v125
 v_mfma_f32_16x16x32_bf16 v[160:163], a[216:219], a[132:135], 0
 ds_read_b64_tr_b16 a[210:211], v30 offset:12672
 v_cvt_pk_bf16_f32 v221, v126, v127
 v_mfma_f32_16x16x32_bf16 v[164:167], a[220:223], a[128:131], 0
 ds_read_b64_tr_b16 a[212:213], v30 offset:8480
 global_load_lds_dwordx4 v23, s[14:15] offset:3168
 v_mfma_f32_16x16x32_bf16 v[168:171], a[220:223], a[132:135], 0
 ds_read_b64_tr_b16 a[214:215], v30 offset:12704
 s_waitcnt lgkmcnt(4)
 v_mfma_f32_16x16x32_bf16 v[172:175], a[192:195], a[128:131], 0
 ds_read_b64_tr_b16 a[216:217], v31 offset:8448
 v_cvt_pk_bf16_f32 v224, v128, v129
 v_mfma_f32_16x16x32_bf16 v[176:179], a[192:195], a[132:135], 0
 ds_read_b64_tr_b16 a[218:219], v31 offset:12672
 v_cvt_pk_bf16_f32 v228, v140, v141
 v_mfma_f32_16x16x32_bf16 v[180:183], a[196:199], a[128:131], 0
 ds_read_b64_tr_b16 a[220:221], v31 offset:8480
 v_cvt_pk_bf16_f32 v225, v130, v131
 v_mfma_f32_16x16x32_bf16 v[184:187], a[196:199], a[132:135], 0
 ds_read_b64_tr_b16 a[222:223], v31 offset:12704
 s_waitcnt vmcnt(8)
 s_barrier
 v_mfma_f32_16x16x32_bf16 v[76:79], a[200:203], v[52:55], v[76:79]
 ds_read_b64_tr_b16 a[192:193], v29 offset:16896
 s_add_u32 m0, s64, 4096
 v_mfma_f32_16x16x32_bf16 v[80:83], a[200:203], v[56:59], v[80:83]
 ds_read_b64_tr_b16 a[194:195], v29 offset:21120
 global_load_lds_dwordx4 v24, s[50:51] offset:-4096
 v_mfma_f32_16x16x32_bf16 v[84:87], a[204:207], v[52:55], v[84:87]
 ds_read_b64_tr_b16 a[196:197], v29 offset:16928
 v_cvt_pk_bf16_f32 v229, v142, v143
 v_mfma_f32_16x16x32_bf16 v[88:91], a[204:207], v[56:59], v[88:91]
 ds_read_b64_tr_b16 a[198:199], v29 offset:21152
 ds_read_b64_tr_b16 a[32:33], v28 offset:16896
 s_waitcnt lgkmcnt(5)
 v_mfma_f32_16x16x32_bf16 v[92:95], a[208:211], v[52:55], v[92:95]
 ds_read_b64_tr_b16 a[200:201], v30 offset:16896
 global_load_lds_dwordx4 v25, s[50:51] offset:-3040
 v_cvt_pk_bf16_f32 v222, v132, v133
 v_mfma_f32_16x16x32_bf16 v[96:99], a[208:211], v[56:59], v[96:99]
 ds_read_b64_tr_b16 a[202:203], v30 offset:21120
 v_cvt_pk_bf16_f32 v236, v156, v157
 v_mfma_f32_16x16x32_bf16 v[100:103], a[212:215], v[52:55], v[100:103]
 ds_read_b64_tr_b16 a[204:205], v30 offset:16928
 ds_read_b64_tr_b16 a[34:35], v28 offset:21120
 v_cvt_pk_bf16_f32 v223, v134, v135
 v_cvt_pk_bf16_f32 v232, v144, v145
 v_mfma_f32_16x16x32_bf16 v[104:107], a[212:215], v[56:59], v[104:107]
 ds_read_b64_tr_b16 a[206:207], v30 offset:21152
 global_load_lds_dwordx4 v26, s[50:51] offset:-1984
 v_mfma_f32_16x16x32_bf16 v[108:111], a[216:219], v[52:55], v[108:111]
 ds_read_b64_tr_b16 a[208:209], v31 offset:16896
 ds_read_b64_tr_b16 a[48:49], v28 offset:33792
 v_cvt_pk_bf16_f32 v226, v136, v137
 ds_read_b64_tr_b16 a[36:37], v28 offset:16928
 v_mfma_f32_16x16x32_bf16 v[112:115], a[216:219], v[56:59], v[112:115]
L_pad1_3048:
 s_cbranch_execz L_ret1_1
 ds_read_b64_tr_b16 a[210:211], v31 offset:21120
 v_cvt_pk_bf16_f32 v237, v158, v159
 v_cvt_pk_bf16_f32 v233, v146, v147
 v_mfma_f32_16x16x32_bf16 v[116:119], a[220:223], v[52:55], v[116:119]
 ds_read_b64_tr_b16 a[212:213], v31 offset:16928
 global_load_lds_dwordx4 v27, s[50:51] offset:-928
 v_cvt_pk_bf16_f32 v227, v138, v139
 v_mfma_f32_16x16x32_bf16 v[120:123], a[220:223], v[56:59], v[120:123]
 ds_read_b64_tr_b16 a[214:215], v31 offset:21152
 s_add_u32 m0, s64, 4224
 ds_read_b64_tr_b16 a[38:39], v28 offset:21152
 v_cvt_pk_bf16_f32 v244, v172, v173
 s_waitcnt lgkmcnt(7)
 v_mfma_f32_16x16x32_bf16 v[76:79], a[192:195], v[220:223], v[76:79]
 ds_read_b64_tr_b16 a[216:217], v29 offset:25344
 v_cvt_pk_bf16_f32 v230, v148, v149
 v_mfma_f32_16x16x32_bf16 v[80:83], a[192:195], v[224:227], v[80:83]
 ds_read_b64_tr_b16 a[218:219], v29 offset:29568
 global_load_lds_dwordx4 v24, s[50:51] offset:0
 v_cvt_pk_bf16_f32 v240, v160, v161
 v_mfma_f32_16x16x32_bf16 v[84:87], a[196:199], v[220:223], v[84:87]
 ds_read_b64_tr_b16 a[220:221], v29 offset:25376
 ds_read_b64_tr_b16 a[40:41], v28 offset:25344
 v_mfma_f32_16x16x32_bf16 v[88:91], a[196:199], v[224:227], v[88:91]
 ds_read_b64_tr_b16 a[222:223], v29 offset:29600
 ds_read_b64_tr_b16 a[50:51], v28 offset:38016
 v_mfma_f32_16x16x32_bf16 v[92:95], a[200:203], v[220:223], v[92:95]
 ds_read_b64_tr_b16 a[192:193], v30 offset:25344
 global_load_lds_dwordx4 v25, s[50:51] offset:1056
 v_cvt_pk_bf16_f32 v231, v150, v151
 ds_read_b64_tr_b16 a[42:43], v28 offset:29568
 v_mfma_f32_16x16x32_bf16 v[96:99], a[200:203], v[224:227], v[96:99]
 ds_read_b64_tr_b16 a[194:195], v30 offset:29568
 v_cvt_pk_bf16_f32 v241, v162, v163
 v_mfma_f32_16x16x32_bf16 v[100:103], a[204:207], v[220:223], v[100:103]
 ds_read_b64_tr_b16 a[196:197], v30 offset:25376
 v_cvt_pk_bf16_f32 v245, v174, v175
 v_mfma_f32_16x16x32_bf16 v[104:107], a[204:207], v[224:227], v[104:107]
 ds_read_b64_tr_b16 a[198:199], v30 offset:29600
 global_load_lds_dwordx4 v26, s[50:51] offset:2112
 ds_read_b64_tr_b16 a[44:45], v28 offset:25376
 v_cvt_pk_bf16_f32 v234, v152, v153
 s_waitcnt lgkmcnt(7)
 v_mfma_f32_16x16x32_bf16 v[108:111], a[208:211], v[220:223], v[108:111]
 ds_read_b64_tr_b16 a[200:201], v31 offset:25344
 ds_read_b64_tr_b16 a[46:47], v28 offset:29600
 v_mfma_f32_16x16x32_bf16 v[112:115], a[208:211], v[224:227], v[112:115]
 ds_read_b64_tr_b16 a[202:203], v31 offset:29568
 v_cvt_pk_bf16_f32 v238, v164, v165
 v_mfma_f32_16x16x32_bf16 v[116:119], a[212:215], v[220:223], v[116:119]
 ds_read_b64_tr_b16 a[204:205], v31 offset:25376
 global_load_lds_dwordx4 v27, s[50:51] offset:3168
 v_cvt_pk_bf16_f32 v235, v154, v155
 v_mfma_f32_16x16x32_bf16 v[120:123], a[212:215], v[224:227], v[120:123]
 ds_read_b64_tr_b16 a[206:207], v31 offset:29600
 s_add_u32 m0, s63, 67584
 ds_read_b64_tr_b16 a[52:53], v28 offset:33824
 v_mfma_f32_16x16x32_bf16 v[76:79], a[216:219], v[228:231], v[76:79]
 ds_read_b64_tr_b16 a[208:209], v29 offset:33792
 v_cvt_pk_bf16_f32 v248, v176, v177
 v_mfma_f32_16x16x32_bf16 v[80:83], a[216:219], v[232:235], v[80:83]
 ds_read_b64_tr_b16 a[210:211], v29 offset:38016
 global_load_lds_dwordx4 v20, s[10:11] offset:0
 v_mfma_f32_16x16x32_bf16 v[84:87], a[220:223], v[228:231], v[84:87]
 ds_read_b64_tr_b16 a[212:213], v29 offset:33824
 v_cvt_pk_bf16_f32 v239, v166, v167
 v_mfma_f32_16x16x32_bf16 v[88:91], a[220:223], v[232:235], v[88:91]
 ds_read_b64_tr_b16 a[214:215], v29 offset:38048
 s_waitcnt lgkmcnt(5)
 v_mfma_f32_16x16x32_bf16 v[92:95], a[192:195], v[228:231], v[92:95]
 ds_read_b64_tr_b16 a[216:217], v30 offset:33792
 global_load_lds_dwordx4 v21, s[10:11] offset:1056
 v_mfma_f32_16x16x32_bf16 v[96:99], a[192:195], v[232:235], v[96:99]
 ds_read_b64_tr_b16 a[218:219], v30 offset:38016
 v_cvt_pk_bf16_f32 v242, v168, v169
 v_mfma_f32_16x16x32_bf16 v[100:103], a[196:199], v[228:231], v[100:103]
 ds_read_b64_tr_b16 a[220:221], v30 offset:33824
 ds_read_b64_tr_b16 a[54:55], v28 offset:38048
 v_mfma_f32_16x16x32_bf16 v[104:107], a[196:199], v[232:235], v[104:107]
 ds_read_b64_tr_b16 a[222:223], v30 offset:38048
 global_load_lds_dwordx4 v22, s[10:11] offset:2112
 v_mfma_f32_16x16x32_bf16 v[108:111], a[200:203], v[228:231], v[108:111]
 ds_read_b64_tr_b16 a[192:193], v31 offset:33792
 v_cvt_pk_bf16_f32 v249, v178, v179
 v_mfma_f32_16x16x32_bf16 v[112:115], a[200:203], v[232:235], v[112:115]
 ds_read_b64_tr_b16 a[194:195], v31 offset:38016
 v_cvt_pk_bf16_f32 v243, v170, v171
 v_mfma_f32_16x16x32_bf16 v[116:119], a[204:207], v[228:231], v[116:119]
 ds_read_b64_tr_b16 a[196:197], v31 offset:33824
 global_load_lds_dwordx4 v23, s[10:11] offset:3168
 v_mfma_f32_16x16x32_bf16 v[120:123], a[204:207], v[232:235], v[120:123]
 ds_read_b64_tr_b16 a[198:199], v31 offset:38048
 s_waitcnt vmcnt(12)
 s_barrier
 s_waitcnt lgkmcnt(4)
 v_mfma_f32_16x16x32_bf16 v[76:79], a[208:211], v[236:239], v[76:79]
 ds_read_b64_tr_b16 a[200:201], v36 offset:8704
 s_add_u32 m0, s63, 0
 v_mfma_f32_16x16x32_bf16 v[80:83], a[208:211], v[240:243], v[80:83]
 ds_read_b64_tr_b16 a[202:203], v36 offset:12928
 global_load_lds_dwordx4 v20, s[6:7] offset:0
 v_mfma_f32_16x16x32_bf16 v[84:87], a[212:215], v[236:239], v[84:87]
 ds_read_b64_tr_b16 a[204:205], v36 offset:8736
 ds_read_b64_tr_b16 a[56:57], v28 offset:42240
 v_mfma_f32_16x16x32_bf16 v[88:91], a[212:215], v[240:243], v[88:91]
 ds_read_b64_tr_b16 a[206:207], v36 offset:12960
 v_cvt_pk_bf16_f32 v246, v180, v181
 v_mfma_f32_16x16x32_bf16 v[92:95], a[216:219], v[236:239], v[92:95]
 ds_read_b64_tr_b16 a[208:209], v37 offset:8704
 global_load_lds_dwordx4 v21, s[6:7] offset:1056
 v_mfma_f32_16x16x32_bf16 v[96:99], a[216:219], v[240:243], v[96:99]
 ds_read_b64_tr_b16 a[210:211], v37 offset:12928
 v_cvt_pk_bf16_f32 v247, v182, v183
 v_mfma_f32_16x16x32_bf16 v[100:103], a[220:223], v[236:239], v[100:103]
 ds_read_b64_tr_b16 a[212:213], v37 offset:8736
 ds_read_b64_tr_b16 a[58:59], v28 offset:46464
 v_mfma_f32_16x16x32_bf16 v[104:107], a[220:223], v[240:243], v[104:107]
 ds_read_b64_tr_b16 a[214:215], v37 offset:12960
 s_waitcnt lgkmcnt(5)
 v_mfma_f32_16x16x32_bf16 v[108:111], a[192:195], v[236:239], v[108:111]
 ds_read_b64_tr_b16 a[216:217], v38 offset:8704
 global_load_lds_dwordx4 v22, s[6:7] offset:2112
 v_mfma_f32_16x16x32_bf16 v[112:115], a[192:195], v[240:243], v[112:115]
 ds_read_b64_tr_b16 a[218:219], v38 offset:12928
 v_cvt_pk_bf16_f32 v250, v184, v185
 v_mfma_f32_16x16x32_bf16 v[116:119], a[196:199], v[236:239], v[116:119]
 ds_read_b64_tr_b16 a[220:221], v38 offset:8736
 ds_read_b64_tr_b16 a[60:61], v28 offset:42272
 v_mfma_f32_16x16x32_bf16 v[120:123], a[196:199], v[240:243], v[120:123]
 ds_read_b64_tr_b16 a[222:223], v38 offset:12960
 v_cvt_pk_bf16_f32 v251, v186, v187
 v_mfma_f32_16x16x32_bf16 v[124:127], a[200:203], a[136:139], 0
 ds_read_b64_tr_b16 a[192:193], v39 offset:8704
 global_load_lds_dwordx4 v23, s[6:7] offset:3168
 v_mfma_f32_16x16x32_bf16 v[128:131], a[200:203], a[140:143], 0
 ds_read_b64_tr_b16 a[194:195], v39 offset:12928
 ds_read_b64_tr_b16 a[62:63], v28 offset:46496
 v_mfma_f32_16x16x32_bf16 v[132:135], a[204:207], a[136:139], 0
 ds_read_b64_tr_b16 a[196:197], v39 offset:8736
 v_mfma_f32_16x16x32_bf16 v[136:139], a[204:207], a[140:143], 0
 ds_read_b64_tr_b16 a[198:199], v39 offset:12960
 s_waitcnt lgkmcnt(5)
 v_mfma_f32_16x16x32_bf16 v[140:143], a[208:211], a[136:139], 0
 ds_read_b64_tr_b16 a[200:201], v29 offset:42240
 s_add_u32 m0, s63, 16896
 v_mfma_f32_16x16x32_bf16 v[144:147], a[208:211], a[140:143], 0
 ds_read_b64_tr_b16 a[202:203], v29 offset:46464
 global_load_lds_dwordx4 v20, s[0:1] offset:0
 v_mfma_f32_16x16x32_bf16 v[148:151], a[212:215], a[136:139], 0
 ds_read_b64_tr_b16 a[204:205], v29 offset:42272
 v_mfma_f32_16x16x32_bf16 v[152:155], a[212:215], a[140:143], 0
 ds_read_b64_tr_b16 a[206:207], v29 offset:46496
 v_mfma_f32_16x16x32_bf16 v[156:159], a[216:219], a[136:139], 0
 ds_read_b64_tr_b16 a[208:209], v30 offset:42240
 global_load_lds_dwordx4 v21, s[0:1] offset:1056
 v_mfma_f32_16x16x32_bf16 v[160:163], a[216:219], a[140:143], 0
 ds_read_b64_tr_b16 a[210:211], v30 offset:46464
 v_cvt_pk_bf16_f32 v188, v124, v125
 v_mfma_f32_16x16x32_bf16 v[164:167], a[220:223], a[136:139], 0
 ds_read_b64_tr_b16 a[212:213], v30 offset:42272
 v_cvt_pk_bf16_f32 v189, v126, v127
 v_mfma_f32_16x16x32_bf16 v[168:171], a[220:223], a[140:143], 0
 ds_read_b64_tr_b16 a[214:215], v30 offset:46496
 s_waitcnt lgkmcnt(4)
 v_mfma_f32_16x16x32_bf16 v[172:175], a[192:195], a[136:139], 0
 ds_read_b64_tr_b16 a[216:217], v31 offset:42240
 global_load_lds_dwordx4 v22, s[0:1] offset:2112
 v_mfma_f32_16x16x32_bf16 v[176:179], a[192:195], a[140:143], 0
 ds_read_b64_tr_b16 a[218:219], v31 offset:46464
 v_cvt_pk_bf16_f32 v196, v140, v141
 v_mfma_f32_16x16x32_bf16 v[180:183], a[196:199], a[136:139], 0
 ds_read_b64_tr_b16 a[220:221], v31 offset:42272
 v_cvt_pk_bf16_f32 v192, v128, v129
 v_mfma_f32_16x16x32_bf16 v[184:187], a[196:199], a[140:143], 0
 ds_read_b64_tr_b16 a[222:223], v31 offset:46496
 s_waitcnt vmcnt(11)
 v_mfma_f32_16x16x32_bf16 v[76:79], a[200:203], v[244:247], v[76:79]
 ds_read_b64_tr_b16 a[192:193], v36 offset:0
 global_load_lds_dwordx4 v23, s[0:1] offset:3168
 v_mfma_f32_16x16x32_bf16 v[80:83], a[200:203], v[248:251], v[80:83]
 ds_read_b64_tr_b16 a[194:195], v36 offset:4224
 v_cvt_pk_bf16_f32 v197, v142, v143
 v_mfma_f32_16x16x32_bf16 v[84:87], a[204:207], v[244:247], v[84:87]
 ds_read_b64_tr_b16 a[196:197], v36 offset:32
 v_cvt_pk_bf16_f32 v193, v130, v131
 v_mfma_f32_16x16x32_bf16 v[88:91], a[204:207], v[248:251], v[88:91]
 ds_read_b64_tr_b16 a[198:199], v36 offset:4256
 s_xor_b32 s66, s75, 0x10000
 v_cvt_pk_bf16_f32 v204, v156, v157
 s_waitcnt lgkmcnt(4)
 v_mfma_f32_16x16x32_bf16 v[92:95], a[208:211], v[244:247], v[92:95]
 ds_read_b64_tr_b16 a[200:201], v37 offset:0
 s_add_u32 s86, s32, s66
 s_addc_u32 s87, s33, 0
 v_cvt_pk_bf16_f32 v200, v144, v145
 v_cvt_pk_bf16_f32 v190, v132, v133
 v_mfma_f32_16x16x32_bf16 v[96:99], a[208:211], v[248:251], v[96:99]
 ds_read_b64_tr_b16 a[202:203], v37 offset:4224
 global_store_dwordx4 v40, a[224:227], s[86:87] offset:0 sc1
 v_cvt_pk_bf16_f32 v205, v158, v159
 v_mfma_f32_16x16x32_bf16 v[100:103], a[212:215], v[244:247], v[100:103]
 ds_read_b64_tr_b16 a[204:205], v37 offset:32
 v_cvt_pk_bf16_f32 v201, v146, v147
 v_mfma_f32_16x16x32_bf16 v[104:107], a[212:215], v[248:251], v[104:107]
 ds_read_b64_tr_b16 a[206:207], v37 offset:4256
 v_cvt_pk_bf16_f32 v191, v134, v135
 v_cvt_pk_bf16_f32 v212, v172, v173
 v_mfma_f32_16x16x32_bf16 v[108:111], a[216:219], v[244:247], v[108:111]
 ds_read_b64_tr_b16 a[208:209], v38 offset:0
 global_store_dwordx4 v40, a[224:227], s[86:87] offset:1024 sc1
 v_cvt_pk_bf16_f32 v208, v160, v161
 v_cvt_pk_bf16_f32 v198, v148, v149
 v_mfma_f32_16x16x32_bf16 v[112:115], a[216:219], v[248:251], v[112:115]
 ds_read_b64_tr_b16 a[210:211], v38 offset:4224
 s_xor_b32 s66, s75, 0x18000
 v_cvt_pk_bf16_f32 v194, v136, v137
 v_cvt_pk_bf16_f32 v213, v174, v175
 v_mfma_f32_16x16x32_bf16 v[116:119], a[220:223], v[244:247], v[116:119]
 ds_read_b64_tr_b16 a[212:213], v38 offset:32
 s_add_u32 s86, s32, s66
 s_addc_u32 s87, s33, 0
 v_cvt_pk_bf16_f32 v209, v162, v163
 v_mfma_f32_16x16x32_bf16 v[120:123], a[220:223], v[248:251], v[120:123]
 ds_read_b64_tr_b16 a[214:215], v38 offset:4256
 global_store_dwordx4 v40, a[224:227], s[86:87] offset:0 sc1
 v_cvt_pk_bf16_f32 v199, v150, v151
 v_cvt_pk_bf16_f32 v195, v138, v139
 s_waitcnt lgkmcnt(4)
 v_mfma_f32_16x16x32_bf16 v[124:127], a[192:195], a[144:147], 0
 ds_read_b64_tr_b16 a[216:217], v39 offset:0
 v_cvt_pk_bf16_f32 v216, v176, v177
 v_cvt_pk_bf16_f32 v206, v164, v165
 v_mfma_f32_16x16x32_bf16 v[128:131], a[192:195], a[148:151], 0
 ds_read_b64_tr_b16 a[218:219], v39 offset:4224
 v_cvt_pk_bf16_f32 v202, v152, v153
 v_mfma_f32_16x16x32_bf16 v[132:135], a[196:199], a[144:147], 0
 ds_read_b64_tr_b16 a[220:221], v39 offset:32
 global_store_dwordx4 v40, a[224:227], s[86:87] offset:1024 sc1
 v_cvt_pk_bf16_f32 v217, v178, v179
 v_mfma_f32_16x16x32_bf16 v[136:139], a[196:199], a[148:151], 0
 ds_read_b64_tr_b16 a[222:223], v39 offset:4256
 v_cvt_pk_bf16_f32 v207, v166, v167
 v_cvt_pk_bf16_f32 v203, v154, v155
 s_waitcnt vmcnt(8)
 s_barrier
 v_mfma_f32_16x16x32_bf16 v[140:143], a[200:203], a[144:147], 0
 ds_read_b64_tr_b16 a[192:193], v33 offset:0
 v_cvt_pk_bf16_f32 v214, v180, v181
 v_mfma_f32_16x16x32_bf16 v[144:147], a[200:203], a[148:151], 0
 ds_read_b64_tr_b16 a[194:195], v33 offset:4224
 v_cvt_pk_bf16_f32 v210, v168, v169
 v_mfma_f32_16x16x32_bf16 v[148:151], a[204:207], a[144:147], 0
 ds_read_b64_tr_b16 a[196:197], v33 offset:32
 v_cvt_pk_bf16_f32 v215, v182, v183
 v_mfma_f32_16x16x32_bf16 v[152:155], a[204:207], a[148:151], 0
 ds_read_b64_tr_b16 a[198:199], v33 offset:4256
 v_cvt_pk_bf16_f32 v211, v170, v171
 s_waitcnt lgkmcnt(4)
 v_mfma_f32_16x16x32_bf16 v[156:159], a[208:211], a[144:147], 0
 ds_read_b64_tr_b16 a[200:201], v33 offset:8448
 v_cvt_pk_bf16_f32 v218, v184, v185
 v_mfma_f32_16x16x32_bf16 v[160:163], a[208:211], a[148:151], 0
 ds_read_b64_tr_b16 a[202:203], v33 offset:12672
 v_cvt_pk_bf16_f32 v124, v124, v125
 v_mfma_f32_16x16x32_bf16 v[164:167], a[212:215], a[144:147], 0
L_pad1_3313:
 s_cbranch_execz L_ret1_1
 ds_read_b64_tr_b16 a[204:205], v33 offset:8480
 v_cvt_pk_bf16_f32 v125, v126, v127
 v_mfma_f32_16x16x32_bf16 v[168:171], a[212:215], a[148:151], 0
 ds_read_b64_tr_b16 a[206:207], v33 offset:12704
 v_cvt_pk_bf16_f32 v219, v186, v187
 v_mfma_f32_16x16x32_bf16 v[172:175], a[216:219], a[144:147], 0
 ds_read_b64_tr_b16 a[208:209], v33 offset:16896
 v_cvt_pk_bf16_f32 v126, v132, v133
 v_mfma_f32_16x16x32_bf16 v[176:179], a[216:219], a[148:151], 0
 ds_read_b64_tr_b16 a[210:211], v33 offset:21120
 v_cvt_pk_bf16_f32 v127, v134, v135
 v_mfma_f32_16x16x32_bf16 v[180:183], a[220:223], a[144:147], 0
 ds_read_b64_tr_b16 a[212:213], v33 offset:16928
 v_cvt_pk_bf16_f32 v128, v128, v129
 v_mfma_f32_16x16x32_bf16 v[184:187], a[220:223], a[148:151], 0
 ds_read_b64_tr_b16 a[214:215], v33 offset:21152
 s_waitcnt lgkmcnt(4)
 v_mfma_f32_16x16x32_bf16 v[76:79], a[192:195], v[188:191], v[76:79]
 ds_read_b64_tr_b16 a[216:217], v33 offset:25344
 v_cvt_pk_bf16_f32 v129, v130, v131
 v_mfma_f32_16x16x32_bf16 v[80:83], a[192:195], v[192:195], v[80:83]
 ds_read_b64_tr_b16 a[218:219], v33 offset:29568
 v_cvt_pk_bf16_f32 v130, v136, v137
 v_mfma_f32_16x16x32_bf16 v[84:87], a[196:199], v[188:191], v[84:87]
 ds_read_b64_tr_b16 a[220:221], v33 offset:25376
 v_cvt_pk_bf16_f32 v131, v138, v139
 v_mfma_f32_16x16x32_bf16 v[88:91], a[196:199], v[192:195], v[88:91]
 ds_read_b64_tr_b16 a[222:223], v33 offset:29600
 v_cvt_pk_bf16_f32 v132, v140, v141
 v_mfma_f32_16x16x32_bf16 v[76:79], a[200:203], v[196:199], v[76:79]
 ds_read_b64_tr_b16 a[192:193], v29 offset:0
 v_cvt_pk_bf16_f32 v133, v142, v143
 v_mfma_f32_16x16x32_bf16 v[80:83], a[200:203], v[200:203], v[80:83]
 ds_read_b64_tr_b16 a[194:195], v29 offset:4224
 v_cvt_pk_bf16_f32 v134, v148, v149
 v_mfma_f32_16x16x32_bf16 v[84:87], a[204:207], v[196:199], v[84:87]
 ds_read_b64_tr_b16 a[196:197], v29 offset:32
 v_cvt_pk_bf16_f32 v135, v150, v151
 v_mfma_f32_16x16x32_bf16 v[88:91], a[204:207], v[200:203], v[88:91]
 ds_read_b64_tr_b16 a[198:199], v29 offset:4256
 v_cvt_pk_bf16_f32 v136, v144, v145
 s_waitcnt lgkmcnt(4)
 v_mfma_f32_16x16x32_bf16 v[76:79], a[208:211], v[204:207], v[76:79]
 ds_read_b64_tr_b16 a[200:201], v29 offset:8448
 v_cvt_pk_bf16_f32 v137, v146, v147
 v_mfma_f32_16x16x32_bf16 v[80:83], a[208:211], v[208:211], v[80:83]
 ds_read_b64_tr_b16 a[202:203], v29 offset:12672
 v_cvt_pk_bf16_f32 v138, v152, v153
 v_mfma_f32_16x16x32_bf16 v[84:87], a[212:215], v[204:207], v[84:87]
 ds_read_b64_tr_b16 a[204:205], v29 offset:8480
 v_cvt_pk_bf16_f32 v139, v154, v155
 v_mfma_f32_16x16x32_bf16 v[88:91], a[212:215], v[208:211], v[88:91]
 ds_read_b64_tr_b16 a[206:207], v29 offset:12704
 v_cvt_pk_bf16_f32 v140, v156, v157
 s_waitcnt vmcnt(4)
 s_barrier
 v_mfma_f32_16x16x32_bf16 v[76:79], a[216:219], v[212:215], v[76:79]
 ds_read_b64_tr_b16 a[208:209], v29 offset:16896
 v_cvt_pk_bf16_f32 v141, v158, v159
 v_mfma_f32_16x16x32_bf16 v[80:83], a[216:219], v[216:219], v[80:83]
 ds_read_b64_tr_b16 a[210:211], v29 offset:21120
 v_cvt_pk_bf16_f32 v142, v164, v165
 v_mfma_f32_16x16x32_bf16 v[84:87], a[220:223], v[212:215], v[84:87]
 ds_read_b64_tr_b16 a[212:213], v29 offset:16928
 v_cvt_pk_bf16_f32 v143, v166, v167
 v_mfma_f32_16x16x32_bf16 v[88:91], a[220:223], v[216:219], v[88:91]
 ds_read_b64_tr_b16 a[214:215], v29 offset:21152
 v_cvt_pk_bf16_f32 v144, v160, v161
 s_waitcnt lgkmcnt(4)
 v_mfma_f32_16x16x32_bf16 v[76:79], a[192:195], v[124:127], v[76:79]
 ds_read_b64_tr_b16 a[216:217], v29 offset:25344
 v_cvt_pk_bf16_f32 v145, v162, v163
 v_mfma_f32_16x16x32_bf16 v[80:83], a[192:195], v[128:131], v[80:83]
 ds_read_b64_tr_b16 a[218:219], v29 offset:29568
 v_cvt_pk_bf16_f32 v146, v168, v169
 v_mfma_f32_16x16x32_bf16 v[84:87], a[196:199], v[124:127], v[84:87]
 ds_read_b64_tr_b16 a[220:221], v29 offset:25376
 v_cvt_pk_bf16_f32 v147, v170, v171
 v_mfma_f32_16x16x32_bf16 v[88:91], a[196:199], v[128:131], v[88:91]
 ds_read_b64_tr_b16 a[222:223], v29 offset:29600
 v_cvt_pk_bf16_f32 v148, v172, v173
 v_mfma_f32_16x16x32_bf16 v[76:79], a[200:203], v[132:135], v[76:79]
 ds_read_b64_tr_b16 a[192:193], v34 offset:0
 v_cvt_pk_bf16_f32 v149, v174, v175
 v_mfma_f32_16x16x32_bf16 v[80:83], a[200:203], v[136:139], v[80:83]
 ds_read_b64_tr_b16 a[194:195], v34 offset:4224
 v_cvt_pk_bf16_f32 v150, v180, v181
 v_mfma_f32_16x16x32_bf16 v[84:87], a[204:207], v[132:135], v[84:87]
 ds_read_b64_tr_b16 a[196:197], v34 offset:32
 v_cvt_pk_bf16_f32 v151, v182, v183
 v_mfma_f32_16x16x32_bf16 v[88:91], a[204:207], v[136:139], v[88:91]
 ds_read_b64_tr_b16 a[198:199], v34 offset:4256
 v_cvt_pk_bf16_f32 v152, v176, v177
 s_waitcnt lgkmcnt(4)
 v_mfma_f32_16x16x32_bf16 v[76:79], a[208:211], v[140:143], v[76:79]
 ds_read_b64_tr_b16 a[200:201], v34 offset:8448
 v_cvt_pk_bf16_f32 v153, v178, v179
 v_mfma_f32_16x16x32_bf16 v[80:83], a[208:211], v[144:147], v[80:83]
 ds_read_b64_tr_b16 a[202:203], v34 offset:12672
 v_cvt_pk_bf16_f32 v154, v184, v185
 v_mfma_f32_16x16x32_bf16 v[84:87], a[212:215], v[140:143], v[84:87]
 ds_read_b64_tr_b16 a[204:205], v34 offset:8480
 v_cvt_pk_bf16_f32 v155, v186, v187
 v_mfma_f32_16x16x32_bf16 v[88:91], a[212:215], v[144:147], v[88:91]
 ds_read_b64_tr_b16 a[206:207], v34 offset:12704
 v_mfma_f32_16x16x32_bf16 v[76:79], a[216:219], v[148:151], v[76:79]
 ds_read_b64_tr_b16 a[208:209], v34 offset:16896
 v_mfma_f32_16x16x32_bf16 v[80:83], a[216:219], v[152:155], v[80:83]
 ds_read_b64_tr_b16 a[210:211], v34 offset:21120
 v_mfma_f32_16x16x32_bf16 v[84:87], a[220:223], v[148:151], v[84:87]
 ds_read_b64_tr_b16 a[212:213], v34 offset:16928
 v_mfma_f32_16x16x32_bf16 v[88:91], a[220:223], v[152:155], v[88:91]
 ds_read_b64_tr_b16 a[214:215], v34 offset:21152
 s_waitcnt lgkmcnt(4)
 v_mfma_f32_16x16x32_bf16 v[92:95], a[192:195], v[188:191], v[92:95]
 ds_read_b64_tr_b16 a[216:217], v34 offset:25344
 v_mfma_f32_16x16x32_bf16 v[96:99], a[192:195], v[192:195], v[96:99]
 ds_read_b64_tr_b16 a[218:219], v34 offset:29568
 v_mfma_f32_16x16x32_bf16 v[100:103], a[196:199], v[188:191], v[100:103]
 ds_read_b64_tr_b16 a[220:221], v34 offset:25376
 v_mfma_f32_16x16x32_bf16 v[104:107], a[196:199], v[192:195], v[104:107]
 ds_read_b64_tr_b16 a[222:223], v34 offset:29600
 s_xor_b32 s66, s75, 0x8000
 s_add_u32 s86, s32, s66
 s_addc_u32 s87, s33, 0
 v_mfma_f32_16x16x32_bf16 v[92:95], a[200:203], v[196:199], v[92:95]
 ds_read_b64_tr_b16 a[192:193], v30 offset:0
 v_cvt_pk_bf16_f32 v156, v76, v77
 v_cvt_pk_bf16_f32 v157, v78, v79
 v_cvt_pk_bf16_f32 v158, v84, v85
 v_mfma_f32_16x16x32_bf16 v[96:99], a[200:203], v[200:203], v[96:99]
 ds_read_b64_tr_b16 a[194:195], v30 offset:4224
 v_cvt_pk_bf16_f32 v159, v86, v87
 global_store_dwordx4 v40, v[156:159], s[86:87] offset:0 sc1
 v_cvt_pk_bf16_f32 v160, v80, v81
 v_mfma_f32_16x16x32_bf16 v[100:103], a[204:207], v[196:199], v[100:103]
 ds_read_b64_tr_b16 a[196:197], v30 offset:32
 v_cvt_pk_bf16_f32 v161, v82, v83
 v_cvt_pk_bf16_f32 v162, v88, v89
 v_cvt_pk_bf16_f32 v163, v90, v91
 v_mfma_f32_16x16x32_bf16 v[104:107], a[204:207], v[200:203], v[104:107]
 ds_read_b64_tr_b16 a[198:199], v30 offset:4256
 global_store_dwordx4 v40, v[160:163], s[86:87] offset:1024 sc1
 s_waitcnt lgkmcnt(4)
 v_mfma_f32_16x16x32_bf16 v[92:95], a[208:211], v[204:207], v[92:95]
 ds_read_b64_tr_b16 a[200:201], v30 offset:8448
 v_mfma_f32_16x16x32_bf16 v[96:99], a[208:211], v[208:211], v[96:99]
 ds_read_b64_tr_b16 a[202:203], v30 offset:12672
 v_mfma_f32_16x16x32_bf16 v[100:103], a[212:215], v[204:207], v[100:103]
 ds_read_b64_tr_b16 a[204:205], v30 offset:8480
 v_mfma_f32_16x16x32_bf16 v[104:107], a[212:215], v[208:211], v[104:107]
 ds_read_b64_tr_b16 a[206:207], v30 offset:12704
 v_mfma_f32_16x16x32_bf16 v[92:95], a[216:219], v[212:215], v[92:95]
 ds_read_b64_tr_b16 a[208:209], v30 offset:16896
 v_mfma_f32_16x16x32_bf16 v[96:99], a[216:219], v[216:219], v[96:99]
 ds_read_b64_tr_b16 a[210:211], v30 offset:21120
 v_mfma_f32_16x16x32_bf16 v[100:103], a[220:223], v[212:215], v[100:103]
 ds_read_b64_tr_b16 a[212:213], v30 offset:16928
 v_mfma_f32_16x16x32_bf16 v[104:107], a[220:223], v[216:219], v[104:107]
 ds_read_b64_tr_b16 a[214:215], v30 offset:21152
 s_waitcnt lgkmcnt(4)
 v_mfma_f32_16x16x32_bf16 v[92:95], a[192:195], v[124:127], v[92:95]
 ds_read_b64_tr_b16 a[216:217], v30 offset:25344
 v_mfma_f32_16x16x32_bf16 v[96:99], a[192:195], v[128:131], v[96:99]
 ds_read_b64_tr_b16 a[218:219], v30 offset:29568
 v_mfma_f32_16x16x32_bf16 v[100:103], a[196:199], v[124:127], v[100:103]
 ds_read_b64_tr_b16 a[220:221], v30 offset:25376
 s_xor_b32 s3, s75, 8192
 v_mfma_f32_16x16x32_bf16 v[104:107], a[196:199], v[128:131], v[104:107]
 ds_read_b64_tr_b16 a[222:223], v30 offset:29600
 s_add_u32 s44, s32, s3
 s_addc_u32 s45, s33, 0
 v_mfma_f32_16x16x32_bf16 v[92:95], a[200:203], v[132:135], v[92:95]
 ds_read_b64_tr_b16 a[192:193], v35 offset:0
 s_xor_b32 s3, s75, 16384
 v_mfma_f32_16x16x32_bf16 v[96:99], a[200:203], v[136:139], v[96:99]
 ds_read_b64_tr_b16 a[194:195], v35 offset:4224
 s_add_u32 s40, s32, s3
 s_addc_u32 s41, s33, 0
 v_mfma_f32_16x16x32_bf16 v[100:103], a[204:207], v[132:135], v[100:103]
 ds_read_b64_tr_b16 a[196:197], v35 offset:32
 s_xor_b32 s3, s75, 24576
 v_mfma_f32_16x16x32_bf16 v[104:107], a[204:207], v[136:139], v[104:107]
 ds_read_b64_tr_b16 a[198:199], v35 offset:4256
 s_waitcnt lgkmcnt(4)
 v_mfma_f32_16x16x32_bf16 v[92:95], a[208:211], v[140:143], v[92:95]
 ds_read_b64_tr_b16 a[200:201], v35 offset:8448
 s_add_u32 s36, s32, s3
 s_addc_u32 s37, s33, 0
 v_mfma_f32_16x16x32_bf16 v[96:99], a[208:211], v[144:147], v[96:99]
 ds_read_b64_tr_b16 a[202:203], v35 offset:12672
 v_mfma_f32_16x16x32_bf16 v[100:103], a[212:215], v[140:143], v[100:103]
 ds_read_b64_tr_b16 a[204:205], v35 offset:8480
 v_mfma_f32_16x16x32_bf16 v[104:107], a[212:215], v[144:147], v[104:107]
 ds_read_b64_tr_b16 a[206:207], v35 offset:12704
 v_mfma_f32_16x16x32_bf16 v[92:95], a[216:219], v[148:151], v[92:95]
 ds_read_b64_tr_b16 a[208:209], v35 offset:16896
 v_mfma_f32_16x16x32_bf16 v[96:99], a[216:219], v[152:155], v[96:99]
 ds_read_b64_tr_b16 a[210:211], v35 offset:21120
 v_mfma_f32_16x16x32_bf16 v[100:103], a[220:223], v[148:151], v[100:103]
 ds_read_b64_tr_b16 a[212:213], v35 offset:16928
 v_mfma_f32_16x16x32_bf16 v[104:107], a[220:223], v[152:155], v[104:107]
 ds_read_b64_tr_b16 a[214:215], v35 offset:21152
 s_waitcnt lgkmcnt(4)
 v_mfma_f32_16x16x32_bf16 v[108:111], a[192:195], v[188:191], v[108:111]
 ds_read_b64_tr_b16 a[216:217], v35 offset:25344
 v_mfma_f32_16x16x32_bf16 v[112:115], a[192:195], v[192:195], v[112:115]
 ds_read_b64_tr_b16 a[218:219], v35 offset:29568
 v_mfma_f32_16x16x32_bf16 v[116:119], a[196:199], v[188:191], v[116:119]
 ds_read_b64_tr_b16 a[220:221], v35 offset:25376
 v_mfma_f32_16x16x32_bf16 v[120:123], a[196:199], v[192:195], v[120:123]
 ds_read_b64_tr_b16 a[222:223], v35 offset:29600
 s_xor_b32 s66, s75, 0x10000
 s_add_u32 s86, s32, s66
 s_addc_u32 s87, s33, 0
 v_mfma_f32_16x16x32_bf16 v[108:111], a[200:203], v[196:199], v[108:111]
 ds_read_b64_tr_b16 a[192:193], v31 offset:0
 v_cvt_pk_bf16_f32 v164, v92, v93
 v_cvt_pk_bf16_f32 v165, v94, v95
 v_cvt_pk_bf16_f32 v166, v100, v101
 v_mfma_f32_16x16x32_bf16 v[112:115], a[200:203], v[200:203], v[112:115]
 ds_read_b64_tr_b16 a[194:195], v31 offset:4224
 v_cvt_pk_bf16_f32 v167, v102, v103
 s_waitcnt vmcnt(4)
 global_store_dwordx4 v40, v[164:167], s[86:87] offset:0 sc1
 v_mfma_f32_16x16x32_bf16 v[116:119], a[204:207], v[196:199], v[116:119]
 ds_read_b64_tr_b16 a[196:197], v31 offset:32
 v_cvt_pk_bf16_f32 v168, v96, v97
 v_cvt_pk_bf16_f32 v169, v98, v99
 v_cvt_pk_bf16_f32 v170, v104, v105
 v_mfma_f32_16x16x32_bf16 v[120:123], a[204:207], v[200:203], v[120:123]
 ds_read_b64_tr_b16 a[198:199], v31 offset:4256
 v_cvt_pk_bf16_f32 v171, v106, v107
 global_store_dwordx4 v40, v[168:171], s[86:87] offset:1024 sc1
 s_waitcnt lgkmcnt(4)
 v_mfma_f32_16x16x32_bf16 v[108:111], a[208:211], v[204:207], v[108:111]
 ds_read_b64_tr_b16 a[200:201], v31 offset:8448
 v_mfma_f32_16x16x32_bf16 v[112:115], a[208:211], v[208:211], v[112:115]
 ds_read_b64_tr_b16 a[202:203], v31 offset:12672
 v_mfma_f32_16x16x32_bf16 v[116:119], a[212:215], v[204:207], v[116:119]
 ds_read_b64_tr_b16 a[204:205], v31 offset:8480
 v_mfma_f32_16x16x32_bf16 v[120:123], a[212:215], v[208:211], v[120:123]
 ds_read_b64_tr_b16 a[206:207], v31 offset:12704
 v_mfma_f32_16x16x32_bf16 v[108:111], a[216:219], v[212:215], v[108:111]
 ds_read_b64_tr_b16 a[208:209], v31 offset:16896
 v_mfma_f32_16x16x32_bf16 v[112:115], a[216:219], v[216:219], v[112:115]
 ds_read_b64_tr_b16 a[210:211], v31 offset:21120
 v_mfma_f32_16x16x32_bf16 v[116:119], a[220:223], v[212:215], v[116:119]
 ds_read_b64_tr_b16 a[212:213], v31 offset:16928
 v_mfma_f32_16x16x32_bf16 v[120:123], a[220:223], v[216:219], v[120:123]
 ds_read_b64_tr_b16 a[214:215], v31 offset:21152
 s_waitcnt vmcnt(2)
 s_mov_b64 exec, 1
 buffer_store_dword v44, v45, s[32:35], s74 offen offset:8 sc1
 s_mov_b64 exec, -1
 s_waitcnt lgkmcnt(4)
 v_mfma_f32_16x16x32_bf16 v[108:111], a[192:195], v[124:127], v[108:111]
 ds_read_b64_tr_b16 a[216:217], v31 offset:25344
 v_mfma_f32_16x16x32_bf16 v[112:115], a[192:195], v[128:131], v[112:115]
 ds_read_b64_tr_b16 a[218:219], v31 offset:29568
 v_mfma_f32_16x16x32_bf16 v[116:119], a[196:199], v[124:127], v[116:119]
 ds_read_b64_tr_b16 a[220:221], v31 offset:25376
 v_mfma_f32_16x16x32_bf16 v[120:123], a[196:199], v[128:131], v[120:123]
 ds_read_b64_tr_b16 a[222:223], v31 offset:29600
 v_mfma_f32_16x16x32_bf16 v[108:111], a[200:203], v[132:135], v[108:111]
 ds_read_b64_tr_b16 a[192:193], v32 offset:0
 v_mfma_f32_16x16x32_bf16 v[112:115], a[200:203], v[136:139], v[112:115]
 ds_read_b64_tr_b16 a[194:195], v32 offset:4224
 v_mfma_f32_16x16x32_bf16 v[116:119], a[204:207], v[132:135], v[116:119]
L_pad1_3582:
 s_cbranch_execz L_ret1_1
 ds_read_b64_tr_b16 a[196:197], v32 offset:32
 v_mfma_f32_16x16x32_bf16 v[120:123], a[204:207], v[136:139], v[120:123]
 ds_read_b64_tr_b16 a[198:199], v32 offset:4256
 s_waitcnt lgkmcnt(4)
 v_mfma_f32_16x16x32_bf16 v[108:111], a[208:211], v[140:143], v[108:111]
 ds_read_b64_tr_b16 a[200:201], v32 offset:8448
 v_mfma_f32_16x16x32_bf16 v[112:115], a[208:211], v[144:147], v[112:115]
 ds_read_b64_tr_b16 a[202:203], v32 offset:12672
 v_mfma_f32_16x16x32_bf16 v[116:119], a[212:215], v[140:143], v[116:119]
 ds_read_b64_tr_b16 a[204:205], v32 offset:8480
 v_mfma_f32_16x16x32_bf16 v[120:123], a[212:215], v[144:147], v[120:123]
 ds_read_b64_tr_b16 a[206:207], v32 offset:12704
 v_mfma_f32_16x16x32_bf16 v[108:111], a[216:219], v[148:151], v[108:111]
 ds_read_b64_tr_b16 a[208:209], v32 offset:16896
 v_mfma_f32_16x16x32_bf16 v[112:115], a[216:219], v[152:155], v[112:115]
 ds_read_b64_tr_b16 a[210:211], v32 offset:21120
 v_mfma_f32_16x16x32_bf16 v[116:119], a[220:223], v[148:151], v[116:119]
 ds_read_b64_tr_b16 a[212:213], v32 offset:16928
 v_mfma_f32_16x16x32_bf16 v[120:123], a[220:223], v[152:155], v[120:123]
 ds_read_b64_tr_b16 a[214:215], v32 offset:21152
 s_waitcnt lgkmcnt(4)
 v_mfma_f32_16x16x32_bf16 v[60:63], a[192:195], v[188:191], v[60:63]
 ds_read_b64_tr_b16 a[216:217], v32 offset:25344
 v_mfma_f32_16x16x32_bf16 v[64:67], a[192:195], v[192:195], v[64:67]
 ds_read_b64_tr_b16 a[218:219], v32 offset:29568
 v_mfma_f32_16x16x32_bf16 v[68:71], a[196:199], v[188:191], v[68:71]
 ds_read_b64_tr_b16 a[220:221], v32 offset:25376
 v_mfma_f32_16x16x32_bf16 v[72:75], a[196:199], v[192:195], v[72:75]
 ds_read_b64_tr_b16 a[222:223], v32 offset:29600
 s_xor_b32 s66, s75, 0x18000
 s_add_u32 s86, s32, s66
 s_addc_u32 s87, s33, 0
 v_mfma_f32_16x16x32_bf16 v[60:63], a[200:203], v[196:199], v[60:63]
 ds_read_b64_tr_b16 a[192:193], v28 offset:0
 v_cvt_pk_bf16_f32 v172, v108, v109
 v_cvt_pk_bf16_f32 v173, v110, v111
 v_cvt_pk_bf16_f32 v174, v116, v117
 v_mfma_f32_16x16x32_bf16 v[64:67], a[200:203], v[200:203], v[64:67]
 ds_read_b64_tr_b16 a[194:195], v28 offset:4224
 v_cvt_pk_bf16_f32 v175, v118, v119
 global_store_dwordx4 v40, v[172:175], s[86:87] offset:0 sc1
 v_mfma_f32_16x16x32_bf16 v[68:71], a[204:207], v[196:199], v[68:71]
 ds_read_b64_tr_b16 a[196:197], v28 offset:32
 v_cvt_pk_bf16_f32 v176, v112, v113
 v_cvt_pk_bf16_f32 v177, v114, v115
 v_cvt_pk_bf16_f32 v178, v120, v121
 v_mfma_f32_16x16x32_bf16 v[72:75], a[204:207], v[200:203], v[72:75]
 ds_read_b64_tr_b16 a[198:199], v28 offset:4256
 v_cvt_pk_bf16_f32 v179, v122, v123
 global_store_dwordx4 v40, v[176:179], s[86:87] offset:1024 sc1
 s_waitcnt lgkmcnt(4)
 v_mfma_f32_16x16x32_bf16 v[60:63], a[208:211], v[204:207], v[60:63]
 ds_read_b64_tr_b16 a[200:201], v28 offset:8448
 v_mfma_f32_16x16x32_bf16 v[64:67], a[208:211], v[208:211], v[64:67]
 ds_read_b64_tr_b16 a[202:203], v28 offset:12672
 v_mfma_f32_16x16x32_bf16 v[68:71], a[212:215], v[204:207], v[68:71]
 ds_read_b64_tr_b16 a[204:205], v28 offset:8480
 buffer_load_dword v43, v42, s[32:35], s73 offen offset:8 sc1
 v_mfma_f32_16x16x32_bf16 v[72:75], a[212:215], v[208:211], v[72:75]
 ds_read_b64_tr_b16 a[206:207], v28 offset:12704
 v_mfma_f32_16x16x32_bf16 v[60:63], a[216:219], v[212:215], v[60:63]
 ds_read_b64_tr_b16 a[208:209], v28 offset:16896
 v_mfma_f32_16x16x32_bf16 v[64:67], a[216:219], v[216:219], v[64:67]
 ds_read_b64_tr_b16 a[210:211], v28 offset:21120
 v_mfma_f32_16x16x32_bf16 v[68:71], a[220:223], v[212:215], v[68:71]
 ds_read_b64_tr_b16 a[212:213], v28 offset:16928
 v_mfma_f32_16x16x32_bf16 v[72:75], a[220:223], v[216:219], v[72:75]
 ds_read_b64_tr_b16 a[214:215], v28 offset:21152
 s_waitcnt lgkmcnt(4)
 v_mfma_f32_16x16x32_bf16 v[60:63], a[192:195], v[124:127], v[60:63]
 ds_read_b64_tr_b16 a[216:217], v28 offset:25344
 v_mfma_f32_16x16x32_bf16 v[64:67], a[192:195], v[128:131], v[64:67]
 ds_read_b64_tr_b16 a[218:219], v28 offset:29568
 v_mfma_f32_16x16x32_bf16 v[68:71], a[196:199], v[124:127], v[68:71]
 ds_read_b64_tr_b16 a[220:221], v28 offset:25376
 v_mfma_f32_16x16x32_bf16 v[72:75], a[196:199], v[128:131], v[72:75]
 ds_read_b64_tr_b16 a[222:223], v28 offset:29600
 v_mfma_f32_16x16x32_bf16 v[60:63], a[200:203], v[132:135], v[60:63]
 v_mfma_f32_16x16x32_bf16 v[64:67], a[200:203], v[136:139], v[64:67]
 v_mfma_f32_16x16x32_bf16 v[68:71], a[204:207], v[132:135], v[68:71]
 v_mfma_f32_16x16x32_bf16 v[72:75], a[204:207], v[136:139], v[72:75]
 s_waitcnt lgkmcnt(0)
 v_mfma_f32_16x16x32_bf16 v[60:63], a[208:211], v[140:143], v[60:63]
 v_mfma_f32_16x16x32_bf16 v[64:67], a[208:211], v[144:147], v[64:67]
 v_mfma_f32_16x16x32_bf16 v[68:71], a[212:215], v[140:143], v[68:71]
 v_mfma_f32_16x16x32_bf16 v[72:75], a[212:215], v[144:147], v[72:75]
 v_mfma_f32_16x16x32_bf16 v[60:63], a[216:219], v[148:151], v[60:63]
 v_mfma_f32_16x16x32_bf16 v[64:67], a[216:219], v[152:155], v[64:67]
 s_waitcnt vmcnt(0)
 v_cmp_ne_u32 vcc, 1, v43
 s_cbranch_vccnz L_slow1p
L_back1p:
 global_load_dwordx4 v[76:79], v40, s[44:45] offset:0 sc1
 v_mfma_f32_16x16x32_bf16 v[68:71], a[220:223], v[148:151], v[68:71]
 global_load_dwordx4 v[80:83], v40, s[44:45] offset:1024 sc1
 v_mfma_f32_16x16x32_bf16 v[72:75], a[220:223], v[152:155], v[72:75]
 global_load_dwordx4 v[84:87], v40, s[40:41] offset:0 sc1
 v_mfma_f32_16x16x32_bf16 v[60:63], a[0:3], v[4:7], v[60:63]
 global_load_dwordx4 v[88:91], v40, s[40:41] offset:1024 sc1
 v_mfma_f32_16x16x32_bf16 v[64:67], a[0:3], v[8:11], v[64:67]
 v_mfma_f32_16x16x32_bf16 v[68:71], a[4:7], v[4:7], v[68:71]
 v_mfma_f32_16x16x32_bf16 v[72:75], a[4:7], v[8:11], v[72:75]
 v_mfma_f32_16x16x32_bf16 v[60:63], a[8:11], v[12:15], v[60:63]
 v_mfma_f32_16x16x32_bf16 v[64:67], a[8:11], v[16:19], v[64:67]
 v_mfma_f32_16x16x32_bf16 v[68:71], a[12:15], v[12:15], v[68:71]
 global_load_dwordx4 v[92:95], v40, s[36:37] offset:0 sc1
 v_mfma_f32_16x16x32_bf16 v[72:75], a[12:15], v[16:19], v[72:75]
 global_load_dwordx4 v[96:99], v40, s[36:37] offset:1024 sc1
 v_mfma_f32_16x16x32_bf16 v[60:63], a[16:19], v[0:3], v[60:63]
 v_mfma_f32_16x16x32_bf16 v[64:67], a[16:19], v[252:255], v[64:67]
 v_mfma_f32_16x16x32_bf16 v[68:71], a[20:23], v[0:3], v[68:71]
 v_mfma_f32_16x16x32_bf16 v[72:75], a[20:23], v[252:255], v[72:75]
 v_mfma_f32_16x16x32_bf16 v[60:63], a[24:27], v[52:55], v[60:63]
 v_mfma_f32_16x16x32_bf16 v[64:67], a[24:27], v[56:59], v[64:67]
 v_mfma_f32_16x16x32_bf16 v[68:71], a[28:31], v[52:55], v[68:71]
 v_mfma_f32_16x16x32_bf16 v[72:75], a[28:31], v[56:59], v[72:75]
 v_mfma_f32_16x16x32_bf16 v[60:63], a[32:35], v[220:223], v[60:63]
 v_mfma_f32_16x16x32_bf16 v[64:67], a[32:35], v[224:227], v[64:67]
 v_mfma_f32_16x16x32_bf16 v[68:71], a[36:39], v[220:223], v[68:71]
 v_mfma_f32_16x16x32_bf16 v[72:75], a[36:39], v[224:227], v[72:75]
 v_mfma_f32_16x16x32_bf16 v[60:63], a[40:43], v[228:231], v[60:63]
 v_mfma_f32_16x16x32_bf16 v[64:67], a[40:43], v[232:235], v[64:67]
 v_mfma_f32_16x16x32_bf16 v[68:71], a[44:47], v[228:231], v[68:71]
 v_mfma_f32_16x16x32_bf16 v[72:75], a[44:47], v[232:235], v[72:75]
 v_mfma_f32_16x16x32_bf16 v[60:63], a[48:51], v[236:239], v[60:63]
 v_mfma_f32_16x16x32_bf16 v[64:67], a[48:51], v[240:243], v[64:67]
 v_mfma_f32_16x16x32_bf16 v[68:71], a[52:55], v[236:239], v[68:71]
 v_mfma_f32_16x16x32_bf16 v[72:75], a[52:55], v[240:243], v[72:75]
 v_mfma_f32_16x16x32_bf16 v[60:63], a[56:59], v[244:247], v[60:63]
 v_mfma_f32_16x16x32_bf16 v[64:67], a[56:59], v[248:251], v[64:67]
 v_mfma_f32_16x16x32_bf16 v[68:71], a[60:63], v[244:247], v[68:71]
 v_mfma_f32_16x16x32_bf16 v[72:75], a[60:63], v[248:251], v[72:75]
 s_nop 4
 v_cvt_pk_bf16_f32 v180, v60, v61
 v_cvt_pk_bf16_f32 v181, v62, v63
 v_cvt_pk_bf16_f32 v182, v68, v69
 v_cvt_pk_bf16_f32 v183, v70, v71
 v_cvt_pk_bf16_f32 v184, v64, v65
 v_cvt_pk_bf16_f32 v185, v66, v67
 v_cvt_pk_bf16_f32 v186, v72, v73
 v_cvt_pk_bf16_f32 v187, v74, v75
 v_add_u32 v48, 32768, v46
 v_mfma_f32_16x16x32_bf16 v[100:103], v[180:183], a[248:251], 0
 v_mfma_f32_16x16x32_bf16 v[104:107], v[180:183], a[252:255], 0
 v_mfma_f32_16x16x32_bf16 v[108:111], v[184:187], a[248:251], 0
 v_mfma_f32_16x16x32_bf16 v[112:115], v[184:187], a[252:255], 0
 s_waitcnt vmcnt(5)
 v_mfma_f32_16x16x32_bf16 v[100:103], v[76:79], a[248:251], v[100:103]
 v_mfma_f32_16x16x32_bf16 v[104:107], v[76:79], a[252:255], v[104:107]
 s_waitcnt vmcnt(4)
 v_mfma_f32_16x16x32_bf16 v[108:111], v[80:83], a[248:251], v[108:111]
 v_mfma_f32_16x16x32_bf16 v[112:115], v[80:83], a[252:255], v[112:115]
 s_waitcnt vmcnt(2)
 v_max_u32 v43, v84, v88
 v_cmp_eq_u32 vcc, -1, v43
 s_cbranch_vccnz L_slow1s2
L_back1s2:
 v_mfma_f32_16x16x32_bf16 v[100:103], v[84:87], a[248:251], v[100:103]
 v_mfma_f32_16x16x32_bf16 v[104:107], v[84:87], a[252:255], v[104:107]
 v_mfma_f32_16x16x32_bf16 v[108:111], v[88:91], a[248:251], v[108:111]
 v_mfma_f32_16x16x32_bf16 v[112:115], v[88:91], a[252:255], v[112:115]
 s_waitcnt vmcnt(0)
 v_max_u32 v43, v92, v96
 v_cmp_eq_u32 vcc, -1, v43
 s_cbranch_vccnz L_slow1s3
L_back1s3:
 v_mfma_f32_16x16x32_bf16 v[100:103], v[92:95], a[248:251], v[100:103]
 v_mfma_f32_16x16x32_bf16 v[104:107], v[92:95], a[252:255], v[104:107]
 v_mfma_f32_16x16x32_bf16 v[108:111], v[96:99], a[248:251], v[108:111]
 v_mfma_f32_16x16x32_bf16 v[112:115], v[96:99], a[252:255], v[112:115]
 s_nop 5
 v_cvt_pk_bf16_f32 v60, v100, v104
 global_store_dword v46, v60, s[24:25] offset:-4096 sc0 sc1
 v_cvt_pk_bf16_f32 v61, v101, v105
 global_store_dword v46, v61, s[24:25] offset:-2048 sc0 sc1
 v_cvt_pk_bf16_f32 v62, v102, v106
 global_store_dword v46, v62, s[24:25] offset:0 sc0 sc1
 v_cvt_pk_bf16_f32 v63, v103, v107
 global_store_dword v46, v63, s[24:25] offset:2048 sc0 sc1
 v_cvt_pk_bf16_f32 v64, v108, v112
 global_store_dword v48, v64, s[24:25] offset:-4096 sc0 sc1
 v_cvt_pk_bf16_f32 v65, v109, v113
 global_store_dword v48, v65, s[24:25] offset:-2048 sc0 sc1
 v_cvt_pk_bf16_f32 v66, v110, v114
 global_store_dword v48, v66, s[24:25] offset:0 sc0 sc1
 v_cvt_pk_bf16_f32 v67, v111, v115
 global_store_dword v48, v67, s[24:25] offset:2048 sc0 sc1
 s_endpgm
L_pad1_3770:
 s_branch L_ret1_1
L_slow1p:
 s_mov_b32 s67, 400000
L_spin1p:
 buffer_load_dword v43, v42, s[32:35], s73 offen offset:8 sc1
 s_waitcnt vmcnt(0)
 v_cmp_ne_u32 vcc, 1, v43
 s_cbranch_vccz L_back1p
 s_sub_u32 s67, s67, 1
 s_cmp_lg_u32 s67, 0
 s_cbranch_scc1 L_spin1p
 s_branch L_back1p
L_init1:
 s_mov_b64 exec, 1
 global_store_dword v45, v44, s[28:29] sc1
 s_mov_b64 exec, -1
 s_branch L_noinit1
L_slow1s2:
 s_mov_b32 s67, 400000
L_spin1s2:
 global_load_dwordx4 v[84:87], v40, s[40:41] offset:0 sc1
 global_load_dwordx4 v[88:91], v40, s[40:41] offset:1024 sc1
 s_waitcnt vmcnt(0)
 v_max_u32 v43, v84, v88
 v_cmp_eq_u32 vcc, -1, v43
 s_cbranch_vccz L_back1s2
 s_sub_u32 s67, s67, 1
 s_cmp_lg_u32 s67, 0
 s_cbranch_scc1 L_spin1s2
 s_branch L_back1s2
L_slow1s3:
 s_mov_b32 s67, 400000
L_spin1s3:
 global_load_dwordx4 v[92:95], v40, s[36:37] offset:0 sc1
 global_load_dwordx4 v[96:99], v40, s[36:37] offset:1024 sc1
 s_waitcnt vmcnt(0)
 v_max_u32 v43, v92, v96
 v_cmp_eq_u32 vcc, -1, v43
 s_cbranch_vccz L_back1s3
 s_sub_u32 s67, s67, 1
 s_cmp_lg_u32 s67, 0
 s_cbranch_scc1 L_spin1s3
 s_branch L_back1s3
L_slow1i:
 s_mov_b32 s67, 400000
L_spin1i:
 global_load_dword v43, v45, s[28:29] sc1
 s_waitcnt vmcnt(0)
 v_cmp_ne_u32 vcc, 1, v43
 s_cbranch_vccz L_back1i
 s_sub_u32 s67, s67, 1
 s_cmp_lg_u32 s67, 0
 s_cbranch_scc1 L_spin1i
 s_branch L_back1i
L_slow1a:
 s_mov_b32 s67, 400000
L_spin1a:
 buffer_load_dword v43, v41, s[32:35], s73 offen offset:0 sc1
 s_waitcnt vmcnt(0)
 v_cmp_ne_u32 vcc, 1, v43
 s_cbranch_vccz L_back1a
 s_sub_u32 s67, s67, 1
 s_cmp_lg_u32 s67, 0
 s_cbranch_scc1 L_spin1a
 s_branch L_back1a
L_slow1b:
 s_mov_b32 s67, 400000
L_spin1b:
 buffer_load_dword v43, v41, s[32:35], s73 offen offset:4 sc1
 s_waitcnt vmcnt(0)
 v_cmp_ne_u32 vcc, 1, v43
 s_cbranch_vccz L_back1b
 s_sub_u32 s67, s67, 1
 s_cmp_lg_u32 s67, 0
 s_cbranch_scc1 L_spin1b
 s_branch L_back1b
L_end:
 s_endpgm
.p2align 8
.fill 2048, 4, 0xbf810000
.section .rodata,"a"
.p2align 6
.amdhsa_kernel concat_heads__mha_block_cached__mha_block_cached__near_ridge_kernel
  .amdhsa_next_free_vgpr 512
  .amdhsa_next_free_sgpr 102
  .amdhsa_accum_offset 256
  .amdhsa_group_segment_fixed_size 0
  .amdhsa_kernarg_size 104
  .amdhsa_user_sgpr_count 2
  .amdhsa_user_sgpr_kernarg_segment_ptr 1
  .amdhsa_system_sgpr_workgroup_id_x 1
  .amdhsa_float_denorm_mode_32 3
.end_amdhsa_kernel
```
